```python
import torch

def _softmax(x, axis=-1):
    return torch.softmax(x, dim=axis)
def _gelu(x):
    return torch.nn.functional.gelu(x, approximate="tanh")
def _silu(x):
    return torch.nn.functional.silu(x)
def _sigmoid(x):
    return torch.sigmoid(x)
def _layernorm(x, axis=-1, eps=1e-5):
    m = x.mean(dim=axis, keepdim=True)
    v = x.var(dim=axis, keepdim=True, unbiased=False)
    return (x - m) / torch.sqrt(v + eps)
def _scatter_add(tgt, idx, src, axis=0):
    return tgt.clone().index_add_(axis, idx, src)
def _segment_sum(src, seg, n):
    out = torch.zeros((n,) + src.shape[1:], dtype=src.dtype)
    return out.index_add_(0, seg, src)
def _pad(x, pw):
    flat = tuple(v for pair in reversed(pw) for v in pair)
    return torch.nn.functional.pad(x, flat)

kernel_name = 'sequential_preLN__sliding_local_dilated__mixer_s_mlp__prompt'

def setup_inputs():

    _w = (lambda a: (lambda t: t.to(torch.bfloat16) if t.is_floating_point() else t)(torch.as_tensor(a)))
    def _A_setup():
        B, S, D = 1, 2048, 640
        return {
            "x": _w((lambda *s: torch.randn(*s, dtype=torch.bfloat16) * 0.05)(B, S, D)),
            "wqkv": _w((lambda *s: torch.randn(*s, dtype=torch.bfloat16) * 0.05)(D, 3 * D)),
            "wo": _w((lambda *s: torch.randn(*s, dtype=torch.bfloat16) * 0.05)(D, D)),
        }
    _A_in = _A_setup()

    def _B_setup():
        B, S, D, F = 1, 2048, 640, 1536
        return {
            "x":  _w((lambda *s: torch.randn(*s, dtype=torch.bfloat16) * 0.05)(B, S, D)),
            "w1": _w((lambda *s: torch.randn(*s, dtype=torch.bfloat16) * 3.2)(D, D) * (D ** -0.5)),
            "w2": _w((lambda *s: torch.randn(*s, dtype=torch.bfloat16) * 3.2)(D, D) * (D ** -0.5)),
            "w3": _w((lambda *s: torch.randn(*s, dtype=torch.bfloat16) * 3.2)(D, F) * (D ** -0.5)),
            "w4": _w((lambda *s: torch.randn(*s, dtype=torch.bfloat16) * 3.2)(F, D) * (F ** -0.5)),
        }
    _B_in = _B_setup()

    return {
        "A_x": _A_in["x"],
        "A_wqkv": _A_in["wqkv"],
        "A_wo": _A_in["wo"],
        "B_x": _B_in["x"],
        "B_w1": _B_in["w1"],
        "B_w2": _B_in["w2"],
        "B_w3": _B_in["w3"],
        "B_w4": _B_in["w4"],
    }

def reference(A_x, A_wqkv, A_wo, B_x, B_w1, B_w2, B_w3, B_w4):
    def _A_ref(x, wqkv, wo):
        B, S, D = x.shape
        H = 32; Dh = D // H
        W, dil = 8, 2
        qkv = (lambda x, *d: x.permute(*d))((x @ wqkv).reshape(B, S, 3, H, Dh), 2, 0, 3, 1, 4)
        q, k, v = qkv[0], qkv[1], qkv[2]
        scale = Dh ** -0.5
        pos = torch.arange(S)
        off = torch.arange(W) * dil
        idx = pos[:, None] - off[None, :]
        mask = idx >= 0
        idx_c = torch.where(mask, idx, 0).reshape(-1)
        kg = k[:, :, idx_c, :].reshape(B, H, S, W, Dh)
        vg = v[:, :, idx_c, :].reshape(B, H, S, W, Dh)
        logits = torch.einsum("bhsd,bhswd->bhsw", q, kg) * scale
        logits = torch.where(mask[None, None, :, :], logits, -1e9)
        attn = _softmax(logits, axis=-1)
        o = torch.einsum("bhsw,bhswd->bhsd", attn, vg)
        return (lambda x, *d: x.permute(*d))(o, 0, 2, 1, 3).reshape(B, S, D) @ wo

    def _B_ref(x, w1, w2, w3, w4):
        B, S, D = x.shape
        h = _gelu(_layernorm(x, axis=-1) @ w1)
        c = D // 4
        g0 = _pad(h[:, :, 0*c:1*c], ((0, 0), (1, 0), (0, 0)))[:, :S, :]
        g1 = _pad(h[:, :, 1*c:2*c], ((0, 0), (0, 1), (0, 0)))[:, 1:, :]
        g2 = _pad(h[:, :, 2*c:3*c], ((0, 0), (2, 0), (0, 0)))[:, :S, :]
        g3 = _pad(h[:, :, 3*c:   ], ((0, 0), (0, 2), (0, 0)))[:, 2:, :]
        hs = torch.concatenate([g0, g1, g2, g3], axis=-1) @ w2
        x1 = x + hs
        h2 = _gelu(_layernorm(x1, axis=-1) @ w3) @ w4
        return x1 + h2

    x = A_x
    h = x + _A_ref(_layernorm(x, axis=-1), A_wqkv, A_wo)
    h2 = h + _B_ref(_layernorm(h, axis=-1), B_w1, B_w2, B_w3, B_w4)
    return h2
```

```asm
; @launch grid=(256,1,1) block=(256,1,1) lds=163840
.amdgcn_target "amdgcn-amd-amdhsa--gfx950"
.text
.globl sequential_preLN__sliding_local_dilated__mixer_s_mlp__prompt_kernel
.p2align 12
.p2align 8
.type sequential_preLN__sliding_local_dilated__mixer_s_mlp__prompt_kernel,@function
sequential_preLN__sliding_local_dilated__mixer_s_mlp__prompt_kernel:
    s_cmp_ge_u32 s2, 256
    s_cbranch_scc1 L_end
    s_load_dwordx16 s[84:99], s[0:1], 0
    s_load_dwordx4 s[76:79], s[0:1], 64
    s_load_dwordx2 s[74:75], s[0:1], 80
    v_lshrrev_b32 v48, 6, v0
    v_and_b32 v0, 63, v0
    v_readfirstlane_b32 s44, v48
    v_lshrrev_b32 v1, 4, v0
    v_and_b32 v2, 15, v0
    s_and_b32 s45, s2, 7
    s_lshr_b32 s46, s2, 3
    s_and_b32 s47, s46, 3
    s_lshr_b32 s48, s46, 2
    s_and_b32 s68, s46, 1
    s_lshl_b32 s54, s45, 1
    s_add_u32 s54, s54, s68
    s_lshr_b32 s55, s46, 1
    s_cmp_eq_u32 s55, 15
    s_cbranch_scc1 L_idle_1
    s_lshr_b32 s3, s44, 1
    s_and_b32 s82, s44, 1
    v_lshrrev_b32 v48, 3, v0
    s_movk_i32 s68, 1280
    v_mul_u32_u24 v48, s68, v48
    v_and_b32 v49, 7, v0
    v_xor_b32 v49, v49, v1
    v_xor_b32 v50, 0, v49
    v_lshl_add_u32 v50, v50, 4, v48
    v_add_u32 v216, 0, v50
    v_xor_b32 v50, 4, v49
    v_lshl_add_u32 v50, v50, 4, v48
    v_add_u32 v217, 9216, v50
    v_xor_b32_e64 v50, 0, v49
    v_lshl_add_u32 v50, v50, 4, v48
    v_add_u32 v218, 18432, v50
    v_xor_b32_e64 v50, 4, v49
    v_lshl_add_u32 v50, v50, 4, v48
    v_add_u32 v219, 27648, v50
    s_movk_i32 s68, 3840
    v_mul_u32_u24 v48, s68, v1
    v_and_b32 v49, 1, v0
    v_lshl_add_u32 v48, v49, 4, v48
    v_lshrrev_b32 v49, 1, v2
    v_xor_b32 v49, v49, v1
    v_xor_b32 v50, 0, v49
    v_lshl_add_u32 v50, v50, 5, v48
    v_add_u32 v220, 0, v50
    v_xor_b32 v50, 0, v49
    v_lshl_add_u32 v50, v50, 5, v48
    v_add_u32 v221, 14336, v50
    v_xor_b32_e64 v50, 4, v49
    v_lshl_add_u32 v50, v50, 5, v48
    v_add_u32 v222, 28672, v50
    v_xor_b32_e64 v50, 4, v49
    v_lshl_add_u32 v50, v50, 5, v48
    v_add_u32 v223, 43008, v50
    s_lshl_b32 s68, s54, 2
    s_add_u32 s68, s68, s44
    s_mul_i32 s83, s68, 40960
    s_mul_i32 s66, s44, 61440
    s_lshl_b32 s68, s55, 8
    s_add_u32 s66, s66, s68
    s_mul_i32 s62, s45, 3
    s_add_u32 s62, s62, s55
    s_mul_i32 s68, s62, 0xCCCD
    s_lshr_b32 s68, s68, 19
    s_mul_i32 s68, s68, 10
    s_sub_u32 s62, s62, s68
    s_lshl_b32 s73, s44, 12
    v_lshrrev_b32 v48, 1, v2
    v_xor_b32 v48, v48, v1
    v_lshlrev_b32 v48, 4, v48
    v_lshl_add_u32 v48, v2, 7, v48
    s_lshl_b32 s71, s3, 13
    s_lshl_b32 s72, s82, 12
    s_add_u32 s71, s71, s72
    v_add_u32 v224, s71, v48
    v_xor_b32 v225, 4096, v224
    v_xor_b32 v226, 64, v224
    v_xor_b32 v227, 64, v225
    v_lshrrev_b32 v48, 2, v2
    v_lshl_add_u32 v49, v1, 3, v48
    v_lshlrev_b32 v49, 8, v49
    v_and_b32 v50, 3, v0
    v_lshl_add_u32 v49, v50, 3, v49
    v_add_u32 v49, 16384, v49
    v_and_b32 v50, 1, v1
    v_lshl_or_b32 v48, v50, 2, v48
    s_lshl_b32 s71, s82, 2
    s_lshl_b32 s72, s3, 1
    s_add_u32 s71, s71, s72
    s_xor_b32 s72, s71, 0
    v_xor_b32 v50, s72, v48
    v_lshl_add_u32 v228, v50, 5, v49
    s_xor_b32 s72, s71, 1
    v_xor_b32 v50, s72, v48
    v_lshl_add_u32 v229, v50, 5, v49
    s_xor_b32 s72, s71, 2
    v_xor_b32 v50, s72, v48
    v_lshl_add_u32 v230, v50, 5, v49
    s_xor_b32 s72, s71, 3
    v_xor_b32 v50, s72, v48
    v_lshl_add_u32 v231, v50, 5, v49
    v_mov_b32 v42, 0x3f803f80
    v_mov_b32 v43, 0x3f803f80
    v_mov_b32 v44, 0x3f803f80
    v_mov_b32 v45, 0x3f803f80
    s_waitcnt lgkmcnt(0)
    s_mov_b32 s4, s84
    s_mov_b32 s5, s85
    s_mov_b32 s6, 2621440
    s_mov_b32 s7, 0x20000
    s_mov_b32 s8, s86
    s_mov_b32 s9, s87
    s_mov_b32 s10, 2457600
    s_mov_b32 s11, 0x20000
    s_mov_b32 s16, s76
    s_mov_b32 s17, s77
    s_mov_b32 s18, 2621440
    s_mov_b32 s19, 0x20000
    s_mov_b32 s20, s78
    s_mov_b32 s21, s79
    s_mov_b32 s22, 256
    s_mov_b32 s23, 0x20000
    s_mov_b32 s78, 0x67452301
    s_mov_b32 s79, 0x89
    s_bitcmp1_b32 s55, 0
    s_cselect_b32 s78, 0x85634120, s78
    s_cselect_b32 s79, 0x97, s79
    s_bitcmp0_b32 s46, 0
    s_cselect_b32 s78, 0x76543210, s78
    s_cselect_b32 s79, 0x98, s79
    s_bfe_u32 s67, s78, 0x40000
    s_add_u32 s67, s67, s62
    s_sub_u32 s69, s67, 10
    s_min_u32 s67, s67, s69
    s_add_u32 m0, s73, 16384
    s_mul_i32 s69, s67, 245760
    s_add_u32 s69, s69, s66
    buffer_load_dwordx4 v220, s[8:11], s69 offen offset:0  lds
    buffer_load_dwordx4 v221, s[8:11], s69 offen offset:1024  lds
    buffer_load_dwordx4 v222, s[8:11], s69 offen offset:2048  lds
    buffer_load_dwordx4 v223, s[8:11], s69 offen offset:3072  lds
    s_add_u32 m0, s73, 0
    s_lshl_b32 s68, s67, 7
    s_add_u32 s68, s68, s83
    buffer_load_dwordx4 v216, s[4:7], s68 offen offset:0 nt lds
    buffer_load_dwordx4 v217, s[4:7], s68 offen offset:1024 nt lds
    buffer_load_dwordx4 v218, s[4:7], s68 offen offset:2048 nt lds
    buffer_load_dwordx4 v219, s[4:7], s68 offen offset:3072 nt lds
    s_getpc_b64 s[80:81]
    s_and_b32 s80, s80, 0xffffff00
    s_mul_i32 s71, s46, 9
    v_add_u32 v48, s71, v0
    v_lshlrev_b32 v48, 7, v48
    s_cmp_lg_u32 s44, 3
    s_cbranch_scc1 L_cp_3
    s_mov_b64 exec, 0x1ff
    global_load_dword v5, v48, s[80:81]
    s_mov_b64 exec, -1
L_cp_3:
    v_add_u32 v240, 65536, v224
    v_add_u32 v241, 65536, v225
    v_add_u32 v242, 65536, v226
    v_add_u32 v243, 65536, v227
    v_add_u32 v244, 65536, v228
    v_add_u32 v245, 65536, v229
    v_add_u32 v246, 65536, v230
    v_add_u32 v247, 65536, v231
    s_mov_b32 s24, s88
    s_mov_b32 s25, s89
    s_mov_b32 s26, 819200
    s_mov_b32 s27, 0x20000
    s_mov_b32 s28, s92
    s_mov_b32 s29, s93
    s_mov_b32 s30, 819200
    s_mov_b32 s31, 0x20000
    s_mov_b32 s32, s94
    s_mov_b32 s33, s95
    s_mov_b32 s34, 819200
    s_mov_b32 s35, 0x20000
    s_mov_b32 s36, s96
    s_mov_b32 s37, s97
    s_mov_b32 s38, 1966080
    s_mov_b32 s39, 0x20000
    s_mov_b32 s40, s98
    s_mov_b32 s41, s99
    s_mov_b32 s42, 1966080
    s_mov_b32 s43, 0x20000
    s_bfe_u32 s67, s78, 0x40004
    s_add_u32 s67, s67, s62
    s_sub_u32 s69, s67, 10
    s_min_u32 s67, s67, s69
    s_add_u32 m0, s73, 49152
    s_mul_i32 s69, s67, 245760
    s_add_u32 s69, s69, s66
    buffer_load_dwordx4 v220, s[8:11], s69 offen offset:0  lds
    s_mov_b32 s12, s74
    s_mov_b32 s13, s75
    s_mov_b32 s14, 18874368
    s_mov_b32 s15, 0x20000
    s_lshl_b32 s49, s47, 2
    s_add_u32 s49, s49, s44
    s_lshl_b32 s57, s45, 4
    s_add_u32 s57, s57, s49
    s_mul_i32 s50, s45, 1310720
    s_add_u32 s50, s50, 1048576
    s_lshl_b32 s53, s45, 9
    s_add_u32 s53, s53, 8192
    s_lshl_b32 s52, s46, 2
    s_add_u32 s52, s52, s44
    s_lshl_b32 s52, s52, 2
    s_add_u32 s52, s52, s53
    v_lshlrev_b32 v8, 3, v0
    v_lshlrev_b32 v48, 3, v0
    v_add_u32 v48, s45, v48
    s_add_u32 s71, s45, 7
    buffer_load_dwordx4 v221, s[8:11], s69 offen offset:1024  lds
    v_lshlrev_b32 v49, 4, v2
    v_add_u32 v49, s71, v49
    v_cmp_lt_u32 vcc, 1, v1
    s_nop 1
    v_cndmask_b32 v48, v48, v49, vcc
    v_lshlrev_b32 v4, 5, v48
    s_movk_i32 s71, 4608
    v_mul_u32_u24 v3, s71, v1
    v_lshlrev_b32 v48, 4, v2
    v_add_u32 v3, v3, v48
    v_lshlrev_b32 v6, 4, v0
    v_lshrrev_b32 v48, 2, v0
    s_movk_i32 s71, 160
    v_mul_u32_u24 v50, s71, v48
    v_and_b32_e64 v49, 3, v0
    v_lshl_add_u32 v15, v49, 3, v50
    v_add_u32 v10, 61440, v6
    v_add_u32 v11, 122880, v6
    v_and_b32 v48, 1, v1
    v_lshlrev_b32 v48, 10, v48
    v_lshrrev_b32_e64 v49, 5, v0
    buffer_load_dwordx4 v222, s[8:11], s69 offen offset:2048  lds
    v_lshl_add_u32 v48, v49, 8, v48
    v_lshl_add_u32 v7, v2, 4, v48
    v_add_u32 v16, 61440, v7
    v_add_u32 v17, 122880, v7
    s_movk_i32 s71, 4608
    v_and_b32 v48, 31, v0
    v_lshlrev_b32 v48, 4, v48
    v_mad_u32_u24 v19, v49, s71, v48
    v_lshlrev_b32 v12, 6, v2
    v_lshl_add_u32 v12, v1, 4, v12
    s_mul_i32 s59, s44, 5120
    s_mul_i32 s58, s48, 5120
    s_mul_i32 s71, s44, 40960
    s_add_u32 s58, s58, s71
    s_mul_i32 s61, s44, 3072
    s_lshr_b32 s60, s46, 1
    s_mul_i32 s60, s60, 6144
    s_lshr_b32 s71, s44, 1
    s_mul_i32 s71, s71, 98304
    s_add_u32 s60, s60, s71
    buffer_load_dwordx4 v223, s[8:11], s69 offen offset:3072  lds
    s_and_b32 s71, s44, 1
    s_mul_i32 s71, s71, 3072
    s_add_u32 s60, s60, s71
    s_mul_i32 s71, s48, 5
    s_lshr_b32 s71, s71, 1
    s_mul_i32 s71, s71, 18432
    s_lshl_b32 s72, s49, 8
    s_add_u32 s72, s72, s50
    s_add_u32 s63, s71, s72
    s_add_u32 s64, s63, 18432
    s_add_u32 s65, s63, 36864
    s_mov_b32 s101, s2
    s_mul_i32 s70, s101, 0xCCCD
    s_lshr_b32 s70, s70, 19
    s_mul_i32 s56, s70, 10
    s_sub_u32 s56, s101, s56
    s_cmp_lt_u32 s101, 200
    s_cselect_b32 s100, 0, 1073741824
    s_lshl_b32 s89, s56, 1
    s_add_u32 s89, s89, s82
    s_lshl_b32 s89, s89, 8
    s_add_u32 m0, s73, 32768
    s_lshl_b32 s68, s67, 7
    s_add_u32 s68, s68, s83
    buffer_load_dwordx4 v216, s[4:7], s68 offen offset:0  lds
    s_add_u32 s89, s89, 15360
    s_or_b32 s89, s89, s100
    s_lshl_b32 s70, s70, 1
    s_add_u32 s70, s70, s82
    s_mul_i32 s90, s70, 20480
    s_lshl_b32 s56, s56, 7
    s_add_u32 s90, s90, s56
    s_or_b32 s90, s90, s100
    s_cmp_eq_u32 s3, 1
    s_cselect_b64 s[32:33], s[28:29], s[32:33]
    s_cselect_b32 s89, s89, 1073741824
    s_mov_b32 s70, 13631488
    s_cselect_b32 s70, 12582912, s70
    s_lshl_b32 s91, s101, 1
    s_add_u32 s91, s91, s82
    s_lshl_b32 s91, s91, 11
    s_add_u32 s91, s91, s70
    s_or_b32 s91, s91, s100
    s_lshl_b32 s101, s101, 2
    s_add_u32 s101, s101, s44
    s_cmp_lt_u32 s101, 480
    s_cselect_b64 s[24:25], s[36:37], s[40:41]
    s_movk_i32 s85, 1280
    s_cselect_b32 s85, 3072, s85
    s_cselect_b32 s70, 0, 480
    s_cselect_b32 s87, 0, 1073741824
    s_mov_b32 s26, 1966080
    s_cmp_lt_u32 s101, 480
    s_mov_b32 s86, 16777216
    s_cselect_b32 s86, 14680064, s86
    s_mov_b32 s56, 0x1999A
    s_cselect_b32 s56, 0xAAAB, s56
    s_cselect_b32 s100, 24, 10
    s_sub_u32 s101, s101, s70
    buffer_load_dwordx4 v217, s[4:7], s68 offen offset:1024  lds
    s_mul_i32 s70, s101, s56
    s_lshr_b32 s70, s70, 20
    s_mul_i32 s56, s70, s100
    s_sub_u32 s56, s101, s56
    s_lshl_b32 s101, s101, 12
    s_add_u32 s86, s86, s101
    s_mul_i32 s84, s70, s85
    s_lshl_b32 s84, s84, 5
    s_lshl_b32 s101, s56, 7
    s_add_u32 s84, s84, s101
    s_lshl_b32 s101, s56, 9
    s_add_u32 s101, s101, 20480
    s_or_b32 s87, s87, s101
    v_lshrrev_b32 v48, 3, v0
    v_and_b32 v49, 7, v0
    v_lshlrev_b32 v49, 4, v49
    v_mad_u32_u24 v232, v48, s85, v49
    s_movk_i32 s101, 1280
    v_mad_u32_u24 v233, v48, s101, v49
    s_lshl_b32 s85, s85, 3
    buffer_load_dwordx4 v218, s[4:7], s68 offen offset:2048  lds
    s_lshl_b32 s100, s44, 12
    s_add_u32 s100, s100, 131072
    v_lshrrev_b32 v48, 2, v0
    v_lshlrev_b32 v48, 7, v48
    v_and_b32 v49, 3, v0
    v_lshl_add_u32 v48, v49, 3, v48
    v_add_u32 v234, s100, v48
    s_lshl_b32 s101, s3, 12
    s_lshl_b32 s70, s82, 6
    s_add_u32 s101, s101, s70
    s_add_u32 s101, s101, 147456
    v_add_u32 v250, s101, v48
    s_lshl_b32 s97, s44, 11
    s_add_u32 s97, s97, 147456
    v_add_u32 v50, 0, v0
    s_mov_b32 s71, 0xCCCD
    v_mul_u32_u24 v51, s71, v50
    v_lshrrev_b32 v51, 19, v51
    s_movk_i32 s71, 1120
    v_mul_u32_u24 v51, s71, v51
    v_lshl_add_u32 v251, v50, 4, v51
    v_add_u32_e64 v50, 64, v0
    buffer_load_dwordx4 v219, s[4:7], s68 offen offset:3072  lds
    s_mov_b32 s71, 0xCCCD
    v_mul_u32_u24 v51, s71, v50
    v_lshrrev_b32 v51, 19, v51
    s_movk_i32 s71, 1120
    v_mul_u32_u24 v51, s71, v51
    v_lshl_add_u32 v252, v50, 4, v51
    v_add_u32 v50, 128, v0
    s_mov_b32 s71, 0xCCCD
    v_mul_u32_u24 v51, s71, v50
    v_lshrrev_b32 v51, 19, v51
    s_movk_i32 s71, 1120
    v_mul_u32_u24 v51, s71, v51
    v_lshl_add_u32 v253, v50, 4, v51
    v_mov_b32 v50, 1073741824
    v_cmp_gt_u32 vcc, 32, v0
    s_nop 1
    v_cndmask_b32 v253, v50, v253, vcc
    s_movk_i32 s101, 160
    v_mul_u32_u24 v254, s101, v2
    v_lshl_add_u32 v254, v1, 3, v254
    v_add_u32 v254, s100, v254
    v_add_u32 v237, 240, v2
    v_lshlrev_b32 v237, 5, v237
    s_lshl_b32 s101, s55, 4
    s_add_u32 s70, s101, 80
    s_sub_u32 s56, s101, 160
    s_cmp_lt_u32 s55, 10
    s_cselect_b32 s88, s70, s56
    v_and_b32 v238, 3, v0
    v_lshlrev_b32 v238, 2, v238
    s_waitcnt vmcnt(8)
    s_barrier
    ds_read_b128 v[152:155], v224 offset:0
    ds_read_b64_tr_b16 v[184:185], v228 offset:0
    ds_read_b64_tr_b16 v[186:187], v228 offset:1024
    ds_read_b128 v[156:159], v224 offset:2048
    ds_read_b64_tr_b16 v[188:189], v229 offset:0
    ds_read_b64_tr_b16 v[190:191], v229 offset:1024
    ds_read_b128 v[160:163], v225 offset:0
    ds_read_b64_tr_b16 v[192:193], v230 offset:0
    ds_read_b64_tr_b16 v[194:195], v230 offset:1024
    ds_read_b128 v[164:167], v225 offset:2048
    ds_read_b64_tr_b16 v[196:197], v231 offset:0
    ds_read_b64_tr_b16 v[198:199], v231 offset:1024
    s_waitcnt lgkmcnt(0)
    v_mfma_f32_16x16x32_bf16 v[64:67], v[184:187], v[152:155], 0
    ds_read_b128 v[168:171], v226 offset:0
    v_mfma_f32_16x16x32_bf16 v[80:83], v[184:187], v[156:159], 0
    ds_read_b64_tr_b16 v[200:201], v228 offset:8192
    s_bfe_u32 s67, s78, 0x40008
    s_add_u32 s67, s67, s62
    s_sub_u32 s69, s67, 10
    s_min_u32 s67, s67, s69
    s_add_u32 m0, s73, 114688
    s_mul_i32 s69, s67, 245760
    s_add_u32 s69, s69, s66
    buffer_load_dwordx4 v220, s[8:11], s69 offen offset:0  lds
    v_mfma_f32_16x16x32_bf16 v[96:99], v[184:187], v[160:163], 0
    ds_read_b64_tr_b16 v[202:203], v228 offset:9216
    v_mfma_f32_16x16x32_bf16 v[112:115], v[184:187], v[164:167], 0
    ds_read_b128 v[172:175], v226 offset:2048
    buffer_load_dwordx4 v221, s[8:11], s69 offen offset:1024  lds
    v_mfma_f32_16x16x32_bf16 v[68:71], v[188:191], v[152:155], 0
    ds_read_b64_tr_b16 v[204:205], v229 offset:8192
    v_mfma_f32_16x16x32_bf16 v[84:87], v[188:191], v[156:159], 0
    ds_read_b64_tr_b16 v[206:207], v229 offset:9216
    v_mfma_f32_16x16x32_bf16 v[100:103], v[188:191], v[160:163], 0
    ds_read_b128 v[176:179], v227 offset:0
    buffer_load_dwordx4 v222, s[8:11], s69 offen offset:2048  lds
    v_mfma_f32_16x16x32_bf16 v[116:119], v[188:191], v[164:167], 0
    ds_read_b64_tr_b16 v[208:209], v230 offset:8192
    v_mfma_f32_16x16x32_bf16 v[72:75], v[192:195], v[152:155], 0
    ds_read_b64_tr_b16 v[210:211], v230 offset:9216
    v_mfma_f32_16x16x32_bf16 v[88:91], v[192:195], v[156:159], 0
    ds_read_b128 v[180:183], v227 offset:2048
    buffer_load_dwordx4 v223, s[8:11], s69 offen offset:3072  lds
    v_mfma_f32_16x16x32_bf16 v[104:107], v[192:195], v[160:163], 0
    ds_read_b64_tr_b16 v[212:213], v231 offset:8192
    v_mfma_f32_16x16x32_bf16 v[120:123], v[192:195], v[164:167], 0
    ds_read_b64_tr_b16 v[214:215], v231 offset:9216
    v_mfma_f32_16x16x32_bf16 v[76:79], v[196:199], v[152:155], 0
    s_add_u32 m0, s73, 98304
    s_lshl_b32 s68, s67, 7
    s_add_u32 s68, s68, s83
    buffer_load_dwordx4 v216, s[4:7], s68 offen offset:0  lds
    v_mfma_f32_16x16x32_bf16 v[92:95], v[196:199], v[156:159], 0
    v_mfma_f32_16x16x32_bf16 v[108:111], v[196:199], v[160:163], 0
    buffer_load_dwordx4 v217, s[4:7], s68 offen offset:1024  lds
    v_mfma_f32_16x16x32_bf16 v[124:127], v[196:199], v[164:167], 0
    v_mfma_f32_16x16x32_bf16 v[128:131], v[184:187], v[42:45], 0
    v_mfma_f32_16x16x32_bf16 v[136:139], v[42:45], v[152:155], 0
    buffer_load_dwordx4 v218, s[4:7], s68 offen offset:2048  lds
    v_mfma_f32_16x16x32_bf16 v[144:147], v[152:155], v[152:155], 0
    v_mfma_f32_16x16x32_bf16 v[132:135], v[188:191], v[42:45], 0
    v_mfma_f32_16x16x32_bf16 v[140:143], v[42:45], v[156:159], 0
    buffer_load_dwordx4 v219, s[4:7], s68 offen offset:3072  lds
    v_mfma_f32_16x16x32_bf16 v[148:151], v[156:159], v[156:159], 0
    s_waitcnt vmcnt(8) lgkmcnt(0)
    s_barrier
    v_mfma_f32_16x16x32_bf16 v[64:67], v[200:203], v[168:171], v[64:67]
    ds_read_b128 v[152:155], v224 offset:32768
    v_mfma_f32_16x16x32_bf16 v[80:83], v[200:203], v[172:175], v[80:83]
    ds_read_b64_tr_b16 v[184:185], v228 offset:32768
    s_bfe_u32 s67, s78, 0x4000c
    s_add_u32 s67, s67, s62
    s_sub_u32 s69, s67, 10
    s_min_u32 s67, s67, s69
    s_add_u32 m0, s73, 81920
    s_mul_i32 s69, s67, 245760
    s_add_u32 s69, s69, s66
    buffer_load_dwordx4 v220, s[8:11], s69 offen offset:0  lds
    v_mfma_f32_16x16x32_bf16 v[96:99], v[200:203], v[176:179], v[96:99]
    ds_read_b64_tr_b16 v[186:187], v228 offset:33792
    v_mfma_f32_16x16x32_bf16 v[112:115], v[200:203], v[180:183], v[112:115]
    ds_read_b128 v[156:159], v224 offset:34816
    buffer_load_dwordx4 v221, s[8:11], s69 offen offset:1024  lds
    v_mfma_f32_16x16x32_bf16 v[68:71], v[204:207], v[168:171], v[68:71]
    ds_read_b64_tr_b16 v[188:189], v229 offset:32768
    v_mfma_f32_16x16x32_bf16 v[84:87], v[204:207], v[172:175], v[84:87]
    ds_read_b64_tr_b16 v[190:191], v229 offset:33792
    v_mfma_f32_16x16x32_bf16 v[100:103], v[204:207], v[176:179], v[100:103]
    ds_read_b128 v[160:163], v225 offset:32768
    buffer_load_dwordx4 v222, s[8:11], s69 offen offset:2048  lds
    v_mfma_f32_16x16x32_bf16 v[116:119], v[204:207], v[180:183], v[116:119]
    ds_read_b64_tr_b16 v[192:193], v230 offset:32768
    v_mfma_f32_16x16x32_bf16 v[72:75], v[208:211], v[168:171], v[72:75]
    ds_read_b64_tr_b16 v[194:195], v230 offset:33792
    v_mfma_f32_16x16x32_bf16 v[88:91], v[208:211], v[172:175], v[88:91]
    ds_read_b128 v[164:167], v225 offset:34816
    buffer_load_dwordx4 v223, s[8:11], s69 offen offset:3072  lds
    v_mfma_f32_16x16x32_bf16 v[104:107], v[208:211], v[176:179], v[104:107]
    ds_read_b64_tr_b16 v[196:197], v231 offset:32768
    v_mfma_f32_16x16x32_bf16 v[120:123], v[208:211], v[180:183], v[120:123]
    ds_read_b64_tr_b16 v[198:199], v231 offset:33792
    v_mfma_f32_16x16x32_bf16 v[76:79], v[212:215], v[168:171], v[76:79]
    s_add_u32 m0, s73, 65536
    s_lshl_b32 s68, s67, 7
    s_add_u32 s68, s68, s83
    buffer_load_dwordx4 v216, s[4:7], s68 offen offset:0  lds
    v_mfma_f32_16x16x32_bf16 v[92:95], v[212:215], v[172:175], v[92:95]
    v_mfma_f32_16x16x32_bf16 v[108:111], v[212:215], v[176:179], v[108:111]
    buffer_load_dwordx4 v217, s[4:7], s68 offen offset:1024  lds
    v_mfma_f32_16x16x32_bf16 v[124:127], v[212:215], v[180:183], v[124:127]
    v_mfma_f32_16x16x32_bf16 v[128:131], v[200:203], v[42:45], v[128:131]
    v_mfma_f32_16x16x32_bf16 v[136:139], v[42:45], v[168:171], v[136:139]
    buffer_load_dwordx4 v218, s[4:7], s68 offen offset:2048  lds
    v_mfma_f32_16x16x32_bf16 v[144:147], v[168:171], v[168:171], v[144:147]
    v_mfma_f32_16x16x32_bf16 v[132:135], v[204:207], v[42:45], v[132:135]
    v_mfma_f32_16x16x32_bf16 v[140:143], v[42:45], v[172:175], v[140:143]
    buffer_load_dwordx4 v219, s[4:7], s68 offen offset:3072  lds
    v_mfma_f32_16x16x32_bf16 v[148:151], v[172:175], v[172:175], v[148:151]
    s_waitcnt lgkmcnt(0)
    v_mfma_f32_16x16x32_bf16 v[64:67], v[184:187], v[152:155], v[64:67]
    ds_read_b128 v[168:171], v226 offset:32768
    v_mfma_f32_16x16x32_bf16 v[80:83], v[184:187], v[156:159], v[80:83]
    ds_read_b64_tr_b16 v[200:201], v228 offset:40960
    s_bfe_u32 s67, s78, 0x40010
    s_add_u32 s67, s67, s62
    s_sub_u32 s69, s67, 10
    s_min_u32 s67, s67, s69
    s_add_u32 m0, s73, 16384
    s_mul_i32 s69, s67, 245760
    s_add_u32 s69, s69, s66
    buffer_load_dwordx4 v220, s[8:11], s69 offen offset:0  lds
    v_mfma_f32_16x16x32_bf16 v[96:99], v[184:187], v[160:163], v[96:99]
    ds_read_b64_tr_b16 v[202:203], v228 offset:41984
    v_mfma_f32_16x16x32_bf16 v[112:115], v[184:187], v[164:167], v[112:115]
    ds_read_b128 v[172:175], v226 offset:34816
    v_mfma_f32_16x16x32_bf16 v[68:71], v[188:191], v[152:155], v[68:71]
    ds_read_b64_tr_b16 v[204:205], v229 offset:40960
    buffer_load_dwordx4 v221, s[8:11], s69 offen offset:1024  lds
    v_mfma_f32_16x16x32_bf16 v[84:87], v[188:191], v[156:159], v[84:87]
    ds_read_b64_tr_b16 v[206:207], v229 offset:41984
    v_mfma_f32_16x16x32_bf16 v[100:103], v[188:191], v[160:163], v[100:103]
    ds_read_b128 v[176:179], v227 offset:32768
    v_mfma_f32_16x16x32_bf16 v[116:119], v[188:191], v[164:167], v[116:119]
    ds_read_b64_tr_b16 v[208:209], v230 offset:40960
    v_mfma_f32_16x16x32_bf16 v[72:75], v[192:195], v[152:155], v[72:75]
    ds_read_b64_tr_b16 v[210:211], v230 offset:41984
    buffer_load_dwordx4 v222, s[8:11], s69 offen offset:2048  lds
    v_mfma_f32_16x16x32_bf16 v[88:91], v[192:195], v[156:159], v[88:91]
    ds_read_b128 v[180:183], v227 offset:34816
    v_mfma_f32_16x16x32_bf16 v[104:107], v[192:195], v[160:163], v[104:107]
    ds_read_b64_tr_b16 v[212:213], v231 offset:40960
    v_mfma_f32_16x16x32_bf16 v[120:123], v[192:195], v[164:167], v[120:123]
    ds_read_b64_tr_b16 v[214:215], v231 offset:41984
    v_mfma_f32_16x16x32_bf16 v[76:79], v[196:199], v[152:155], v[76:79]
    buffer_load_dwordx4 v223, s[8:11], s69 offen offset:3072  lds
    v_mfma_f32_16x16x32_bf16 v[92:95], v[196:199], v[156:159], v[92:95]
    v_mfma_f32_16x16x32_bf16 v[108:111], v[196:199], v[160:163], v[108:111]
    v_mfma_f32_16x16x32_bf16 v[124:127], v[196:199], v[164:167], v[124:127]
    s_add_u32 m0, s100, 0
    s_nop 0
    buffer_load_dwordx4 v232, s[24:27], s84 offen nt lds
    s_add_u32 s84, s84, s85
    v_mfma_f32_16x16x32_bf16 v[128:131], v[184:187], v[42:45], v[128:131]
    v_mfma_f32_16x16x32_bf16 v[136:139], v[42:45], v[152:155], v[136:139]
    v_mfma_f32_16x16x32_bf16 v[144:147], v[152:155], v[152:155], v[144:147]
    v_mfma_f32_16x16x32_bf16 v[132:135], v[188:191], v[42:45], v[132:135]
    s_add_u32 m0, s97, 0
    s_nop 0
    buffer_load_dwordx4 v233, s[32:35], s90 offen nt lds
    s_add_u32 s90, s90, 10240
    v_mfma_f32_16x16x32_bf16 v[140:143], v[42:45], v[156:159], v[140:143]
    v_mfma_f32_16x16x32_bf16 v[148:151], v[156:159], v[156:159], v[148:151]
    s_waitcnt vmcnt(14) lgkmcnt(0)
    s_barrier
    v_mfma_f32_16x16x32_bf16 v[64:67], v[200:203], v[168:171], v[64:67]
    ds_read_b128 v[152:155], v240 offset:32768
    v_mfma_f32_16x16x32_bf16 v[80:83], v[200:203], v[172:175], v[80:83]
    ds_read_b64_tr_b16 v[184:185], v244 offset:32768
    buffer_load_dword v236, v238, s[20:23], 0 offen sc1
    v_mfma_f32_16x16x32_bf16 v[96:99], v[200:203], v[176:179], v[96:99]
    ds_read_b64_tr_b16 v[186:187], v244 offset:33792
    v_mfma_f32_16x16x32_bf16 v[112:115], v[200:203], v[180:183], v[112:115]
    ds_read_b128 v[156:159], v240 offset:34816
    v_mfma_f32_16x16x32_bf16 v[68:71], v[204:207], v[168:171], v[68:71]
    ds_read_b64_tr_b16 v[188:189], v245 offset:32768
    s_add_u32 m0, s73, 0
    s_lshl_b32 s68, s67, 7
    s_add_u32 s68, s68, s83
    buffer_load_dwordx4 v216, s[4:7], s68 offen offset:0  lds
    v_mfma_f32_16x16x32_bf16 v[84:87], v[204:207], v[172:175], v[84:87]
    ds_read_b64_tr_b16 v[190:191], v245 offset:33792
    v_mfma_f32_16x16x32_bf16 v[100:103], v[204:207], v[176:179], v[100:103]
    ds_read_b128 v[160:163], v241 offset:32768
    v_mfma_f32_16x16x32_bf16 v[116:119], v[204:207], v[180:183], v[116:119]
    ds_read_b64_tr_b16 v[192:193], v246 offset:32768
    v_mfma_f32_16x16x32_bf16 v[72:75], v[208:211], v[168:171], v[72:75]
    ds_read_b64_tr_b16 v[194:195], v246 offset:33792
    buffer_load_dwordx4 v217, s[4:7], s68 offen offset:1024  lds
    v_mfma_f32_16x16x32_bf16 v[88:91], v[208:211], v[172:175], v[88:91]
    ds_read_b128 v[164:167], v241 offset:34816
    v_mfma_f32_16x16x32_bf16 v[104:107], v[208:211], v[176:179], v[104:107]
    ds_read_b64_tr_b16 v[196:197], v247 offset:32768
    v_mfma_f32_16x16x32_bf16 v[120:123], v[208:211], v[180:183], v[120:123]
    ds_read_b64_tr_b16 v[198:199], v247 offset:33792
    v_mfma_f32_16x16x32_bf16 v[76:79], v[212:215], v[168:171], v[76:79]
    buffer_load_dwordx4 v218, s[4:7], s68 offen offset:2048  lds
    v_mfma_f32_16x16x32_bf16 v[92:95], v[212:215], v[172:175], v[92:95]
    v_mfma_f32_16x16x32_bf16 v[108:111], v[212:215], v[176:179], v[108:111]
    v_mfma_f32_16x16x32_bf16 v[124:127], v[212:215], v[180:183], v[124:127]
    buffer_load_dwordx4 v219, s[4:7], s68 offen offset:3072  lds
    v_mfma_f32_16x16x32_bf16 v[128:131], v[200:203], v[42:45], v[128:131]
    v_mfma_f32_16x16x32_bf16 v[136:139], v[42:45], v[168:171], v[136:139]
    v_mfma_f32_16x16x32_bf16 v[144:147], v[168:171], v[168:171], v[144:147]
    v_mfma_f32_16x16x32_bf16 v[132:135], v[204:207], v[42:45], v[132:135]
    s_add_u32 m0, s100, 1024
    s_nop 0
    buffer_load_dwordx4 v232, s[24:27], s84 offen nt lds
    s_add_u32 s84, s84, s85
    v_mfma_f32_16x16x32_bf16 v[140:143], v[42:45], v[172:175], v[140:143]
    v_mfma_f32_16x16x32_bf16 v[148:151], v[172:175], v[172:175], v[148:151]
    s_waitcnt lgkmcnt(0)
    v_mfma_f32_16x16x32_bf16 v[64:67], v[184:187], v[152:155], v[64:67]
    ds_read_b128 v[168:171], v242 offset:32768
    v_mfma_f32_16x16x32_bf16 v[80:83], v[184:187], v[156:159], v[80:83]
    ds_read_b64_tr_b16 v[200:201], v244 offset:40960
    s_bfe_u32 s67, s78, 0x40014
    s_add_u32 s67, s67, s62
    s_sub_u32 s69, s67, 10
    s_min_u32 s67, s67, s69
    s_add_u32 m0, s73, 49152
    s_mul_i32 s69, s67, 245760
    s_add_u32 s69, s69, s66
    buffer_load_dwordx4 v220, s[8:11], s69 offen offset:0  lds
    v_mfma_f32_16x16x32_bf16 v[96:99], v[184:187], v[160:163], v[96:99]
    ds_read_b64_tr_b16 v[202:203], v244 offset:41984
    v_mfma_f32_16x16x32_bf16 v[112:115], v[184:187], v[164:167], v[112:115]
    ds_read_b128 v[172:175], v242 offset:34816
    v_mfma_f32_16x16x32_bf16 v[68:71], v[188:191], v[152:155], v[68:71]
    ds_read_b64_tr_b16 v[204:205], v245 offset:40960
    buffer_load_dwordx4 v221, s[8:11], s69 offen offset:1024  lds
    v_mfma_f32_16x16x32_bf16 v[84:87], v[188:191], v[156:159], v[84:87]
    ds_read_b64_tr_b16 v[206:207], v245 offset:41984
    v_mfma_f32_16x16x32_bf16 v[100:103], v[188:191], v[160:163], v[100:103]
    ds_read_b128 v[176:179], v243 offset:32768
    v_mfma_f32_16x16x32_bf16 v[116:119], v[188:191], v[164:167], v[116:119]
    ds_read_b64_tr_b16 v[208:209], v246 offset:40960
    v_mfma_f32_16x16x32_bf16 v[72:75], v[192:195], v[152:155], v[72:75]
    ds_read_b64_tr_b16 v[210:211], v246 offset:41984
    buffer_load_dwordx4 v222, s[8:11], s69 offen offset:2048  lds
    v_mfma_f32_16x16x32_bf16 v[88:91], v[192:195], v[156:159], v[88:91]
    ds_read_b128 v[180:183], v243 offset:34816
    v_mfma_f32_16x16x32_bf16 v[104:107], v[192:195], v[160:163], v[104:107]
    ds_read_b64_tr_b16 v[212:213], v247 offset:40960
    v_mfma_f32_16x16x32_bf16 v[120:123], v[192:195], v[164:167], v[120:123]
    ds_read_b64_tr_b16 v[214:215], v247 offset:41984
    v_mfma_f32_16x16x32_bf16 v[76:79], v[196:199], v[152:155], v[76:79]
    buffer_load_dwordx4 v223, s[8:11], s69 offen offset:3072  lds
    v_mfma_f32_16x16x32_bf16 v[92:95], v[196:199], v[156:159], v[92:95]
    v_mfma_f32_16x16x32_bf16 v[108:111], v[196:199], v[160:163], v[108:111]
    v_mfma_f32_16x16x32_bf16 v[124:127], v[196:199], v[164:167], v[124:127]
    s_add_u32 m0, s100, 2048
    s_nop 0
    buffer_load_dwordx4 v232, s[24:27], s84 offen nt lds
    s_add_u32 s84, s84, s85
    v_mfma_f32_16x16x32_bf16 v[128:131], v[184:187], v[42:45], v[128:131]
    v_mfma_f32_16x16x32_bf16 v[136:139], v[42:45], v[152:155], v[136:139]
    v_mfma_f32_16x16x32_bf16 v[144:147], v[152:155], v[152:155], v[144:147]
    v_mfma_f32_16x16x32_bf16 v[132:135], v[188:191], v[42:45], v[132:135]
    s_add_u32 m0, s97, 1024
    s_nop 0
    buffer_load_dwordx4 v233, s[32:35], s90 offen nt lds
    s_add_u32 s90, s90, 10240
    v_mfma_f32_16x16x32_bf16 v[140:143], v[42:45], v[156:159], v[140:143]
    v_mfma_f32_16x16x32_bf16 v[148:151], v[156:159], v[156:159], v[148:151]
    s_waitcnt vmcnt(18) lgkmcnt(0)
    s_barrier
    v_mfma_f32_16x16x32_bf16 v[64:67], v[200:203], v[168:171], v[64:67]
    ds_read_b128 v[152:155], v240 offset:0
    v_mfma_f32_16x16x32_bf16 v[80:83], v[200:203], v[172:175], v[80:83]
    ds_read_b64_tr_b16 v[184:185], v244 offset:0
    s_add_u32 m0, s73, 32768
    s_lshl_b32 s68, s67, 7
    s_add_u32 s68, s68, s83
    buffer_load_dwordx4 v216, s[4:7], s68 offen offset:0  lds
    v_mfma_f32_16x16x32_bf16 v[96:99], v[200:203], v[176:179], v[96:99]
    ds_read_b64_tr_b16 v[186:187], v244 offset:1024
    v_mfma_f32_16x16x32_bf16 v[112:115], v[200:203], v[180:183], v[112:115]
    ds_read_b128 v[156:159], v240 offset:2048
    v_mfma_f32_16x16x32_bf16 v[68:71], v[204:207], v[168:171], v[68:71]
    ds_read_b64_tr_b16 v[188:189], v245 offset:0
    v_mfma_f32_16x16x32_bf16 v[84:87], v[204:207], v[172:175], v[84:87]
    ds_read_b64_tr_b16 v[190:191], v245 offset:1024
    buffer_load_dwordx4 v217, s[4:7], s68 offen offset:1024  lds
    v_mfma_f32_16x16x32_bf16 v[100:103], v[204:207], v[176:179], v[100:103]
    ds_read_b128 v[160:163], v241 offset:0
    v_mfma_f32_16x16x32_bf16 v[116:119], v[204:207], v[180:183], v[116:119]
    ds_read_b64_tr_b16 v[192:193], v246 offset:0
    v_mfma_f32_16x16x32_bf16 v[72:75], v[208:211], v[168:171], v[72:75]
    ds_read_b64_tr_b16 v[194:195], v246 offset:1024
    v_mfma_f32_16x16x32_bf16 v[88:91], v[208:211], v[172:175], v[88:91]
    ds_read_b128 v[164:167], v241 offset:2048
    buffer_load_dwordx4 v218, s[4:7], s68 offen offset:2048  lds
    v_mfma_f32_16x16x32_bf16 v[104:107], v[208:211], v[176:179], v[104:107]
    ds_read_b64_tr_b16 v[196:197], v247 offset:0
    v_mfma_f32_16x16x32_bf16 v[120:123], v[208:211], v[180:183], v[120:123]
    ds_read_b64_tr_b16 v[198:199], v247 offset:1024
    v_mfma_f32_16x16x32_bf16 v[76:79], v[212:215], v[168:171], v[76:79]
    v_mfma_f32_16x16x32_bf16 v[92:95], v[212:215], v[172:175], v[92:95]
    v_mfma_f32_16x16x32_bf16 v[108:111], v[212:215], v[176:179], v[108:111]
    buffer_load_dwordx4 v219, s[4:7], s68 offen offset:3072  lds
    v_mfma_f32_16x16x32_bf16 v[124:127], v[212:215], v[180:183], v[124:127]
    v_mfma_f32_16x16x32_bf16 v[128:131], v[200:203], v[42:45], v[128:131]
    v_mfma_f32_16x16x32_bf16 v[136:139], v[42:45], v[168:171], v[136:139]
    v_mfma_f32_16x16x32_bf16 v[144:147], v[168:171], v[168:171], v[144:147]
    s_add_u32 m0, s100, 3072
    s_nop 0
    buffer_load_dwordx4 v232, s[24:27], s84 offen nt lds
    s_add_u32 s84, s84, s85
    v_mfma_f32_16x16x32_bf16 v[132:135], v[204:207], v[42:45], v[132:135]
    v_mfma_f32_16x16x32_bf16 v[140:143], v[42:45], v[172:175], v[140:143]
    v_mfma_f32_16x16x32_bf16 v[148:151], v[172:175], v[172:175], v[148:151]
    s_waitcnt lgkmcnt(0)
    v_mfma_f32_16x16x32_bf16 v[64:67], v[184:187], v[152:155], v[64:67]
    ds_read_b128 v[168:171], v242 offset:0
    v_mfma_f32_16x16x32_bf16 v[80:83], v[184:187], v[156:159], v[80:83]
    ds_read_b64_tr_b16 v[200:201], v244 offset:8192
    s_bfe_u32 s67, s78, 0x40018
    s_add_u32 s67, s67, s62
    s_sub_u32 s69, s67, 10
    s_min_u32 s67, s67, s69
    s_add_u32 m0, s73, 114688
    s_mul_i32 s69, s67, 245760
    s_add_u32 s69, s69, s66
    buffer_load_dwordx4 v220, s[8:11], s69 offen offset:0  lds
    v_mfma_f32_16x16x32_bf16 v[96:99], v[184:187], v[160:163], v[96:99]
    ds_read_b64_tr_b16 v[202:203], v244 offset:9216
    v_mfma_f32_16x16x32_bf16 v[112:115], v[184:187], v[164:167], v[112:115]
    ds_read_b128 v[172:175], v242 offset:2048
    v_mfma_f32_16x16x32_bf16 v[68:71], v[188:191], v[152:155], v[68:71]
    ds_read_b64_tr_b16 v[204:205], v245 offset:8192
    v_mfma_f32_16x16x32_bf16 v[84:87], v[188:191], v[156:159], v[84:87]
    ds_read_b64_tr_b16 v[206:207], v245 offset:9216
    v_mfma_f32_16x16x32_bf16 v[100:103], v[188:191], v[160:163], v[100:103]
    ds_read_b128 v[176:179], v243 offset:0
    buffer_load_dwordx4 v221, s[8:11], s69 offen offset:1024  lds
    v_mfma_f32_16x16x32_bf16 v[116:119], v[188:191], v[164:167], v[116:119]
    ds_read_b64_tr_b16 v[208:209], v246 offset:8192
    v_mfma_f32_16x16x32_bf16 v[72:75], v[192:195], v[152:155], v[72:75]
    ds_read_b64_tr_b16 v[210:211], v246 offset:9216
    v_mfma_f32_16x16x32_bf16 v[88:91], v[192:195], v[156:159], v[88:91]
    ds_read_b128 v[180:183], v243 offset:2048
    v_mfma_f32_16x16x32_bf16 v[104:107], v[192:195], v[160:163], v[104:107]
    ds_read_b64_tr_b16 v[212:213], v247 offset:8192
    v_mfma_f32_16x16x32_bf16 v[120:123], v[192:195], v[164:167], v[120:123]
    ds_read_b64_tr_b16 v[214:215], v247 offset:9216
    v_mfma_f32_16x16x32_bf16 v[76:79], v[196:199], v[152:155], v[76:79]
    buffer_load_dwordx4 v222, s[8:11], s69 offen offset:2048  lds
    v_mfma_f32_16x16x32_bf16 v[92:95], v[196:199], v[156:159], v[92:95]
    v_mfma_f32_16x16x32_bf16 v[108:111], v[196:199], v[160:163], v[108:111]
    v_mfma_f32_16x16x32_bf16 v[124:127], v[196:199], v[164:167], v[124:127]
    v_mfma_f32_16x16x32_bf16 v[128:131], v[184:187], v[42:45], v[128:131]
    v_mfma_f32_16x16x32_bf16 v[136:139], v[42:45], v[152:155], v[136:139]
    buffer_load_dwordx4 v223, s[8:11], s69 offen offset:3072  lds
    v_mfma_f32_16x16x32_bf16 v[144:147], v[152:155], v[152:155], v[144:147]
    v_mfma_f32_16x16x32_bf16 v[132:135], v[188:191], v[42:45], v[132:135]
    v_mfma_f32_16x16x32_bf16 v[140:143], v[42:45], v[156:159], v[140:143]
    v_mfma_f32_16x16x32_bf16 v[148:151], v[156:159], v[156:159], v[148:151]
    s_waitcnt vmcnt(16) lgkmcnt(0)
    v_cmp_eq_u32 vcc, 0, v236
    s_cbranch_vccz L_ok_4
    s_mov_b32 s56, 0
L_sp_5:
    buffer_load_dword v236, v238, s[20:23], 0 offen sc1
    s_add_u32 s56, s56, 1
    s_waitcnt vmcnt(0)
    v_cmp_eq_u32 vcc, 0, v236
    s_cmp_gt_u32 s56, 200000
    s_cbranch_scc1 L_spo_6
    s_cbranch_vccnz L_sp_5
L_spo_6:
L_ok_4:
    s_barrier
    v_mfma_f32_16x16x32_bf16 v[64:67], v[200:203], v[168:171], v[64:67]
    ds_read_b128 v[152:155], v224 offset:0
    v_mfma_f32_16x16x32_bf16 v[80:83], v[200:203], v[172:175], v[80:83]
    ds_read_b64_tr_b16 v[184:185], v228 offset:0
    s_add_u32 m0, s73, 98304
    s_lshl_b32 s68, s67, 7
    s_add_u32 s68, s68, s83
    buffer_load_dwordx4 v216, s[4:7], s68 offen offset:0  lds
    v_mfma_f32_16x16x32_bf16 v[96:99], v[200:203], v[176:179], v[96:99]
    ds_read_b64_tr_b16 v[186:187], v228 offset:1024
    v_mfma_f32_16x16x32_bf16 v[112:115], v[200:203], v[180:183], v[112:115]
    ds_read_b128 v[156:159], v224 offset:2048
    v_mfma_f32_16x16x32_bf16 v[68:71], v[204:207], v[168:171], v[68:71]
    ds_read_b64_tr_b16 v[188:189], v229 offset:0
    v_mfma_f32_16x16x32_bf16 v[84:87], v[204:207], v[172:175], v[84:87]
    ds_read_b64_tr_b16 v[190:191], v229 offset:1024
    buffer_load_dwordx4 v217, s[4:7], s68 offen offset:1024  lds
    v_mfma_f32_16x16x32_bf16 v[100:103], v[204:207], v[176:179], v[100:103]
    ds_read_b128 v[160:163], v225 offset:0
    v_mfma_f32_16x16x32_bf16 v[116:119], v[204:207], v[180:183], v[116:119]
    ds_read_b64_tr_b16 v[192:193], v230 offset:0
    v_mfma_f32_16x16x32_bf16 v[72:75], v[208:211], v[168:171], v[72:75]
    ds_read_b64_tr_b16 v[194:195], v230 offset:1024
    v_mfma_f32_16x16x32_bf16 v[88:91], v[208:211], v[172:175], v[88:91]
    ds_read_b128 v[164:167], v225 offset:2048
    buffer_load_dwordx4 v218, s[4:7], s68 offen offset:2048  lds
    v_mfma_f32_16x16x32_bf16 v[104:107], v[208:211], v[176:179], v[104:107]
    ds_read_b64_tr_b16 v[196:197], v231 offset:0
    v_mfma_f32_16x16x32_bf16 v[120:123], v[208:211], v[180:183], v[120:123]
    ds_read_b64_tr_b16 v[198:199], v231 offset:1024
    v_mfma_f32_16x16x32_bf16 v[76:79], v[212:215], v[168:171], v[76:79]
    v_mfma_f32_16x16x32_bf16 v[92:95], v[212:215], v[172:175], v[92:95]
    v_mfma_f32_16x16x32_bf16 v[108:111], v[212:215], v[176:179], v[108:111]
    buffer_load_dwordx4 v219, s[4:7], s68 offen offset:3072  lds
    v_mfma_f32_16x16x32_bf16 v[124:127], v[212:215], v[180:183], v[124:127]
    v_mfma_f32_16x16x32_bf16 v[128:131], v[200:203], v[42:45], v[128:131]
    v_mfma_f32_16x16x32_bf16 v[136:139], v[42:45], v[168:171], v[136:139]
    v_mfma_f32_16x16x32_bf16 v[144:147], v[168:171], v[168:171], v[144:147]
    s_getreg_b32 s71, hwreg(HW_REG_XCC_ID)
    s_and_b32 s71, s71, 15
    s_or_b32 s71, s71, 0x80
    v_mov_b32 v48, s71
    s_lshl_b32 s71, s2, 5
    s_cmp_eq_u32 s44, 0
    s_cselect_b32 s71, s71, 1073741824
    v_mov_b32 v49, 0
    s_mov_b64 exec, 1
    buffer_store_dword v48, v49, s[12:15], s71 offen sc1
    s_mov_b64 exec, -1
    v_mfma_f32_16x16x32_bf16 v[132:135], v[204:207], v[42:45], v[132:135]
    v_mfma_f32_16x16x32_bf16 v[140:143], v[42:45], v[172:175], v[140:143]
    v_mfma_f32_16x16x32_bf16 v[148:151], v[172:175], v[172:175], v[148:151]
    s_waitcnt lgkmcnt(0)
    v_mfma_f32_16x16x32_bf16 v[64:67], v[184:187], v[152:155], v[64:67]
    ds_read_b128 v[168:171], v226 offset:0
    v_mfma_f32_16x16x32_bf16 v[80:83], v[184:187], v[156:159], v[80:83]
    ds_read_b64_tr_b16 v[200:201], v228 offset:8192
    s_bfe_u32 s67, s78, 0x4001c
    s_add_u32 s67, s67, s62
    s_sub_u32 s69, s67, 10
    s_min_u32 s67, s67, s69
    s_add_u32 m0, s73, 81920
    s_mul_i32 s69, s67, 245760
    s_add_u32 s69, s69, s66
    buffer_load_dwordx4 v220, s[8:11], s69 offen offset:0  lds
    v_mfma_f32_16x16x32_bf16 v[96:99], v[184:187], v[160:163], v[96:99]
    ds_read_b64_tr_b16 v[202:203], v228 offset:9216
    v_mfma_f32_16x16x32_bf16 v[112:115], v[184:187], v[164:167], v[112:115]
    ds_read_b128 v[172:175], v226 offset:2048
    v_mfma_f32_16x16x32_bf16 v[68:71], v[188:191], v[152:155], v[68:71]
    ds_read_b64_tr_b16 v[204:205], v229 offset:8192
    v_mfma_f32_16x16x32_bf16 v[84:87], v[188:191], v[156:159], v[84:87]
    ds_read_b64_tr_b16 v[206:207], v229 offset:9216
    v_mfma_f32_16x16x32_bf16 v[100:103], v[188:191], v[160:163], v[100:103]
    ds_read_b128 v[176:179], v227 offset:0
    buffer_load_dwordx4 v221, s[8:11], s69 offen offset:1024  lds
    v_mfma_f32_16x16x32_bf16 v[116:119], v[188:191], v[164:167], v[116:119]
    ds_read_b64_tr_b16 v[208:209], v230 offset:8192
    v_mfma_f32_16x16x32_bf16 v[72:75], v[192:195], v[152:155], v[72:75]
    ds_read_b64_tr_b16 v[210:211], v230 offset:9216
    v_mfma_f32_16x16x32_bf16 v[88:91], v[192:195], v[156:159], v[88:91]
    ds_read_b128 v[180:183], v227 offset:2048
    v_mfma_f32_16x16x32_bf16 v[104:107], v[192:195], v[160:163], v[104:107]
    ds_read_b64_tr_b16 v[212:213], v231 offset:8192
    v_mfma_f32_16x16x32_bf16 v[120:123], v[192:195], v[164:167], v[120:123]
    ds_read_b64_tr_b16 v[214:215], v231 offset:9216
    v_mfma_f32_16x16x32_bf16 v[76:79], v[196:199], v[152:155], v[76:79]
    buffer_load_dwordx4 v222, s[8:11], s69 offen offset:2048  lds
    v_mfma_f32_16x16x32_bf16 v[92:95], v[196:199], v[156:159], v[92:95]
    v_mfma_f32_16x16x32_bf16 v[108:111], v[196:199], v[160:163], v[108:111]
    v_mfma_f32_16x16x32_bf16 v[124:127], v[196:199], v[164:167], v[124:127]
    v_mfma_f32_16x16x32_bf16 v[128:131], v[184:187], v[42:45], v[128:131]
    v_mfma_f32_16x16x32_bf16 v[136:139], v[42:45], v[152:155], v[136:139]
    buffer_load_dwordx4 v223, s[8:11], s69 offen offset:3072  lds
    v_mfma_f32_16x16x32_bf16 v[144:147], v[152:155], v[152:155], v[144:147]
    v_mfma_f32_16x16x32_bf16 v[132:135], v[188:191], v[42:45], v[132:135]
    v_mfma_f32_16x16x32_bf16 v[140:143], v[42:45], v[156:159], v[140:143]
    v_mfma_f32_16x16x32_bf16 v[148:151], v[156:159], v[156:159], v[148:151]
    s_waitcnt vmcnt(14) lgkmcnt(0)
    s_waitcnt vmcnt(13)
    s_barrier
    v_mfma_f32_16x16x32_bf16 v[64:67], v[200:203], v[168:171], v[64:67]
    ds_read_b128 v[152:155], v224 offset:32768
    v_mfma_f32_16x16x32_bf16 v[80:83], v[200:203], v[172:175], v[80:83]
    ds_read_b64_tr_b16 v[184:185], v228 offset:32768
    s_add_u32 m0, s73, 65536
    s_lshl_b32 s68, s67, 7
    s_add_u32 s68, s68, s83
    buffer_load_dwordx4 v216, s[4:7], s68 offen offset:0  lds
    v_mfma_f32_16x16x32_bf16 v[96:99], v[200:203], v[176:179], v[96:99]
    ds_read_b64_tr_b16 v[186:187], v228 offset:33792
    buffer_load_dwordx4 v217, s[4:7], s68 offen offset:1024  lds
    v_mfma_f32_16x16x32_bf16 v[112:115], v[200:203], v[180:183], v[112:115]
    ds_read_b128 v[156:159], v224 offset:34816
    buffer_load_dwordx4 v218, s[4:7], s68 offen offset:2048  lds
    v_mfma_f32_16x16x32_bf16 v[68:71], v[204:207], v[168:171], v[68:71]
    ds_read_b64_tr_b16 v[188:189], v229 offset:32768
    v_mfma_f32_16x16x32_bf16 v[84:87], v[204:207], v[172:175], v[84:87]
    ds_read_b64_tr_b16 v[190:191], v229 offset:33792
    buffer_load_dwordx4 v219, s[4:7], s68 offen offset:3072  lds
    v_mfma_f32_16x16x32_bf16 v[100:103], v[204:207], v[176:179], v[100:103]
    ds_read_b128 v[160:163], v225 offset:32768
    ds_read_b64_tr_b16 a[0:1], v234 offset:0
    v_mfma_f32_16x16x32_bf16 v[116:119], v[204:207], v[180:183], v[116:119]
    ds_read_b64_tr_b16 v[192:193], v230 offset:32768
    ds_read_b64_tr_b16 a[2:3], v234 offset:2048
    v_mfma_f32_16x16x32_bf16 v[72:75], v[208:211], v[168:171], v[72:75]
    ds_read_b64_tr_b16 v[194:195], v230 offset:33792
    v_mfma_f32_16x16x32_bf16 v[88:91], v[208:211], v[172:175], v[88:91]
    ds_read_b128 v[164:167], v225 offset:34816
    ds_read_b64_tr_b16 a[4:5], v234 offset:32
    v_mfma_f32_16x16x32_bf16 v[104:107], v[208:211], v[176:179], v[104:107]
    ds_read_b64_tr_b16 v[196:197], v231 offset:32768
    ds_read_b64_tr_b16 a[6:7], v234 offset:2080
    v_mfma_f32_16x16x32_bf16 v[120:123], v[208:211], v[180:183], v[120:123]
    ds_read_b64_tr_b16 v[198:199], v231 offset:33792
    v_mfma_f32_16x16x32_bf16 v[76:79], v[212:215], v[168:171], v[76:79]
    ds_read_b64_tr_b16 a[8:9], v234 offset:64
    v_mfma_f32_16x16x32_bf16 v[92:95], v[212:215], v[172:175], v[92:95]
    ds_read_b64_tr_b16 a[10:11], v234 offset:2112
    v_mfma_f32_16x16x32_bf16 v[108:111], v[212:215], v[176:179], v[108:111]
    ds_read_b64_tr_b16 a[12:13], v234 offset:96
    v_mfma_f32_16x16x32_bf16 v[124:127], v[212:215], v[180:183], v[124:127]
    v_mfma_f32_16x16x32_bf16 v[128:131], v[200:203], v[42:45], v[128:131]
    ds_read_b64_tr_b16 a[14:15], v234 offset:2144
    v_mfma_f32_16x16x32_bf16 v[136:139], v[42:45], v[168:171], v[136:139]
    ds_read_b64_tr_b16 a[16:17], v250 offset:0
    v_mfma_f32_16x16x32_bf16 v[144:147], v[168:171], v[168:171], v[144:147]
    ds_read_b64_tr_b16 a[18:19], v250 offset:2048
    v_mfma_f32_16x16x32_bf16 v[132:135], v[204:207], v[42:45], v[132:135]
    v_mfma_f32_16x16x32_bf16 v[140:143], v[42:45], v[172:175], v[140:143]
    ds_read_b64_tr_b16 a[20:21], v250 offset:32
    v_mfma_f32_16x16x32_bf16 v[148:151], v[172:175], v[172:175], v[148:151]
    ds_read_b64_tr_b16 a[22:23], v250 offset:2080
    s_waitcnt lgkmcnt(0)
    v_mfma_f32_16x16x32_bf16 v[64:67], v[184:187], v[152:155], v[64:67]
    ds_read_b128 v[168:171], v226 offset:32768
    v_mfma_f32_16x16x32_bf16 v[80:83], v[184:187], v[156:159], v[80:83]
    ds_read_b64_tr_b16 v[200:201], v228 offset:40960
    v_mfma_f32_16x16x32_bf16 v[20:23], v[42:45], a[0:3], 0
    v_mfma_f32_16x16x32_bf16 v[24:27], v[42:45], a[4:7], 0
    v_mfma_f32_16x16x32_bf16 v[28:31], v[42:45], a[8:11], 0
    v_mfma_f32_16x16x32_bf16 v[32:35], v[42:45], a[12:15], 0
    v_mfma_f32_16x16x32_bf16 v[96:99], v[184:187], v[160:163], v[96:99]
    ds_read_b64_tr_b16 v[202:203], v228 offset:41984
    v_mfma_f32_16x16x32_bf16 v[112:115], v[184:187], v[164:167], v[112:115]
    ds_read_b128 v[172:175], v226 offset:34816
    s_bfe_u32 s67, s79, 0x40000
    s_add_u32 s67, s67, s62
    s_sub_u32 s69, s67, 10
    s_min_u32 s67, s67, s69
    s_add_u32 m0, s73, 16384
    s_mul_i32 s69, s67, 245760
    s_add_u32 s69, s69, s66
    buffer_load_dwordx4 v220, s[8:11], s69 offen offset:0  lds
    v_mfma_f32_16x16x32_bf16 v[68:71], v[188:191], v[152:155], v[68:71]
    ds_read_b64_tr_b16 v[204:205], v229 offset:40960
    v_mfma_f32_16x16x32_bf16 v[84:87], v[188:191], v[156:159], v[84:87]
    ds_read_b64_tr_b16 v[206:207], v229 offset:41984
    buffer_store_dwordx4 a[0:3], v6, s[12:15], s86 offen offset:0 sc1
    v_mfma_f32_16x16x32_bf16 v[100:103], v[188:191], v[160:163], v[100:103]
    ds_read_b128 v[176:179], v227 offset:32768
    v_mfma_f32_16x16x32_bf16 v[116:119], v[188:191], v[164:167], v[116:119]
    ds_read_b64_tr_b16 v[208:209], v230 offset:40960
    buffer_load_dwordx4 v221, s[8:11], s69 offen offset:1024  lds
    v_mfma_f32_16x16x32_bf16 v[72:75], v[192:195], v[152:155], v[72:75]
    ds_read_b64_tr_b16 v[210:211], v230 offset:41984
    v_mfma_f32_16x16x32_bf16 v[88:91], v[192:195], v[156:159], v[88:91]
    ds_read_b128 v[180:183], v227 offset:34816
    buffer_load_dwordx4 v222, s[8:11], s69 offen offset:2048  lds
    v_mfma_f32_16x16x32_bf16 v[104:107], v[192:195], v[160:163], v[104:107]
    ds_read_b64_tr_b16 v[212:213], v231 offset:40960
    v_mfma_f32_16x16x32_bf16 v[120:123], v[192:195], v[164:167], v[120:123]
    ds_read_b64_tr_b16 v[214:215], v231 offset:41984
    buffer_load_dwordx4 v223, s[8:11], s69 offen offset:3072  lds
    v_mfma_f32_16x16x32_bf16 v[76:79], v[196:199], v[152:155], v[76:79]
    v_mfma_f32_16x16x32_bf16 v[92:95], v[196:199], v[156:159], v[92:95]
    s_mov_b32 s80, 0xffff0000
    s_mov_b32 s81, 0x0
    v_cndmask_b32 v20, v20, v24, s[80:81]
    v_mfma_f32_16x16x32_bf16 v[108:111], v[196:199], v[160:163], v[108:111]
    v_mfma_f32_16x16x32_bf16 v[124:127], v[196:199], v[164:167], v[124:127]
    s_mov_b32 s80, 0x0
    s_mov_b32 s81, 0xffff
    v_cndmask_b32 v20, v20, v28, s[80:81]
    v_mfma_f32_16x16x32_bf16 v[128:131], v[184:187], v[42:45], v[128:131]
    v_mfma_f32_16x16x32_bf16 v[136:139], v[42:45], v[152:155], v[136:139]
    s_mov_b32 s80, 0x0
    s_mov_b32 s81, 0xffff0000
    v_cndmask_b32 v20, v20, v32, s[80:81]
    v_mfma_f32_16x16x32_bf16 v[144:147], v[152:155], v[152:155], v[144:147]
    v_mfma_f32_16x16x32_bf16 v[132:135], v[188:191], v[42:45], v[132:135]
    v_cvt_f64_f32 v[22:23], v20
    v_mfma_f32_16x16x32_bf16 v[140:143], v[42:45], v[156:159], v[140:143]
    v_mfma_f32_16x16x32_bf16 v[148:151], v[156:159], v[156:159], v[148:151]
    buffer_atomic_add_f64 v[22:23], v8, s[12:15], s87 offen
    s_waitcnt vmcnt(15) lgkmcnt(0)
    s_barrier
    v_mfma_f32_16x16x32_bf16 v[64:67], v[200:203], v[168:171], v[64:67]
    ds_read_b128 v[152:155], v240 offset:32768
    v_mfma_f32_16x16x32_bf16 v[80:83], v[200:203], v[172:175], v[80:83]
    ds_read_b64_tr_b16 v[184:185], v244 offset:32768
    v_mfma_f32_16x16x32_bf16 v[20:23], v[42:45], a[16:19], 0
    v_mfma_f32_16x16x32_bf16 v[24:27], v[42:45], a[20:23], 0
    v_mfma_f32_16x16x32_bf16 v[96:99], v[200:203], v[176:179], v[96:99]
    ds_read_b64_tr_b16 v[186:187], v244 offset:33792
    v_mfma_f32_16x16x32_bf16 v[112:115], v[200:203], v[180:183], v[112:115]
    ds_read_b128 v[156:159], v240 offset:34816
    s_add_u32 m0, s73, 0
    s_lshl_b32 s68, s67, 7
    s_add_u32 s68, s68, s83
    buffer_load_dwordx4 v216, s[4:7], s68 offen offset:0  lds
    v_mfma_f32_16x16x32_bf16 v[68:71], v[204:207], v[168:171], v[68:71]
    ds_read_b64_tr_b16 v[188:189], v245 offset:32768
    v_mfma_f32_16x16x32_bf16 v[84:87], v[204:207], v[172:175], v[84:87]
    ds_read_b64_tr_b16 v[190:191], v245 offset:33792
    buffer_store_dwordx4 a[4:7], v6, s[12:15], s86 offen offset:1024 sc1
    v_mfma_f32_16x16x32_bf16 v[100:103], v[204:207], v[176:179], v[100:103]
    ds_read_b128 v[160:163], v241 offset:32768
    v_mfma_f32_16x16x32_bf16 v[116:119], v[204:207], v[180:183], v[116:119]
    ds_read_b64_tr_b16 v[192:193], v246 offset:32768
    v_mfma_f32_16x16x32_bf16 v[72:75], v[208:211], v[168:171], v[72:75]
    ds_read_b64_tr_b16 v[194:195], v246 offset:33792
    buffer_load_dwordx4 v217, s[4:7], s68 offen offset:1024  lds
    v_mfma_f32_16x16x32_bf16 v[88:91], v[208:211], v[172:175], v[88:91]
    ds_read_b128 v[164:167], v241 offset:34816
    v_mfma_f32_16x16x32_bf16 v[104:107], v[208:211], v[176:179], v[104:107]
    ds_read_b64_tr_b16 v[196:197], v247 offset:32768
    buffer_load_dwordx4 v218, s[4:7], s68 offen offset:2048  lds
    v_mfma_f32_16x16x32_bf16 v[120:123], v[208:211], v[180:183], v[120:123]
    ds_read_b64_tr_b16 v[198:199], v247 offset:33792
    v_mfma_f32_16x16x32_bf16 v[76:79], v[212:215], v[168:171], v[76:79]
    v_mfma_f32_16x16x32_bf16 v[92:95], v[212:215], v[172:175], v[92:95]
    buffer_load_dwordx4 v219, s[4:7], s68 offen offset:3072  lds
    v_mfma_f32_16x16x32_bf16 v[108:111], v[212:215], v[176:179], v[108:111]
    v_mfma_f32_16x16x32_bf16 v[124:127], v[212:215], v[180:183], v[124:127]
    s_mov_b32 s80, 0xffff0000
    s_mov_b32 s81, 0x0
    v_cndmask_b32 v20, v20, v24, s[80:81]
    v_mfma_f32_16x16x32_bf16 v[128:131], v[200:203], v[42:45], v[128:131]
    v_mfma_f32_16x16x32_bf16 v[136:139], v[42:45], v[168:171], v[136:139]
    v_mfma_f32_16x16x32_bf16 v[144:147], v[168:171], v[168:171], v[144:147]
    v_cvt_f64_f32 v[22:23], v20
    v_mfma_f32_16x16x32_bf16 v[132:135], v[204:207], v[42:45], v[132:135]
    v_mfma_f32_16x16x32_bf16 v[140:143], v[42:45], v[172:175], v[140:143]
    s_mov_b32 exec_hi, 0
    buffer_atomic_add_f64 v[22:23], v8, s[12:15], s89 offen
    s_mov_b32 exec_hi, -1
    v_mfma_f32_16x16x32_bf16 v[148:151], v[172:175], v[172:175], v[148:151]
    s_waitcnt lgkmcnt(0)
    v_mfma_f32_16x16x32_bf16 v[64:67], v[184:187], v[152:155], v[64:67]
    ds_read_b128 v[168:171], v242 offset:32768
    v_mfma_f32_16x16x32_bf16 v[80:83], v[184:187], v[156:159], v[80:83]
    ds_read_b64_tr_b16 v[200:201], v244 offset:40960
    s_bfe_u32 s67, s79, 0x40004
    s_add_u32 s67, s67, s62
    s_sub_u32 s69, s67, 10
    s_min_u32 s67, s67, s69
    s_add_u32 m0, s73, 49152
    s_mul_i32 s69, s67, 245760
    s_add_u32 s69, s69, s66
    buffer_load_dwordx4 v220, s[8:11], s69 offen offset:0  lds
    v_mfma_f32_16x16x32_bf16 v[96:99], v[184:187], v[160:163], v[96:99]
    ds_read_b64_tr_b16 v[202:203], v244 offset:41984
    v_mfma_f32_16x16x32_bf16 v[112:115], v[184:187], v[164:167], v[112:115]
    ds_read_b128 v[172:175], v242 offset:34816
    v_mfma_f32_16x16x32_bf16 v[68:71], v[188:191], v[152:155], v[68:71]
    ds_read_b64_tr_b16 v[204:205], v245 offset:40960
    v_mfma_f32_16x16x32_bf16 v[84:87], v[188:191], v[156:159], v[84:87]
    ds_read_b64_tr_b16 v[206:207], v245 offset:41984
    buffer_store_dwordx4 a[8:11], v6, s[12:15], s86 offen offset:2048 sc1
    v_mfma_f32_16x16x32_bf16 v[100:103], v[188:191], v[160:163], v[100:103]
    ds_read_b128 v[176:179], v243 offset:32768
    v_mfma_f32_16x16x32_bf16 v[116:119], v[188:191], v[164:167], v[116:119]
    ds_read_b64_tr_b16 v[208:209], v246 offset:40960
    v_mfma_f32_16x16x32_bf16 v[72:75], v[192:195], v[152:155], v[72:75]
    ds_read_b64_tr_b16 v[210:211], v246 offset:41984
    v_mfma_f32_16x16x32_bf16 v[88:91], v[192:195], v[156:159], v[88:91]
    ds_read_b128 v[180:183], v243 offset:34816
    buffer_load_dwordx4 v221, s[8:11], s69 offen offset:1024  lds
    v_mfma_f32_16x16x32_bf16 v[104:107], v[192:195], v[160:163], v[104:107]
    ds_read_b64_tr_b16 v[212:213], v247 offset:40960
    v_mfma_f32_16x16x32_bf16 v[120:123], v[192:195], v[164:167], v[120:123]
    ds_read_b64_tr_b16 v[214:215], v247 offset:41984
    v_mfma_f32_16x16x32_bf16 v[76:79], v[196:199], v[152:155], v[76:79]
    v_mfma_f32_16x16x32_bf16 v[92:95], v[196:199], v[156:159], v[92:95]
    v_mfma_f32_16x16x32_bf16 v[108:111], v[196:199], v[160:163], v[108:111]
    buffer_load_dwordx4 v222, s[8:11], s69 offen offset:2048  lds
    v_mfma_f32_16x16x32_bf16 v[124:127], v[196:199], v[164:167], v[124:127]
    v_mfma_f32_16x16x32_bf16 v[128:131], v[184:187], v[42:45], v[128:131]
    v_mfma_f32_16x16x32_bf16 v[136:139], v[42:45], v[152:155], v[136:139]
    v_mfma_f32_16x16x32_bf16 v[144:147], v[152:155], v[152:155], v[144:147]
    buffer_load_dwordx4 v223, s[8:11], s69 offen offset:3072  lds
    v_mfma_f32_16x16x32_bf16 v[132:135], v[188:191], v[42:45], v[132:135]
    v_mfma_f32_16x16x32_bf16 v[140:143], v[42:45], v[156:159], v[140:143]
    v_mfma_f32_16x16x32_bf16 v[148:151], v[156:159], v[156:159], v[148:151]
    s_waitcnt vmcnt(17) lgkmcnt(0)
    s_barrier
    v_mfma_f32_16x16x32_bf16 v[64:67], v[200:203], v[168:171], v[64:67]
    ds_read_b128 v[152:155], v240 offset:0
    v_mfma_f32_16x16x32_bf16 v[80:83], v[200:203], v[172:175], v[80:83]
    ds_read_b64_tr_b16 v[184:185], v244 offset:0
    buffer_load_dword v236, v237, s[12:15], 0 offen offset:16 sc1
    v_mfma_f32_16x16x32_bf16 v[96:99], v[200:203], v[176:179], v[96:99]
    ds_read_b64_tr_b16 v[186:187], v244 offset:1024
    v_mfma_f32_16x16x32_bf16 v[112:115], v[200:203], v[180:183], v[112:115]
    ds_read_b128 v[156:159], v240 offset:2048
    buffer_store_dwordx4 a[12:15], v6, s[12:15], s86 offen offset:3072 sc1
    v_mfma_f32_16x16x32_bf16 v[68:71], v[204:207], v[168:171], v[68:71]
    ds_read_b64_tr_b16 v[188:189], v245 offset:0
    v_mfma_f32_16x16x32_bf16 v[84:87], v[204:207], v[172:175], v[84:87]
    ds_read_b64_tr_b16 v[190:191], v245 offset:1024
    v_mfma_f32_16x16x32_bf16 v[100:103], v[204:207], v[176:179], v[100:103]
    ds_read_b128 v[160:163], v241 offset:0
    s_mov_b32 exec_hi, 0
    buffer_load_dword v239, v4, s[12:15], 0 offen sc1
    s_mov_b32 exec_hi, -1
    v_mfma_f32_16x16x32_bf16 v[116:119], v[204:207], v[180:183], v[116:119]
    ds_read_b64_tr_b16 v[192:193], v246 offset:0
    v_mfma_f32_16x16x32_bf16 v[72:75], v[208:211], v[168:171], v[72:75]
    ds_read_b64_tr_b16 v[194:195], v246 offset:1024
    v_mfma_f32_16x16x32_bf16 v[88:91], v[208:211], v[172:175], v[88:91]
    ds_read_b128 v[164:167], v241 offset:2048
    buffer_load_dwordx2 v[62:63], v8, s[12:15], s53 offen sc1
    v_mfma_f32_16x16x32_bf16 v[104:107], v[208:211], v[176:179], v[104:107]
    ds_read_b64_tr_b16 v[196:197], v247 offset:0
    v_mfma_f32_16x16x32_bf16 v[120:123], v[208:211], v[180:183], v[120:123]
    ds_read_b64_tr_b16 v[198:199], v247 offset:1024
    v_mfma_f32_16x16x32_bf16 v[76:79], v[212:215], v[168:171], v[76:79]
    s_add_u32 m0, s73, 32768
    s_lshl_b32 s68, s67, 7
    s_add_u32 s68, s68, s83
    buffer_load_dwordx4 v216, s[4:7], s68 offen offset:0  lds
    v_mfma_f32_16x16x32_bf16 v[92:95], v[212:215], v[172:175], v[92:95]
    v_mfma_f32_16x16x32_bf16 v[108:111], v[212:215], v[176:179], v[108:111]
    buffer_load_dwordx4 v217, s[4:7], s68 offen offset:1024  lds
    v_mfma_f32_16x16x32_bf16 v[124:127], v[212:215], v[180:183], v[124:127]
    v_mfma_f32_16x16x32_bf16 v[128:131], v[200:203], v[42:45], v[128:131]
    v_mfma_f32_16x16x32_bf16 v[136:139], v[42:45], v[168:171], v[136:139]
    buffer_load_dwordx4 v218, s[4:7], s68 offen offset:2048  lds
    v_mfma_f32_16x16x32_bf16 v[144:147], v[168:171], v[168:171], v[144:147]
    v_mfma_f32_16x16x32_bf16 v[132:135], v[204:207], v[42:45], v[132:135]
    v_mfma_f32_16x16x32_bf16 v[140:143], v[42:45], v[172:175], v[140:143]
    buffer_load_dwordx4 v219, s[4:7], s68 offen offset:3072  lds
    v_mfma_f32_16x16x32_bf16 v[148:151], v[172:175], v[172:175], v[148:151]
    s_waitcnt lgkmcnt(0)
    v_mfma_f32_16x16x32_bf16 v[64:67], v[184:187], v[152:155], v[64:67]
    ds_read_b128 v[168:171], v242 offset:0
    v_mfma_f32_16x16x32_bf16 v[80:83], v[184:187], v[156:159], v[80:83]
    ds_read_b64_tr_b16 v[200:201], v244 offset:8192
    s_mul_i32 s72, s57, 20480
    s_mul_i32 s70, s48, 160
    s_add_u32 s72, s72, s70
    s_add_u32 m0, s100, 0
    s_nop 0
    buffer_load_dwordx4 v251, s[4:7], s72 offen lds
    v_mfma_f32_16x16x32_bf16 v[96:99], v[184:187], v[160:163], v[96:99]
    ds_read_b64_tr_b16 v[202:203], v244 offset:9216
    v_mfma_f32_16x16x32_bf16 v[112:115], v[184:187], v[164:167], v[112:115]
    ds_read_b128 v[172:175], v242 offset:2048
    v_mfma_f32_16x16x32_bf16 v[68:71], v[188:191], v[152:155], v[68:71]
    ds_read_b64_tr_b16 v[204:205], v245 offset:8192
    v_mfma_f32_16x16x32_bf16 v[84:87], v[188:191], v[156:159], v[84:87]
    ds_read_b64_tr_b16 v[206:207], v245 offset:9216
    buffer_store_dwordx4 a[16:19], v6, s[12:15], s91 offen offset:0 sc1
    v_mfma_f32_16x16x32_bf16 v[100:103], v[188:191], v[160:163], v[100:103]
    ds_read_b128 v[176:179], v243 offset:0
    v_mfma_f32_16x16x32_bf16 v[116:119], v[188:191], v[164:167], v[116:119]
    ds_read_b64_tr_b16 v[208:209], v246 offset:8192
    v_mfma_f32_16x16x32_bf16 v[72:75], v[192:195], v[152:155], v[72:75]
    ds_read_b64_tr_b16 v[210:211], v246 offset:9216
    v_mfma_f32_16x16x32_bf16 v[88:91], v[192:195], v[156:159], v[88:91]
    ds_read_b128 v[180:183], v243 offset:2048
    s_add_u32 m0, s100, 1024
    s_nop 0
    buffer_load_dwordx4 v252, s[4:7], s72 offen lds
    v_mfma_f32_16x16x32_bf16 v[104:107], v[192:195], v[160:163], v[104:107]
    ds_read_b64_tr_b16 v[212:213], v247 offset:8192
    v_mfma_f32_16x16x32_bf16 v[120:123], v[192:195], v[164:167], v[120:123]
    ds_read_b64_tr_b16 v[214:215], v247 offset:9216
    v_mfma_f32_16x16x32_bf16 v[76:79], v[196:199], v[152:155], v[76:79]
    v_mfma_f32_16x16x32_bf16 v[92:95], v[196:199], v[156:159], v[92:95]
    v_mfma_f32_16x16x32_bf16 v[108:111], v[196:199], v[160:163], v[108:111]
    s_add_u32 m0, s100, 2048
    s_nop 0
    buffer_load_dwordx4 v253, s[4:7], s72 offen lds
    v_mfma_f32_16x16x32_bf16 v[124:127], v[196:199], v[164:167], v[124:127]
    v_mfma_f32_16x16x32_bf16 v[128:131], v[184:187], v[42:45], v[128:131]
    v_mfma_f32_16x16x32_bf16 v[136:139], v[42:45], v[152:155], v[136:139]
    v_mfma_f32_16x16x32_bf16 v[144:147], v[152:155], v[152:155], v[144:147]
    s_lshl_b32 s68, s57, 10
    s_add_u32 s68, s68, 262144
    s_mov_b64 exec, 0x5555
    buffer_load_dword v5, v12, s[12:15], s68 offen sc1
    s_mov_b64 exec, -1
    v_mfma_f32_16x16x32_bf16 v[132:135], v[188:191], v[42:45], v[132:135]
    v_mfma_f32_16x16x32_bf16 v[140:143], v[42:45], v[156:159], v[140:143]
    v_mfma_f32_16x16x32_bf16 v[148:151], v[156:159], v[156:159], v[148:151]
    s_waitcnt vmcnt(19) lgkmcnt(0)
    s_waitcnt vmcnt(9)
    s_mov_b32 exec_hi, 0
    v_cmp_eq_u32 vcc, 0, v239
    s_cbranch_vccz L_gm_7
    s_mov_b32 s56, 0
L_sp_8:
    buffer_load_dword v239, v4, s[12:15], 0 offen sc1
    s_add_u32 s56, s56, 1
    s_waitcnt vmcnt(0)
    v_cmp_eq_u32 vcc, 0, v239
    s_cmp_gt_u32 s56, 200000
    s_cbranch_scc1 L_spo_9
    s_cbranch_vccnz L_sp_8
L_spo_9:
L_gm_7:
    s_getreg_b32 s71, hwreg(HW_REG_XCC_ID)
    s_and_b32 s71, s71, 15
    s_or_b32 s71, s71, 0x80
    v_cmp_ne_u32 vcc, s71, v239
    s_mov_b32 exec_hi, -1
    s_cmp_eq_u32 vcc_lo, 0
    s_cselect_b32 s51, 1, 0
    v_cmp_eq_u32 vcc, 0, v236
    s_cbranch_vccz L_ok_10
    s_mov_b32 s56, 0
L_sp_11:
    buffer_load_dword v236, v237, s[12:15], 0 offen offset:16 sc1
    s_add_u32 s56, s56, 1
    s_waitcnt vmcnt(0)
    v_cmp_eq_u32 vcc, 0, v236
    s_cmp_gt_u32 s56, 200000
    s_cbranch_scc1 L_spo_12
    s_cbranch_vccnz L_sp_11
L_spo_12:
L_ok_10:
    s_barrier
    v_mfma_f32_16x16x32_bf16 v[64:67], v[200:203], v[168:171], v[64:67]
    ds_read_b128 v[152:155], v224 offset:0
    v_mfma_f32_16x16x32_bf16 v[80:83], v[200:203], v[172:175], v[80:83]
    ds_read_b64_tr_b16 v[184:185], v228 offset:0
    s_add_u32 m0, s59, 81920
    s_add_u32 s67, s58, 11698176
    buffer_load_dwordx4 v6, s[12:15], s67 offen offset:0 sc1 lds
    v_mfma_f32_16x16x32_bf16 v[96:99], v[200:203], v[176:179], v[96:99]
    ds_read_b64_tr_b16 v[186:187], v228 offset:1024
    v_mfma_f32_16x16x32_bf16 v[112:115], v[200:203], v[180:183], v[112:115]
    ds_read_b128 v[156:159], v224 offset:2048
    v_mfma_f32_16x16x32_bf16 v[68:71], v[204:207], v[168:171], v[68:71]
    ds_read_b64_tr_b16 v[188:189], v229 offset:0
    buffer_store_dwordx4 a[20:23], v6, s[12:15], s91 offen offset:1024 sc1
    v_mfma_f32_16x16x32_bf16 v[84:87], v[204:207], v[172:175], v[84:87]
    ds_read_b64_tr_b16 v[190:191], v229 offset:1024
    v_mfma_f32_16x16x32_bf16 v[100:103], v[204:207], v[176:179], v[100:103]
    ds_read_b128 v[160:163], v225 offset:0
    v_mfma_f32_16x16x32_bf16 v[116:119], v[204:207], v[180:183], v[116:119]
    ds_read_b64_tr_b16 v[192:193], v230 offset:0
    v_mfma_f32_16x16x32_bf16 v[72:75], v[208:211], v[168:171], v[72:75]
    ds_read_b64_tr_b16 v[194:195], v230 offset:1024
    buffer_load_dwordx4 v6, s[12:15], s67 offen offset:1024 sc1 lds
    v_mfma_f32_16x16x32_bf16 v[88:91], v[208:211], v[172:175], v[88:91]
    ds_read_b128 v[164:167], v225 offset:2048
    v_mfma_f32_16x16x32_bf16 v[104:107], v[208:211], v[176:179], v[104:107]
    ds_read_b64_tr_b16 v[196:197], v231 offset:0
    v_mfma_f32_16x16x32_bf16 v[120:123], v[208:211], v[180:183], v[120:123]
    ds_read_b64_tr_b16 v[198:199], v231 offset:1024
    v_mfma_f32_16x16x32_bf16 v[76:79], v[212:215], v[168:171], v[76:79]
    buffer_load_dwordx4 v6, s[12:15], s67 offen offset:2048 sc1 lds
    v_mfma_f32_16x16x32_bf16 v[92:95], v[212:215], v[172:175], v[92:95]
    v_mfma_f32_16x16x32_bf16 v[108:111], v[212:215], v[176:179], v[108:111]
    v_mfma_f32_16x16x32_bf16 v[124:127], v[212:215], v[180:183], v[124:127]
    buffer_load_dwordx4 v6, s[12:15], s67 offen offset:3072 sc1 lds
    v_mfma_f32_16x16x32_bf16 v[128:131], v[200:203], v[42:45], v[128:131]
    v_mfma_f32_16x16x32_bf16 v[136:139], v[42:45], v[168:171], v[136:139]
    v_mfma_f32_16x16x32_bf16 v[144:147], v[168:171], v[168:171], v[144:147]
    v_mfma_f32_16x16x32_bf16 v[132:135], v[204:207], v[42:45], v[132:135]
    s_add_u32 m0, s59, 86016
    s_add_u32 s67, s58, 11702272
    buffer_load_dwordx4 v6, s[12:15], s67 offen offset:0 sc1 lds
    v_mfma_f32_16x16x32_bf16 v[140:143], v[42:45], v[172:175], v[140:143]
    v_mfma_f32_16x16x32_bf16 v[148:151], v[172:175], v[172:175], v[148:151]
    s_waitcnt vmcnt(7) lgkmcnt(0)
    v_mfma_f32_16x16x32_bf16 v[64:67], v[184:187], v[152:155], v[64:67]
    ds_read_b128 v[168:171], v226 offset:0
    v_mfma_f32_16x16x32_bf16 v[80:83], v[184:187], v[156:159], v[80:83]
    ds_read_b64_tr_b16 v[200:201], v228 offset:8192
    s_add_u32 m0, s59, 102400
    s_add_u32 s67, s58, 11862016
    buffer_load_dwordx4 v6, s[12:15], s67 offen offset:0 sc1 lds
    v_mfma_f32_16x16x32_bf16 v[96:99], v[184:187], v[160:163], v[96:99]
    ds_read_b64_tr_b16 v[202:203], v228 offset:9216
    v_mfma_f32_16x16x32_bf16 v[112:115], v[184:187], v[164:167], v[112:115]
    ds_read_b128 v[172:175], v226 offset:2048
    buffer_load_dwordx4 v6, s[12:15], s67 offen offset:1024 sc1 lds
    v_mfma_f32_16x16x32_bf16 v[68:71], v[188:191], v[152:155], v[68:71]
    ds_read_b64_tr_b16 v[204:205], v229 offset:8192
    v_mfma_f32_16x16x32_bf16 v[84:87], v[188:191], v[156:159], v[84:87]
    ds_read_b64_tr_b16 v[206:207], v229 offset:9216
    buffer_load_dwordx4 v6, s[12:15], s67 offen offset:2048 sc1 lds
    v_mfma_f32_16x16x32_bf16 v[100:103], v[188:191], v[160:163], v[100:103]
    ds_read_b128 v[176:179], v227 offset:0
    v_mfma_f32_16x16x32_bf16 v[116:119], v[188:191], v[164:167], v[116:119]
    ds_read_b64_tr_b16 v[208:209], v230 offset:8192
    buffer_load_dwordx4 v6, s[12:15], s67 offen offset:3072 sc1 lds
    v_mfma_f32_16x16x32_bf16 v[72:75], v[192:195], v[152:155], v[72:75]
    ds_read_b64_tr_b16 v[210:211], v230 offset:9216
    v_mfma_f32_16x16x32_bf16 v[88:91], v[192:195], v[156:159], v[88:91]
    ds_read_b128 v[180:183], v227 offset:2048
    s_add_u32 m0, s59, 106496
    s_add_u32 s67, s58, 11866112
    buffer_load_dwordx4 v6, s[12:15], s67 offen offset:0 sc1 lds
    v_mfma_f32_16x16x32_bf16 v[104:107], v[192:195], v[160:163], v[104:107]
    ds_read_b64_tr_b16 v[212:213], v231 offset:8192
    v_mfma_f32_16x16x32_bf16 v[120:123], v[192:195], v[164:167], v[120:123]
    ds_read_b64_tr_b16 v[214:215], v231 offset:9216
    v_mfma_f32_16x16x32_bf16 v[76:79], v[196:199], v[152:155], v[76:79]
    ds_read_b64 v[20:21], v254 offset:0
    v_mfma_f32_16x16x32_bf16 v[92:95], v[196:199], v[156:159], v[92:95]
    v_mfma_f32_16x16x32_bf16 v[108:111], v[196:199], v[160:163], v[108:111]
    ds_read_b64 v[22:23], v254 offset:32
    v_mfma_f32_16x16x32_bf16 v[124:127], v[196:199], v[164:167], v[124:127]
    v_mfma_f32_16x16x32_bf16 v[128:131], v[184:187], v[42:45], v[128:131]
    ds_read_b64 v[24:25], v254 offset:64
    v_mfma_f32_16x16x32_bf16 v[136:139], v[42:45], v[152:155], v[136:139]
    v_mfma_f32_16x16x32_bf16 v[144:147], v[152:155], v[152:155], v[144:147]
    ds_read_b64 v[26:27], v254 offset:96
    v_mfma_f32_16x16x32_bf16 v[132:135], v[188:191], v[42:45], v[132:135]
    v_mfma_f32_16x16x32_bf16 v[140:143], v[42:45], v[156:159], v[140:143]
    ds_read_b64 v[28:29], v254 offset:128
    v_mfma_f32_16x16x32_bf16 v[148:151], v[156:159], v[156:159], v[148:151]
    s_waitcnt lgkmcnt(0)
    s_barrier
    v_mfma_f32_16x16x32_bf16 v[64:67], v[200:203], v[168:171], v[64:67]
    ds_read_b128 v[152:155], v224 offset:32768
    v_mfma_f32_16x16x32_bf16 v[80:83], v[200:203], v[172:175], v[80:83]
    ds_read_b64_tr_b16 v[184:185], v228 offset:32768
    s_add_u32 m0, s59, 122880
    s_add_u32 s67, s58, 12025856
    buffer_load_dwordx4 v6, s[12:15], s67 offen offset:0 sc1 lds
    v_mfma_f32_16x16x32_bf16 v[96:99], v[200:203], v[176:179], v[96:99]
    ds_read_b64_tr_b16 v[186:187], v228 offset:33792
    v_mfma_f32_16x16x32_bf16 v[112:115], v[200:203], v[180:183], v[112:115]
    ds_read_b128 v[156:159], v224 offset:34816
    v_mfma_f32_16x16x32_bf16 v[68:71], v[204:207], v[168:171], v[68:71]
    ds_read_b64_tr_b16 v[188:189], v229 offset:32768
    v_mfma_f32_16x16x32_bf16 v[84:87], v[204:207], v[172:175], v[84:87]
    ds_read_b64_tr_b16 v[190:191], v229 offset:33792
    buffer_load_dwordx4 v6, s[12:15], s67 offen offset:1024 sc1 lds
    v_mfma_f32_16x16x32_bf16 v[100:103], v[204:207], v[176:179], v[100:103]
    ds_read_b128 v[160:163], v225 offset:32768
    v_mfma_f32_16x16x32_bf16 v[116:119], v[204:207], v[180:183], v[116:119]
    ds_read_b64_tr_b16 v[192:193], v230 offset:32768
    v_mfma_f32_16x16x32_bf16 v[72:75], v[208:211], v[168:171], v[72:75]
    ds_read_b64_tr_b16 v[194:195], v230 offset:33792
    v_mfma_f32_16x16x32_bf16 v[88:91], v[208:211], v[172:175], v[88:91]
    ds_read_b128 v[164:167], v225 offset:34816
    buffer_load_dwordx4 v6, s[12:15], s67 offen offset:2048 sc1 lds
    v_mfma_f32_16x16x32_bf16 v[104:107], v[208:211], v[176:179], v[104:107]
    ds_read_b64_tr_b16 v[196:197], v231 offset:32768
    v_mfma_f32_16x16x32_bf16 v[120:123], v[208:211], v[180:183], v[120:123]
    ds_read_b64_tr_b16 v[198:199], v231 offset:33792
    v_mfma_f32_16x16x32_bf16 v[76:79], v[212:215], v[168:171], v[76:79]
    v_mfma_f32_16x16x32_bf16 v[92:95], v[212:215], v[172:175], v[92:95]
    v_mfma_f32_16x16x32_bf16 v[108:111], v[212:215], v[176:179], v[108:111]
    buffer_load_dwordx4 v6, s[12:15], s67 offen offset:3072 sc1 lds
    v_mfma_f32_16x16x32_bf16 v[124:127], v[212:215], v[180:183], v[124:127]
    v_mfma_f32_16x16x32_bf16 v[128:131], v[200:203], v[42:45], v[128:131]
    v_mfma_f32_16x16x32_bf16 v[136:139], v[42:45], v[168:171], v[136:139]
    v_mfma_f32_16x16x32_bf16 v[144:147], v[168:171], v[168:171], v[144:147]
    s_add_u32 m0, s59, 126976
    s_add_u32 s67, s58, 12029952
    buffer_load_dwordx4 v6, s[12:15], s67 offen offset:0 sc1 lds
    v_mfma_f32_16x16x32_bf16 v[132:135], v[204:207], v[42:45], v[132:135]
    v_mfma_f32_16x16x32_bf16 v[140:143], v[42:45], v[172:175], v[140:143]
    v_mfma_f32_16x16x32_bf16 v[148:151], v[172:175], v[172:175], v[148:151]
    s_waitcnt lgkmcnt(0)
    v_mfma_f32_16x16x32_bf16 v[64:67], v[184:187], v[152:155], v[64:67]
    ds_read_b128 v[168:171], v226 offset:32768
    v_mfma_f32_16x16x32_bf16 v[80:83], v[184:187], v[156:159], v[80:83]
    ds_read_b64_tr_b16 v[200:201], v228 offset:40960
    s_add_u32 m0, s59, 143360
    s_add_u32 s67, s58, 12189696
    buffer_load_dwordx4 v6, s[12:15], s67 offen offset:0 sc1 lds
    v_mfma_f32_16x16x32_bf16 v[96:99], v[184:187], v[160:163], v[96:99]
    ds_read_b64_tr_b16 v[202:203], v228 offset:41984
    v_mfma_f32_16x16x32_bf16 v[112:115], v[184:187], v[164:167], v[112:115]
    ds_read_b128 v[172:175], v226 offset:34816
    v_mfma_f32_16x16x32_bf16 v[68:71], v[188:191], v[152:155], v[68:71]
    ds_read_b64_tr_b16 v[204:205], v229 offset:40960
    v_mfma_f32_16x16x32_bf16 v[84:87], v[188:191], v[156:159], v[84:87]
    ds_read_b64_tr_b16 v[206:207], v229 offset:41984
    buffer_load_dwordx4 v6, s[12:15], s67 offen offset:1024 sc1 lds
    v_mfma_f32_16x16x32_bf16 v[100:103], v[188:191], v[160:163], v[100:103]
    ds_read_b128 v[176:179], v227 offset:32768
    v_mfma_f32_16x16x32_bf16 v[116:119], v[188:191], v[164:167], v[116:119]
    ds_read_b64_tr_b16 v[208:209], v230 offset:40960
    v_mfma_f32_16x16x32_bf16 v[72:75], v[192:195], v[152:155], v[72:75]
    ds_read_b64_tr_b16 v[210:211], v230 offset:41984
    v_mfma_f32_16x16x32_bf16 v[88:91], v[192:195], v[156:159], v[88:91]
    ds_read_b128 v[180:183], v227 offset:34816
    buffer_load_dwordx4 v6, s[12:15], s67 offen offset:2048 sc1 lds
    v_mfma_f32_16x16x32_bf16 v[104:107], v[192:195], v[160:163], v[104:107]
    ds_read_b64_tr_b16 v[212:213], v231 offset:40960
    v_mfma_f32_16x16x32_bf16 v[120:123], v[192:195], v[164:167], v[120:123]
    ds_read_b64_tr_b16 v[214:215], v231 offset:41984
    v_mfma_f32_16x16x32_bf16 v[76:79], v[196:199], v[152:155], v[76:79]
    v_mfma_f32_16x16x32_bf16 v[92:95], v[196:199], v[156:159], v[92:95]
    v_mfma_f32_16x16x32_bf16 v[108:111], v[196:199], v[160:163], v[108:111]
    buffer_load_dwordx4 v6, s[12:15], s67 offen offset:3072 sc1 lds
    v_mfma_f32_16x16x32_bf16 v[124:127], v[196:199], v[164:167], v[124:127]
    v_mfma_f32_16x16x32_bf16 v[128:131], v[184:187], v[42:45], v[128:131]
    v_mfma_f32_16x16x32_bf16 v[136:139], v[42:45], v[152:155], v[136:139]
    v_mfma_f32_16x16x32_bf16 v[144:147], v[152:155], v[152:155], v[144:147]
    s_add_u32 m0, s59, 147456
    s_add_u32 s67, s58, 12193792
    buffer_load_dwordx4 v6, s[12:15], s67 offen offset:0 sc1 lds
    v_mfma_f32_16x16x32_bf16 v[132:135], v[188:191], v[42:45], v[132:135]
    v_mfma_f32_16x16x32_bf16 v[140:143], v[42:45], v[156:159], v[140:143]
    v_mfma_f32_16x16x32_bf16 v[148:151], v[156:159], v[156:159], v[148:151]
    s_waitcnt lgkmcnt(0)
    s_waitcnt vmcnt(19)
    v_mov_b32 v48, 1
    v_mov_b32 v49, 0
    s_mov_b64 exec, 1
    s_cmp_eq_u32 s51, 1
    s_cbranch_scc0 L_alt_13
    buffer_store_dword v48, v49, s[12:15], s52 offen
    s_branch L_altd_14
L_alt_13:
    buffer_store_dword v48, v49, s[12:15], s52 offen sc1
L_altd_14:
    s_mov_b64 exec, -1
    s_barrier
    v_mfma_f32_16x16x32_bf16 v[64:67], v[200:203], v[168:171], v[64:67]
    v_mfma_f32_16x16x32_bf16 v[80:83], v[200:203], v[172:175], v[80:83]
    s_add_u32 m0, s59, 61440
    s_add_u32 s67, s58, 11534336
    buffer_load_dwordx4 v6, s[12:15], s67 offen offset:0 sc1 lds
    v_mfma_f32_16x16x32_bf16 v[96:99], v[200:203], v[176:179], v[96:99]
    v_mfma_f32_16x16x32_bf16 v[112:115], v[200:203], v[180:183], v[112:115]
    v_mfma_f32_16x16x32_bf16 v[68:71], v[204:207], v[168:171], v[68:71]
    v_mfma_f32_16x16x32_bf16 v[84:87], v[204:207], v[172:175], v[84:87]
    buffer_load_dwordx4 v6, s[12:15], s67 offen offset:1024 sc1 lds
    v_mfma_f32_16x16x32_bf16 v[100:103], v[204:207], v[176:179], v[100:103]
    v_mfma_f32_16x16x32_bf16 v[116:119], v[204:207], v[180:183], v[116:119]
    v_mfma_f32_16x16x32_bf16 v[72:75], v[208:211], v[168:171], v[72:75]
    v_mfma_f32_16x16x32_bf16 v[88:91], v[208:211], v[172:175], v[88:91]
    buffer_load_dwordx4 v6, s[12:15], s67 offen offset:2048 sc1 lds
    v_mfma_f32_16x16x32_bf16 v[104:107], v[208:211], v[176:179], v[104:107]
    v_mfma_f32_16x16x32_bf16 v[120:123], v[208:211], v[180:183], v[120:123]
    v_mfma_f32_16x16x32_bf16 v[76:79], v[212:215], v[168:171], v[76:79]
    v_mfma_f32_16x16x32_bf16 v[92:95], v[212:215], v[172:175], v[92:95]
    v_mfma_f32_16x16x32_bf16 v[108:111], v[212:215], v[176:179], v[108:111]
    buffer_load_dwordx4 v6, s[12:15], s67 offen offset:3072 sc1 lds
    v_mfma_f32_16x16x32_bf16 v[124:127], v[212:215], v[180:183], v[124:127]
    v_mfma_f32_16x16x32_bf16 v[128:131], v[200:203], v[42:45], v[128:131]
    v_mfma_f32_16x16x32_bf16 v[136:139], v[42:45], v[168:171], v[136:139]
    v_mfma_f32_16x16x32_bf16 v[144:147], v[168:171], v[168:171], v[144:147]
    s_add_u32 m0, s59, 65536
    s_add_u32 s67, s58, 11538432
    buffer_load_dwordx4 v6, s[12:15], s67 offen offset:0 sc1 lds
    v_mfma_f32_16x16x32_bf16 v[132:135], v[204:207], v[42:45], v[132:135]
    v_mfma_f32_16x16x32_bf16 v[140:143], v[42:45], v[172:175], v[140:143]
    v_mfma_f32_16x16x32_bf16 v[148:151], v[172:175], v[172:175], v[148:151]
    s_mov_b32 s76, 0x22222222
    s_mov_b32 s77, 0x22222222
    s_mov_b32 s78, 0x44444444
    s_mov_b32 s79, 0x44444444
    s_mov_b32 s80, 0x88888888
    s_mov_b32 s81, 0x88888888
    s_mov_b32 s74, 0x00f0000f
    s_mov_b32 s75, 0xf0000f00
    s_lshl_b32 s68, s3, 9
    s_lshl_b32 s69, s82, 8
    s_add_u32 s68, s68, s69
    s_add_u32 s68, s68, 40960
    v_lshlrev_b32 v48, 3, v2
    v_add_u32 v48, s68, v48
    s_lshl_b32 s68, s82, 8
    s_lshl_b32 s69, s3, 7
    s_add_u32 s68, s68, s69
    s_add_u32 s68, s68, 41984
    v_lshlrev_b32 v49, 4, v1
    v_add_u32 v49, s68, v49
    v_cndmask_b32 v137, v144, v145, s[76:77]
    v_cndmask_b32 v137, v137, v146, s[78:79]
    v_cndmask_b32 v137, v137, v147, s[80:81]
    v_cndmask_b32 v141, v148, v149, s[76:77]
    v_cndmask_b32 v141, v141, v150, s[78:79]
    v_cndmask_b32 v141, v141, v151, s[80:81]
    s_mov_b64 exec, s[74:75]
    ds_write_b64 v48, v[136:137] offset:0
    ds_write_b64 v48, v[140:141] offset:128
    s_mov_b32 exec_lo, 0x00010001
    s_mov_b32 exec_hi, 0x00010001
    ds_write_b128 v49, v[128:131] offset:0
    ds_write_b128 v49, v[132:135] offset:64
    s_mov_b64 exec, -1
    v_xor_b32 v50, 256, v48
    v_xor_b32 v51, 128, v49
    s_add_u32 s68, s50, 256
    s_lshl_b32 s70, s82, 3
    s_add_u32 s69, s88, s70
    s_lshl_b32 s70, s3, 2
    s_add_u32 s71, s69, s70
    s_xor_b32 s70, s70, 4
    s_add_u32 s69, s69, s70
    s_mul_i32 s71, s71, 4608
    s_mul_i32 s69, s69, 4608
    s_add_u32 s71, s71, s68
    s_add_u32 s69, s69, s68
    s_and_b32 s68, s54, 1
    s_lshl_b32 s68, s68, 11
    s_lshl_b32 s70, s3, 10
    s_add_u32 s68, s68, s70
    s_lshl_b32 s70, s82, 9
    s_add_u32 s68, s68, s70
    v_add_u32 v52, s68, v3
    s_xor_b32 s68, s68, 512
    v_add_u32 v53, s68, v3
    s_and_b32 s68, s54, s3
    s_cmp_ge_u32 s55, 5
    s_cselect_b32 s68, s68, 0
    s_cmp_lt_u32 s45, 7
    s_cselect_b32 s68, s68, 0
    s_cmp_eq_u32 s68, 1
    s_cselect_b32 s72, 0, 1073741824
    s_add_u32 s84, s71, 1310464
    s_add_u32 s85, s69, 1310464
    s_or_b32 s84, s84, s72
    s_or_b32 s85, s85, s72
    s_lshl_b32 s86, s2, 5
    s_lshl_b32 s87, s82, 2
    s_add_u32 s86, s86, s87
    s_add_u32 s86, s86, 8
    s_or_b32 s86, s86, s72
    s_cmp_lt_u32 s55, 5
    s_cselect_b32 s70, 0x3ea52b5c, 0x3f800000
    s_waitcnt lgkmcnt(0)
    s_barrier
    ds_read_b64 v[152:153], v48 offset:0
    ds_read_b64 v[154:155], v48 offset:128
    ds_read_b64 v[156:157], v50 offset:0
    ds_read_b64 v[158:159], v50 offset:128
    ds_read_b128 v[168:171], v49 offset:0
    ds_read_b128 v[172:175], v49 offset:64
    ds_read_b128 v[176:179], v51 offset:0
    ds_read_b128 v[180:183], v51 offset:64
    s_waitcnt lgkmcnt(4)
    v_mul_f32 v160, 0x3acccccd, v152
    v_mul_f32 v162, 0x3acccccd, v154
    v_mul_f32 v164, 0x3acccccd, v156
    v_mul_f32 v166, 0x3acccccd, v158
    v_mul_f32 v153, 0x3acccccd, v153
    v_mul_f32 v155, 0x3acccccd, v155
    v_mul_f32 v157, 0x3acccccd, v157
    v_mul_f32 v159, 0x3acccccd, v159
    v_fma_f32 v153, -v160, v160, v153
    v_fma_f32 v155, -v162, v162, v155
    v_fma_f32 v157, -v164, v164, v157
    v_fma_f32 v159, -v166, v166, v159
    v_max_f32 v153, 0, v153
    v_max_f32 v155, 0, v155
    v_max_f32 v157, 0, v157
    v_max_f32 v159, 0, v159
    v_add_f32 v216, 0x3727c5ac, v153
    v_add_f32 v218, 0x3727c5ac, v155
    v_add_f32 v220, 0x3727c5ac, v157
    v_add_f32 v222, 0x3727c5ac, v159
    v_rsq_f32 v216, v216
    v_rsq_f32 v218, v218
    v_rsq_f32 v220, v220
    v_rsq_f32 v222, v222
    v_mul_f32 v216, s70, v216
    v_mul_f32 v218, s70, v218
    v_mul_f32 v220, s70, v220
    v_mul_f32 v222, s70, v222
    s_waitcnt lgkmcnt(0)
    v_pk_fma_f32 v[80:81], v[168:169], v[162:163], v[80:81] op_sel_hi:[1,0,1] neg_lo:[0,1,0] neg_hi:[0,1,0]
    v_pk_fma_f32 v[82:83], v[170:171], v[162:163], v[82:83] op_sel_hi:[1,0,1] neg_lo:[0,1,0] neg_hi:[0,1,0]
    v_pk_fma_f32 v[84:85], v[172:173], v[162:163], v[84:85] op_sel_hi:[1,0,1] neg_lo:[0,1,0] neg_hi:[0,1,0]
    v_pk_fma_f32 v[86:87], v[174:175], v[162:163], v[86:87] op_sel_hi:[1,0,1] neg_lo:[0,1,0] neg_hi:[0,1,0]
    v_pk_fma_f32 v[88:89], v[176:177], v[162:163], v[88:89] op_sel_hi:[1,0,1] neg_lo:[0,1,0] neg_hi:[0,1,0]
    v_pk_fma_f32 v[90:91], v[178:179], v[162:163], v[90:91] op_sel_hi:[1,0,1] neg_lo:[0,1,0] neg_hi:[0,1,0]
    v_pk_fma_f32 v[92:93], v[180:181], v[162:163], v[92:93] op_sel_hi:[1,0,1] neg_lo:[0,1,0] neg_hi:[0,1,0]
    v_pk_fma_f32 v[94:95], v[182:183], v[162:163], v[94:95] op_sel_hi:[1,0,1] neg_lo:[0,1,0] neg_hi:[0,1,0]
    v_pk_mul_f32 v[80:81], v[80:81], v[218:219] op_sel_hi:[1,0]
    v_pk_mul_f32 v[82:83], v[82:83], v[218:219] op_sel_hi:[1,0]
    v_pk_mul_f32 v[84:85], v[84:85], v[218:219] op_sel_hi:[1,0]
    v_pk_mul_f32 v[86:87], v[86:87], v[218:219] op_sel_hi:[1,0]
    v_pk_mul_f32 v[88:89], v[88:89], v[218:219] op_sel_hi:[1,0]
    v_pk_mul_f32 v[90:91], v[90:91], v[218:219] op_sel_hi:[1,0]
    v_pk_mul_f32 v[92:93], v[92:93], v[218:219] op_sel_hi:[1,0]
    v_pk_mul_f32 v[94:95], v[94:95], v[218:219] op_sel_hi:[1,0]
    v_cvt_pk_bf16_f32 v192, v80, v81
    v_cvt_pk_bf16_f32 v193, v82, v83
    v_cvt_pk_bf16_f32 v194, v84, v85
    v_cvt_pk_bf16_f32 v195, v86, v87
    v_cvt_pk_bf16_f32 v196, v88, v89
    v_cvt_pk_bf16_f32 v197, v90, v91
    v_cvt_pk_bf16_f32 v198, v92, v93
    v_cvt_pk_bf16_f32 v199, v94, v95
    buffer_store_dwordx4 v[192:195], v52, s[12:15], s71 offen offset:256 sc1
    buffer_store_dwordx4 v[196:199], v52, s[12:15], s69 offen offset:256 sc1
    v_pk_fma_f32 v[112:113], v[168:169], v[166:167], v[112:113] op_sel_hi:[1,0,1] neg_lo:[0,1,0] neg_hi:[0,1,0]
    v_pk_fma_f32 v[114:115], v[170:171], v[166:167], v[114:115] op_sel_hi:[1,0,1] neg_lo:[0,1,0] neg_hi:[0,1,0]
    v_pk_fma_f32 v[116:117], v[172:173], v[166:167], v[116:117] op_sel_hi:[1,0,1] neg_lo:[0,1,0] neg_hi:[0,1,0]
    v_pk_fma_f32 v[118:119], v[174:175], v[166:167], v[118:119] op_sel_hi:[1,0,1] neg_lo:[0,1,0] neg_hi:[0,1,0]
    v_pk_fma_f32 v[120:121], v[176:177], v[166:167], v[120:121] op_sel_hi:[1,0,1] neg_lo:[0,1,0] neg_hi:[0,1,0]
    v_pk_fma_f32 v[122:123], v[178:179], v[166:167], v[122:123] op_sel_hi:[1,0,1] neg_lo:[0,1,0] neg_hi:[0,1,0]
    v_pk_fma_f32 v[124:125], v[180:181], v[166:167], v[124:125] op_sel_hi:[1,0,1] neg_lo:[0,1,0] neg_hi:[0,1,0]
    v_pk_fma_f32 v[126:127], v[182:183], v[166:167], v[126:127] op_sel_hi:[1,0,1] neg_lo:[0,1,0] neg_hi:[0,1,0]
    v_pk_mul_f32 v[112:113], v[112:113], v[222:223] op_sel_hi:[1,0]
    v_pk_mul_f32 v[114:115], v[114:115], v[222:223] op_sel_hi:[1,0]
    v_pk_mul_f32 v[116:117], v[116:117], v[222:223] op_sel_hi:[1,0]
    v_pk_mul_f32 v[118:119], v[118:119], v[222:223] op_sel_hi:[1,0]
    v_pk_mul_f32 v[120:121], v[120:121], v[222:223] op_sel_hi:[1,0]
    v_pk_mul_f32 v[122:123], v[122:123], v[222:223] op_sel_hi:[1,0]
    v_pk_mul_f32 v[124:125], v[124:125], v[222:223] op_sel_hi:[1,0]
    v_pk_mul_f32 v[126:127], v[126:127], v[222:223] op_sel_hi:[1,0]
    v_cvt_pk_bf16_f32 v208, v112, v113
    v_cvt_pk_bf16_f32 v209, v114, v115
    v_cvt_pk_bf16_f32 v210, v116, v117
    v_cvt_pk_bf16_f32 v211, v118, v119
    v_cvt_pk_bf16_f32 v212, v120, v121
    v_cvt_pk_bf16_f32 v213, v122, v123
    v_cvt_pk_bf16_f32 v214, v124, v125
    v_cvt_pk_bf16_f32 v215, v126, v127
    s_cmp_lg_u32 s72, 0
    s_cbranch_scc1 L_nohalo_15
    s_cmp_eq_u32 s82, 1
    s_cbranch_scc0 L_alt_16
    buffer_store_dwordx4 v[192:195], v3, s[12:15], s84 offen sc1
    buffer_store_dwordx4 v[196:199], v3, s[12:15], s85 offen sc1
    s_branch L_altd_17
L_alt_16:
    buffer_store_dwordx4 v[208:211], v3, s[12:15], s84 offen sc1
    buffer_store_dwordx4 v[212:215], v3, s[12:15], s85 offen sc1
L_altd_17:
L_nohalo_15:
    buffer_store_dwordx4 v[208:211], v53, s[12:15], s71 offen offset:256 sc1
    buffer_store_dwordx4 v[212:215], v53, s[12:15], s69 offen offset:256 sc1
    s_waitcnt vmcnt(4)
    s_barrier
    v_pk_fma_f32 v[64:65], v[168:169], v[160:161], v[64:65] op_sel_hi:[1,0,1] neg_lo:[0,1,0] neg_hi:[0,1,0]
    v_pk_fma_f32 v[66:67], v[170:171], v[160:161], v[66:67] op_sel_hi:[1,0,1] neg_lo:[0,1,0] neg_hi:[0,1,0]
    v_pk_fma_f32 v[68:69], v[172:173], v[160:161], v[68:69] op_sel_hi:[1,0,1] neg_lo:[0,1,0] neg_hi:[0,1,0]
    v_pk_fma_f32 v[70:71], v[174:175], v[160:161], v[70:71] op_sel_hi:[1,0,1] neg_lo:[0,1,0] neg_hi:[0,1,0]
    v_pk_fma_f32 v[72:73], v[176:177], v[160:161], v[72:73] op_sel_hi:[1,0,1] neg_lo:[0,1,0] neg_hi:[0,1,0]
    v_pk_fma_f32 v[74:75], v[178:179], v[160:161], v[74:75] op_sel_hi:[1,0,1] neg_lo:[0,1,0] neg_hi:[0,1,0]
    v_pk_fma_f32 v[76:77], v[180:181], v[160:161], v[76:77] op_sel_hi:[1,0,1] neg_lo:[0,1,0] neg_hi:[0,1,0]
    v_pk_fma_f32 v[78:79], v[182:183], v[160:161], v[78:79] op_sel_hi:[1,0,1] neg_lo:[0,1,0] neg_hi:[0,1,0]
    v_pk_mul_f32 v[64:65], v[64:65], v[216:217] op_sel_hi:[1,0]
    v_pk_mul_f32 v[66:67], v[66:67], v[216:217] op_sel_hi:[1,0]
    v_pk_mul_f32 v[68:69], v[68:69], v[216:217] op_sel_hi:[1,0]
    v_pk_mul_f32 v[70:71], v[70:71], v[216:217] op_sel_hi:[1,0]
    v_pk_mul_f32 v[72:73], v[72:73], v[216:217] op_sel_hi:[1,0]
    v_pk_mul_f32 v[74:75], v[74:75], v[216:217] op_sel_hi:[1,0]
    v_pk_mul_f32 v[76:77], v[76:77], v[216:217] op_sel_hi:[1,0]
    v_pk_mul_f32 v[78:79], v[78:79], v[216:217] op_sel_hi:[1,0]
    v_cvt_pk_bf16_f32 v184, v64, v65
    v_cvt_pk_bf16_f32 v185, v66, v67
    v_cvt_pk_bf16_f32 v186, v68, v69
    v_cvt_pk_bf16_f32 v187, v70, v71
    v_cvt_pk_bf16_f32 v188, v72, v73
    v_cvt_pk_bf16_f32 v189, v74, v75
    v_cvt_pk_bf16_f32 v190, v76, v77
    v_cvt_pk_bf16_f32 v191, v78, v79
    buffer_store_dwordx4 v[184:187], v52, s[12:15], s71 offen offset:0 sc1
    buffer_store_dwordx4 v[188:191], v52, s[12:15], s69 offen offset:0 sc1
    v_pk_fma_f32 v[96:97], v[168:169], v[164:165], v[96:97] op_sel_hi:[1,0,1] neg_lo:[0,1,0] neg_hi:[0,1,0]
    v_pk_fma_f32 v[98:99], v[170:171], v[164:165], v[98:99] op_sel_hi:[1,0,1] neg_lo:[0,1,0] neg_hi:[0,1,0]
    v_pk_fma_f32 v[100:101], v[172:173], v[164:165], v[100:101] op_sel_hi:[1,0,1] neg_lo:[0,1,0] neg_hi:[0,1,0]
    v_pk_fma_f32 v[102:103], v[174:175], v[164:165], v[102:103] op_sel_hi:[1,0,1] neg_lo:[0,1,0] neg_hi:[0,1,0]
    v_pk_fma_f32 v[104:105], v[176:177], v[164:165], v[104:105] op_sel_hi:[1,0,1] neg_lo:[0,1,0] neg_hi:[0,1,0]
    v_pk_fma_f32 v[106:107], v[178:179], v[164:165], v[106:107] op_sel_hi:[1,0,1] neg_lo:[0,1,0] neg_hi:[0,1,0]
    v_pk_fma_f32 v[108:109], v[180:181], v[164:165], v[108:109] op_sel_hi:[1,0,1] neg_lo:[0,1,0] neg_hi:[0,1,0]
    v_pk_fma_f32 v[110:111], v[182:183], v[164:165], v[110:111] op_sel_hi:[1,0,1] neg_lo:[0,1,0] neg_hi:[0,1,0]
    v_pk_mul_f32 v[96:97], v[96:97], v[220:221] op_sel_hi:[1,0]
    v_pk_mul_f32 v[98:99], v[98:99], v[220:221] op_sel_hi:[1,0]
    v_pk_mul_f32 v[100:101], v[100:101], v[220:221] op_sel_hi:[1,0]
    v_pk_mul_f32 v[102:103], v[102:103], v[220:221] op_sel_hi:[1,0]
    v_pk_mul_f32 v[104:105], v[104:105], v[220:221] op_sel_hi:[1,0]
    v_pk_mul_f32 v[106:107], v[106:107], v[220:221] op_sel_hi:[1,0]
    v_pk_mul_f32 v[108:109], v[108:109], v[220:221] op_sel_hi:[1,0]
    v_pk_mul_f32 v[110:111], v[110:111], v[220:221] op_sel_hi:[1,0]
    v_cvt_pk_bf16_f32 v200, v96, v97
    v_cvt_pk_bf16_f32 v201, v98, v99
    v_cvt_pk_bf16_f32 v202, v100, v101
    v_cvt_pk_bf16_f32 v203, v102, v103
    v_cvt_pk_bf16_f32 v204, v104, v105
    v_cvt_pk_bf16_f32 v205, v106, v107
    v_cvt_pk_bf16_f32 v206, v108, v109
    v_cvt_pk_bf16_f32 v207, v110, v111
    buffer_store_dwordx4 v[200:203], v53, s[12:15], s71 offen offset:0 sc1
    buffer_store_dwordx4 v[204:207], v53, s[12:15], s69 offen offset:0 sc1
    v_mov_b32 v248, v52
    v_mov_b32 v249, v53
    s_mov_b32 s88, s71
    s_mov_b32 s89, s69
    s_and_b32 s62, s46, 1
    s_lshl_b32 s62, s62, 2
    s_add_u32 s62, s62, s44
    v_lshlrev_b32 v53, 2, v1
    v_sub_u32 v53, v2, v53
    v_mov_b32 v55, 0xf149f2ca
    s_cmp_eq_u32 s57, 0
    s_cselect_b32 s70, 7, 0x80000000
    v_subrev_u32 v54, 0, v53
    v_and_b32 v54, 0x80000001, v54
    v_cmp_eq_u32 vcc, 0, v54
    s_nop 1
    v_cndmask_b32 v176, v55, 0, vcc
    v_cmp_eq_u32 vcc, s70, v54
    s_nop 1
    v_cndmask_b32 v172, v55, 0, vcc
    v_subrev_u32 v54, 1, v53
    v_and_b32 v54, 0x80000001, v54
    v_cmp_eq_u32 vcc, 0, v54
    s_nop 1
    v_cndmask_b32 v177, v55, 0, vcc
    v_cmp_eq_u32 vcc, s70, v54
    s_nop 1
    v_cndmask_b32 v173, v55, 0, vcc
    v_subrev_u32 v54, 2, v53
    v_and_b32 v54, 0x80000001, v54
    v_cmp_eq_u32 vcc, 0, v54
    s_nop 1
    v_cndmask_b32 v178, v55, 0, vcc
    v_cmp_eq_u32 vcc, s70, v54
    s_nop 1
    v_cndmask_b32 v174, v55, 0, vcc
    v_subrev_u32 v54, 3, v53
    v_and_b32 v54, 0x80000001, v54
    v_cmp_eq_u32 vcc, 0, v54
    s_nop 1
    v_cndmask_b32 v179, v55, 0, vcc
    v_cmp_eq_u32 vcc, s70, v54
    s_nop 1
    v_cndmask_b32 v175, v55, 0, vcc
    v_add_u32 v56, 368640, v3
    v_add_u32 v57, 737280, v3
    v_add_u32 v58, 0, v3
    s_cmp_eq_u32 s57, 0
    s_cselect_b32 s70, 1073741824, 0
    v_or_b32 v59, s70, v57
    v_or_b32 v60, s70, v58
    s_add_u32 s68, s59, 40960
    s_movk_i32 s69, 160
    v_mul_u32_u24 v53, s69, v2
    v_lshlrev_b32 v54, 3, v1
    v_add3_u32 v53, v53, v54, s68
    v_add_u32_e64 v54, s68, v15
    s_mul_i32 s68, s48, 80
    s_add_u32 s69, s68, 79
    s_lshr_b32 s68, s68, 7
    s_lshr_b32 s69, s69, 7
    s_lshl_b32 s72, 0x420, s68
    s_lshl_b32 s73, 0x420, s69
    s_or_b32 s72, s72, s73
    s_lshl_b32 s68, s68, 2
    s_lshl_b32 s69, s69, 2
    s_mov_b32 s76, 0x00100001
    s_mov_b32 s77, 0x100
    s_lshl_b64 s[74:75], s[76:77], s68
    s_lshl_b64 s[76:77], s[76:77], s69
    s_or_b64 s[76:77], s[74:75], s[76:77]
    s_lshr_b32 s68, s49, 2
    s_sub_u32 s69, s49, 1
    s_max_i32 s69, s69, 0
    s_lshr_b32 s69, s69, 2
    s_lshl_b64 s[74:75], s[76:77], s68
    s_lshl_b64 s[76:77], s[76:77], s69
    s_or_b64 s[74:75], s[74:75], s[76:77]
    ds_read_b128 a[48:51], v10 offset:0
    ds_read_b128 a[52:55], v10 offset:1024
    ds_read_b128 a[56:59], v10 offset:2048
    ds_read_b128 a[60:63], v10 offset:3072
    ds_read_b128 a[64:67], v10 offset:4096
    ds_read_b128 a[68:71], v10 offset:5120
    ds_read_b128 a[72:75], v10 offset:6144
    ds_read_b128 a[76:79], v10 offset:7168
    ds_read_b128 a[80:83], v10 offset:8192
    ds_read_b128 a[84:87], v10 offset:9216
    ds_read_b128 a[88:91], v10 offset:10240
    ds_read_b128 a[92:95], v10 offset:11264
    ds_read_b128 a[96:99], v10 offset:12288
    ds_read_b128 a[100:103], v10 offset:13312
    ds_read_b128 a[104:107], v10 offset:14336
    ds_read_b128 a[108:111], v10 offset:15360
    ds_read_b128 a[112:115], v10 offset:16384
    ds_read_b128 a[116:119], v10 offset:17408
    ds_read_b128 a[120:123], v10 offset:18432
    ds_read_b128 a[124:127], v10 offset:19456
    ds_read_b128 a[128:131], v10 offset:20480
    ds_read_b128 a[132:135], v10 offset:21504
    ds_read_b128 a[136:139], v10 offset:22528
    ds_read_b128 a[140:143], v10 offset:23552
    ds_read_b128 a[144:147], v10 offset:24576
    ds_read_b128 a[148:151], v10 offset:25600
    ds_read_b128 a[152:155], v10 offset:26624
    ds_read_b128 a[156:159], v10 offset:27648
    ds_read_b128 a[160:163], v10 offset:28672
    ds_read_b128 a[164:167], v10 offset:29696
    ds_read_b128 a[168:171], v10 offset:30720
    ds_read_b128 a[172:175], v10 offset:31744
    ds_read_b128 a[176:179], v10 offset:32768
    ds_read_b128 a[180:183], v10 offset:33792
    ds_read_b128 a[184:187], v10 offset:34816
    ds_read_b128 a[188:191], v10 offset:35840
    ds_read_b128 a[192:195], v10 offset:36864
    ds_read_b128 a[196:199], v10 offset:37888
    ds_read_b128 a[200:203], v10 offset:38912
    ds_read_b128 a[204:207], v10 offset:39936
    ds_read_b128 a[208:211], v10 offset:40960
    ds_read_b128 a[212:215], v10 offset:41984
    ds_read_b128 a[216:219], v10 offset:43008
    ds_read_b128 a[220:223], v10 offset:44032
    ds_read_b128 a[224:227], v10 offset:45056
    ds_read_b128 a[228:231], v10 offset:46080
    ds_read_b128 a[232:235], v10 offset:47104
    ds_read_b128 a[236:239], v10 offset:48128
    ds_read_b128 a[240:243], v10 offset:49152
    ds_read_b128 a[244:247], v10 offset:50176
    ds_read_b128 a[248:251], v10 offset:51200
    ds_read_b128 a[252:255], v10 offset:52224
    s_waitcnt vmcnt(0)
    v_mov_b32 v48, 2
    v_mov_b32 v49, 0
    s_mov_b64 exec, 1
    s_cmp_eq_u32 s51, 1
    s_cbranch_scc0 L_alt_18
    buffer_store_dword v48, v49, s[12:15], s52 offen
    s_branch L_altd_19
L_alt_18:
    buffer_store_dword v48, v49, s[12:15], s52 offen sc1
L_altd_19:
    s_mov_b64 exec, -1
    s_mov_b64 exec, 1
    buffer_store_dword v48, v49, s[12:15], s86 offen sc1
    s_mov_b64 exec, -1
L_join_2:
    s_waitcnt lgkmcnt(0)
    s_barrier
    s_cmp_lg_u32 s44, 0
    s_cbranch_scc1 L_nt4
    s_call_b64 s[98:99], L_stub4
L_nt4:
    s_cmp_lg_u32 s44, 1
    s_cbranch_scc1 L_nt5
    s_call_b64 s[98:99], L_stub5
L_nt5:
    s_cmp_lg_u32 s44, 2
    s_cbranch_scc1 L_nt6
    s_call_b64 s[98:99], L_stub6
L_nt6:
    s_cmp_lg_u32 s44, 3
    s_cbranch_scc1 L_nt7
    s_call_b64 s[98:99], L_stub7
L_nt7:
    s_mov_b64 exec, s[74:75]
    s_mov_b32 s56, 0
L_sp_34:
    buffer_load_dwordx2 v[48:49], v8, s[12:15], s53 offen sc1
    s_add_u32 s56, s56, 1
    s_waitcnt vmcnt(0)
    v_min_u32 v48, v48, v49
    v_cmp_gt_u32 vcc, 2, v48
    s_cmp_gt_u32 s56, 200000
    s_cbranch_scc1 L_spo_35
    s_cbranch_vccnz L_sp_34
L_spo_35:
    s_mov_b64 exec, -1
    s_cmp_lg_u32 s49, 0
    s_cbranch_scc1 L_nohp_36
    s_cmp_eq_u32 s45, 0
    s_cbranch_scc1 L_nohp_36
    s_mov_b32 exec_lo, 0
    s_mov_b32 exec_hi, s72
    s_mov_b32 s56, 0
L_sp_37:
    buffer_load_dwordx2 v[48:49], v4, s[12:15], 0 offen offset:8 sc1
    s_add_u32 s56, s56, 1
    s_waitcnt vmcnt(0)
    v_min_u32 v48, v48, v49
    v_cmp_eq_u32 vcc, 0, v48
    s_cmp_gt_u32 s56, 200000
    s_cbranch_scc1 L_spo_38
    s_cbranch_vccnz L_sp_37
L_spo_38:
    s_mov_b64 exec, -1
L_nohp_36:
    s_bitcmp0_b32 s48, 0
    s_cbranch_scc0 L_alt_39
    buffer_load_dwordx4 v[64:67], v56, s[12:15], s63 offen offset:256 sc1
    buffer_load_dwordx4 v[68:71], v56, s[12:15], s64 offen offset:256 sc1
    buffer_load_dwordx2 v[72:73], v56, s[12:15], s65 offen offset:256 sc1
    buffer_load_dwordx4 v[88:91], v59, s[12:15], s63 offen offset:0 sc1
    buffer_load_dwordx4 v[92:95], v59, s[12:15], s64 offen offset:0 sc1
    buffer_load_dwordx2 v[96:97], v59, s[12:15], s65 offen offset:0 sc1
    buffer_load_dwordx4 v[76:79], v57, s[12:15], s63 offen offset:256 sc1
    buffer_load_dwordx4 v[80:83], v57, s[12:15], s64 offen offset:256 sc1
    buffer_load_dwordx2 v[84:85], v57, s[12:15], s65 offen offset:256 sc1
    buffer_load_dwordx4 v[112:115], v60, s[12:15], s63 offen offset:0 sc1
    buffer_load_dwordx4 v[116:119], v60, s[12:15], s64 offen offset:0 sc1
    buffer_load_dwordx2 v[120:121], v60, s[12:15], s65 offen offset:0 sc1
    buffer_load_dwordx4 v[100:103], v58, s[12:15], s63 offen offset:256 sc1
    buffer_load_dwordx4 v[104:107], v58, s[12:15], s64 offen offset:256 sc1
    buffer_load_dwordx2 v[108:109], v58, s[12:15], s65 offen offset:256 sc1
    s_branch L_altd_40
L_alt_39:
    buffer_load_dwordx2 v[64:65], v56, s[12:15], s63 offen offset:264 sc1
    buffer_load_dwordx4 v[66:69], v56, s[12:15], s64 offen offset:256 sc1
    buffer_load_dwordx4 v[70:73], v56, s[12:15], s65 offen offset:256 sc1
    buffer_load_dwordx2 v[88:89], v59, s[12:15], s63 offen offset:8 sc1
    buffer_load_dwordx4 v[90:93], v59, s[12:15], s64 offen offset:0 sc1
    buffer_load_dwordx4 v[94:97], v59, s[12:15], s65 offen offset:0 sc1
    buffer_load_dwordx2 v[76:77], v57, s[12:15], s63 offen offset:264 sc1
    buffer_load_dwordx4 v[78:81], v57, s[12:15], s64 offen offset:256 sc1
    buffer_load_dwordx4 v[82:85], v57, s[12:15], s65 offen offset:256 sc1
    buffer_load_dwordx2 v[112:113], v60, s[12:15], s63 offen offset:8 sc1
    buffer_load_dwordx4 v[114:117], v60, s[12:15], s64 offen offset:0 sc1
    buffer_load_dwordx4 v[118:121], v60, s[12:15], s65 offen offset:0 sc1
    buffer_load_dwordx2 v[100:101], v58, s[12:15], s63 offen offset:264 sc1
    buffer_load_dwordx4 v[102:105], v58, s[12:15], s64 offen offset:256 sc1
    buffer_load_dwordx4 v[106:109], v58, s[12:15], s65 offen offset:256 sc1
L_altd_40:
    v_lshlrev_b32 v14, 2, v0
    s_mov_b64 exec, 0xff
    v_add_u32 v14, 14336, v14
    buffer_load_dword v13, v14, s[12:15], 0 offen sc1
    s_mov_b64 exec, -1
    s_mov_b32 s84, 0xffff0000
    s_mov_b32 s85, 0xffffffff
    s_mov_b32 s86, 0x0
    s_mov_b32 s87, 0xffffffff
    s_mov_b32 s88, 0x0
    s_mov_b32 s89, 0xffff0000
    s_mov_b32 s90, 0xffff
    s_mov_b32 s91, 0x0
    s_mov_b32 s92, 0xffffffff
    s_mov_b32 s93, 0x0
    s_mov_b32 s94, 0xffffffff
    s_mov_b32 s95, 0xffff
    s_waitcnt vmcnt(13)
    v_mov_b32 v124, v64
    v_cndmask_b32 v126, 0, v66, s[90:91]
    v_mov_b32 v125, v65
    v_cndmask_b32 v127, 0, v67, s[90:91]
    v_cndmask_b32 v128, 0, v66, s[84:85]
    v_cndmask_b32 v130, 0, v68, s[92:93]
    v_cndmask_b32 v129, 0, v67, s[84:85]
    v_cndmask_b32 v131, 0, v69, s[92:93]
    v_cndmask_b32 v132, 0, v68, s[86:87]
    v_cndmask_b32 v134, 0, v70, s[94:95]
    v_cndmask_b32 v133, 0, v69, s[86:87]
    v_cndmask_b32 v135, 0, v71, s[94:95]
    v_cndmask_b32 v136, 0, v70, s[88:89]
    v_mov_b32 v138, v72
    v_cndmask_b32 v137, 0, v71, s[88:89]
    v_mov_b32 v139, v73
    s_waitcnt vmcnt(7)
    v_mfma_f32_16x16x32_bf16 v[140:143], v[88:91], v[124:127], v[172:175]
    v_mfma_f32_16x16x32_bf16 v[144:147], v[76:79], v[124:127], v[176:179]
    v_mfma_f32_16x16x32_bf16 v[148:151], v[90:93], v[128:131], v[172:175]
    v_mfma_f32_16x16x32_bf16 v[152:155], v[78:81], v[128:131], v[176:179]
    v_mfma_f32_16x16x32_bf16 v[156:159], v[92:95], v[132:135], v[172:175]
    v_mfma_f32_16x16x32_bf16 v[160:163], v[80:83], v[132:135], v[176:179]
    v_mfma_f32_16x16x32_bf16 v[164:167], v[94:97], v[136:139], v[172:175]
    v_mfma_f32_16x16x32_bf16 v[168:171], v[82:85], v[136:139], v[176:179]
    s_nop 0
    v_max3_f32 v64, v140, v141, v142
    s_nop 0
    v_max3_f32 v66, v148, v149, v150
    s_nop 0
    v_max3_f32 v68, v156, v157, v158
    s_nop 0
    v_max3_f32 v70, v164, v165, v166
    v_max3_f32 v64, v64, v143, v144
    v_max3_f32 v66, v66, v151, v152
    v_max3_f32 v68, v68, v159, v160
    v_max3_f32 v70, v70, v167, v168
    v_max3_f32 v64, v64, v145, v146
    v_max3_f32 v66, v66, v153, v154
    v_max3_f32 v68, v68, v161, v162
    v_max3_f32 v70, v70, v169, v170
    v_max_f32 v64, v64, v147
    v_max_f32 v66, v66, v155
    v_max_f32 v68, v68, v163
    v_max_f32 v70, v70, v171
    v_mov_b32 v56, v64
    v_mov_b32 v57, v66
    v_mov_b32 v58, v68
    v_mov_b32 v59, v70
    v_permlane16_swap_b32 v64, v56
    v_permlane16_swap_b32 v66, v57
    v_permlane16_swap_b32 v68, v58
    v_permlane16_swap_b32 v70, v59
    v_max_f32 v64, v64, v56
    v_max_f32 v66, v66, v57
    v_max_f32 v68, v68, v58
    v_max_f32 v70, v70, v59
    v_mov_b32 v56, v64
    v_mov_b32 v57, v66
    v_mov_b32 v58, v68
    v_mov_b32 v59, v70
    v_permlane32_swap_b32 v64, v56
    v_permlane32_swap_b32 v66, v57
    v_permlane32_swap_b32 v68, v58
    v_permlane32_swap_b32 v70, v59
    v_max_f32 v64, v64, v56
    v_max_f32 v66, v66, v57
    v_max_f32 v68, v68, v58
    v_max_f32 v70, v70, v59
    s_waitcnt vmcnt(1)
    ds_write_b64 v53, v[112:113] offset:0
    ds_write_b64 v53, v[100:101] offset:2560
    ds_write_b64 v53, v[114:115] offset:32
    ds_write_b64 v53, v[102:103] offset:2592
    ds_write_b64 v53, v[116:117] offset:64
    ds_write_b64 v53, v[104:105] offset:2624
    ds_write_b64 v53, v[118:119] offset:96
    ds_write_b64 v53, v[106:107] offset:2656
    ds_write_b64 v53, v[120:121] offset:128
    ds_write_b64 v53, v[108:109] offset:2688
    s_waitcnt vmcnt(0)
    s_mov_b64 exec, 0xff
    v_cmp_eq_u32 vcc, 0, v13
    s_cbranch_vccz L_gdok_41
    s_mov_b32 s56, 0
L_sp_42:
    buffer_load_dword v13, v14, s[12:15], 0 offen sc1
    s_add_u32 s56, s56, 1
    s_waitcnt vmcnt(0)
    v_cmp_eq_u32 vcc, 0, v13
    s_cmp_gt_u32 s56, 200000
    s_cbranch_scc1 L_spo_43
    s_cbranch_vccnz L_sp_42
L_spo_43:
L_gdok_41:
    s_mov_b64 exec, -1
    v_pk_add_f32 v[140:141], v[140:141], v[64:65] op_sel_hi:[1,0] neg_lo:[0,1] neg_hi:[0,1]
    v_pk_add_f32 v[142:143], v[142:143], v[64:65] op_sel_hi:[1,0] neg_lo:[0,1] neg_hi:[0,1]
    v_pk_add_f32 v[144:145], v[144:145], v[64:65] op_sel_hi:[1,0] neg_lo:[0,1] neg_hi:[0,1]
    v_pk_add_f32 v[146:147], v[146:147], v[64:65] op_sel_hi:[1,0] neg_lo:[0,1] neg_hi:[0,1]
    s_add_u32 m0, s59, 0
    s_add_u32 s67, s58, 12582912
    buffer_load_dwordx4 v6, s[12:15], s67 offen offset:0 sc1 lds
    v_exp_f32 v140, v140
    v_exp_f32 v141, v141
    v_exp_f32 v142, v142
    v_exp_f32 v143, v143
    buffer_load_dwordx4 v6, s[12:15], s67 offen offset:1024 sc1 lds
    v_exp_f32 v144, v144
    v_exp_f32 v145, v145
    v_exp_f32 v146, v146
    v_exp_f32_e64 v147, v147
    buffer_load_dwordx4 v6, s[12:15], s67 offen offset:2048 sc1 lds
    v_cvt_pk_bf16_f32 v200, v140, v141
    v_cvt_pk_bf16_f32 v201, v142, v143
    v_cvt_pk_bf16_f32 v202, v144, v145
    v_cvt_pk_bf16_f32 v203, v146, v147
    buffer_load_dwordx4 v6, s[12:15], s67 offen offset:3072 sc1 lds
    v_pk_add_f32 v[148:149], v[148:149], v[66:67] op_sel_hi:[1,0] neg_lo:[0,1] neg_hi:[0,1]
    v_pk_add_f32 v[150:151], v[150:151], v[66:67] op_sel_hi:[1,0] neg_lo:[0,1] neg_hi:[0,1]
    v_pk_add_f32 v[152:153], v[152:153], v[66:67] op_sel_hi:[1,0] neg_lo:[0,1] neg_hi:[0,1]
    v_pk_add_f32 v[154:155], v[154:155], v[66:67] op_sel_hi:[1,0] neg_lo:[0,1] neg_hi:[0,1]
    s_add_u32 m0, s59, 4096
    s_add_u32 s67, s58, 12587008
    buffer_load_dwordx4 v6, s[12:15], s67 offen offset:0 sc1 lds
    v_exp_f32 v148, v148
    v_exp_f32 v149, v149
    v_exp_f32 v150, v150
    v_exp_f32 v151, v151
    s_add_u32 m0, s59, 20480
    s_add_u32 s67, s58, 12746752
    buffer_load_dwordx4 v6, s[12:15], s67 offen offset:0 sc1 lds
    v_exp_f32 v152, v152
    v_exp_f32 v153, v153
    v_exp_f32 v154, v154
    v_exp_f32 v155, v155
    buffer_load_dwordx4 v6, s[12:15], s67 offen offset:1024 sc1 lds
    v_cvt_pk_bf16_f32 v204, v148, v149
    v_cvt_pk_bf16_f32 v205, v150, v151
    v_cvt_pk_bf16_f32 v206, v152, v153
    v_cvt_pk_bf16_f32 v207, v154, v155
    buffer_load_dwordx4 v6, s[12:15], s67 offen offset:2048 sc1 lds
    s_waitcnt lgkmcnt(0)
    ds_read_b64_tr_b16 v[180:181], v54 offset:0
    ds_read_b64_tr_b16 v[182:183], v54 offset:2560
    ds_read_b64_tr_b16 v[184:185], v54 offset:32
    ds_read_b64_tr_b16 v[186:187], v54 offset:2592
    ds_read_b64_tr_b16 v[188:189], v54 offset:64
    ds_read_b64_tr_b16 v[190:191], v54 offset:2624
    ds_read_b64_tr_b16 v[192:193], v54 offset:96
    ds_read_b64_tr_b16 v[194:195], v54 offset:2656
    ds_read_b64_tr_b16 v[196:197], v54 offset:128
    ds_read_b64_tr_b16 v[198:199], v54 offset:2688
    v_pk_add_f32 v[156:157], v[156:157], v[68:69] op_sel_hi:[1,0] neg_lo:[0,1] neg_hi:[0,1]
    v_pk_add_f32 v[158:159], v[158:159], v[68:69] op_sel_hi:[1,0] neg_lo:[0,1] neg_hi:[0,1]
    v_pk_add_f32 v[160:161], v[160:161], v[68:69] op_sel_hi:[1,0] neg_lo:[0,1] neg_hi:[0,1]
    v_pk_add_f32 v[162:163], v[162:163], v[68:69] op_sel_hi:[1,0] neg_lo:[0,1] neg_hi:[0,1]
    v_exp_f32 v156, v156
    v_exp_f32 v157, v157
    v_exp_f32 v158, v158
    v_exp_f32 v159, v159
    v_exp_f32 v160, v160
    v_exp_f32 v161, v161
    v_exp_f32 v162, v162
    v_exp_f32_e64 v163, v163
    v_cvt_pk_bf16_f32 v208, v156, v157
    v_cvt_pk_bf16_f32 v209, v158, v159
    v_cvt_pk_bf16_f32 v210, v160, v161
    v_cvt_pk_bf16_f32 v211, v162, v163
    buffer_load_dwordx4 v6, s[12:15], s67 offen offset:3072 sc1 lds
    v_pk_add_f32 v[164:165], v[164:165], v[70:71] op_sel_hi:[1,0] neg_lo:[0,1] neg_hi:[0,1]
    v_pk_add_f32 v[166:167], v[166:167], v[70:71] op_sel_hi:[1,0] neg_lo:[0,1] neg_hi:[0,1]
    v_pk_add_f32 v[168:169], v[168:169], v[70:71] op_sel_hi:[1,0] neg_lo:[0,1] neg_hi:[0,1]
    v_pk_add_f32 v[170:171], v[170:171], v[70:71] op_sel_hi:[1,0] neg_lo:[0,1] neg_hi:[0,1]
    v_exp_f32 v164, v164
    v_exp_f32 v165, v165
    v_exp_f32 v166, v166
    v_exp_f32 v167, v167
    v_exp_f32 v168, v168
    v_exp_f32 v169, v169
    v_exp_f32 v170, v170
    v_exp_f32 v171, v171
    v_cvt_pk_bf16_f32 v212, v164, v165
    v_cvt_pk_bf16_f32 v213, v166, v167
    v_cvt_pk_bf16_f32 v214, v168, v169
    v_cvt_pk_bf16_f32 v215, v170, v171
    s_add_u32 m0, s59, 24576
    s_add_u32 s67, s58, 12750848
    buffer_load_dwordx4 v6, s[12:15], s67 offen offset:0 sc1 lds
    s_waitcnt lgkmcnt(0)
    v_mfma_f32_16x16x32_bf16 v[76:79], v[42:45], v[200:203], 0
    v_mfma_f32_16x16x32_bf16 v[80:83], v[42:45], v[204:207], 0
    v_mfma_f32_16x16x32_bf16 v[84:87], v[42:45], v[208:211], 0
    v_mfma_f32_16x16x32_bf16 v[88:91], v[42:45], v[212:215], 0
    v_mfma_f32_16x16x32_bf16 v[216:219], v[180:183], v[200:203], 0
    v_mfma_f32_16x16x32_bf16 v[220:223], v[184:187], v[200:203], 0
    v_mfma_f32_16x16x32_bf16 v[224:227], v[184:187], v[204:207], 0
    v_mfma_f32_16x16x32_bf16 v[228:231], v[188:191], v[204:207], 0
    v_mfma_f32_16x16x32_bf16 v[232:235], v[188:191], v[208:211], 0
    v_mfma_f32_16x16x32_bf16 v[236:239], v[192:195], v[208:211], 0
    v_mfma_f32_16x16x32_bf16 v[240:243], v[192:195], v[212:215], 0
    v_mfma_f32_16x16x32_bf16 v[244:247], v[196:199], v[212:215], 0
    v_rcp_f32 v76, v76
    v_rcp_f32 v80, v80
    v_rcp_f32 v84, v84
    v_rcp_f32_e64 v88, v88
    v_pk_mul_f32 v[216:217], v[216:217], v[76:77] op_sel_hi:[1,0]
    v_pk_mul_f32 v[218:219], v[218:219], v[76:77] op_sel_hi:[1,0]
    v_cvt_pk_bf16_f32 v100, v216, v217
    v_cvt_pk_bf16_f32 v101, v218, v219
    v_cndmask_b32 v220, v220, v224, s[84:85]
    v_cndmask_b32 v221, v221, v225, s[84:85]
    v_cndmask_b32 v222, v222, v226, s[84:85]
    v_cndmask_b32 v223, v223, v227, s[84:85]
    v_cndmask_b32 v82, v76, v80, s[84:85]
    v_pk_mul_f32 v[220:221], v[220:221], v[82:83] op_sel_hi:[1,0]
    v_pk_mul_f32 v[222:223], v[222:223], v[82:83] op_sel_hi:[1,0]
    v_cvt_pk_bf16_f32 v102, v220, v221
    v_cvt_pk_bf16_f32 v103, v222, v223
    v_cndmask_b32 v228, v228, v232, s[86:87]
    v_cndmask_b32 v229, v229, v233, s[86:87]
    v_cndmask_b32 v230, v230, v234, s[86:87]
    v_cndmask_b32 v231, v231, v235, s[86:87]
    v_cndmask_b32 v86, v80, v84, s[86:87]
    v_pk_mul_f32 v[228:229], v[228:229], v[86:87] op_sel_hi:[1,0]
    v_pk_mul_f32 v[230:231], v[230:231], v[86:87] op_sel_hi:[1,0]
    v_cvt_pk_bf16_f32 v104, v228, v229
    v_cvt_pk_bf16_f32 v105, v230, v231
    v_cndmask_b32 v236, v236, v240, s[88:89]
    v_cndmask_b32 v237, v237, v241, s[88:89]
    v_cndmask_b32 v238, v238, v242, s[88:89]
    v_cndmask_b32 v239, v239, v243, s[88:89]
    v_cndmask_b32 v90, v84, v88, s[88:89]
    v_pk_mul_f32 v[236:237], v[236:237], v[90:91] op_sel_hi:[1,0]
    v_pk_mul_f32 v[238:239], v[238:239], v[90:91] op_sel_hi:[1,0]
    v_cvt_pk_bf16_f32 v106, v236, v237
    v_cvt_pk_bf16_f32 v107, v238, v239
    v_pk_mul_f32 v[244:245], v[244:245], v[88:89] op_sel_hi:[1,0]
    v_pk_mul_f32 v[246:247], v[246:247], v[88:89] op_sel_hi:[1,0]
    v_cvt_pk_bf16_f32 v108, v244, v245
    v_cvt_pk_bf16_f32 v109, v246, v247
    v_add_u32 v50, 368640, v3
    s_cmp_eq_u32 s51, 1
    s_cbranch_scc0 L_alt_44
    s_bitcmp0_b32 s48, 0
    s_cbranch_scc0 L_alt_46
    buffer_store_dwordx4 v[100:103], v50, s[12:15], s63 offen offset:256
    buffer_store_dwordx4 v[104:107], v50, s[12:15], s64 offen offset:256
    buffer_store_dwordx2 v[108:109], v50, s[12:15], s65 offen offset:256
    s_branch L_altd_47
L_alt_46:
    buffer_store_dwordx2 v[100:101], v50, s[12:15], s63 offen offset:264
    buffer_store_dwordx4 v[102:105], v50, s[12:15], s64 offen offset:256
    buffer_store_dwordx4 v[106:109], v50, s[12:15], s65 offen offset:256
L_altd_47:
    s_branch L_altd_45
L_alt_44:
    s_bitcmp0_b32 s48, 0
    s_cbranch_scc0 L_alt_48
    buffer_store_dwordx4 v[100:103], v50, s[12:15], s63 offen offset:256 sc1
    buffer_store_dwordx4 v[104:107], v50, s[12:15], s64 offen offset:256 sc1
    buffer_store_dwordx2 v[108:109], v50, s[12:15], s65 offen offset:256 sc1
    s_branch L_altd_49
L_alt_48:
    buffer_store_dwordx2 v[100:101], v50, s[12:15], s63 offen offset:264 sc1
    buffer_store_dwordx4 v[102:105], v50, s[12:15], s64 offen offset:256 sc1
    buffer_store_dwordx4 v[106:109], v50, s[12:15], s65 offen offset:256 sc1
L_altd_49:
L_altd_45:
    s_waitcnt vmcnt(0)
    v_mov_b32 v48, 3
    v_mov_b32 v49, 0
    s_mov_b64 exec, 1
    s_cmp_eq_u32 s51, 1
    s_cbranch_scc0 L_alt_50
    buffer_store_dword v48, v49, s[12:15], s52 offen
    s_branch L_altd_51
L_alt_50:
    buffer_store_dword v48, v49, s[12:15], s52 offen sc1
L_altd_51:
    s_mov_b64 exec, -1
    ds_read_b128 v[172:175], v10 offset:53248
    ds_read_b128 v[176:179], v10 offset:54272
    ds_read_b128 v[180:183], v10 offset:55296
    ds_read_b128 v[184:187], v10 offset:56320
    ds_read_b128 v[188:191], v10 offset:57344
    s_add_u32 m0, s59, 40960
    s_add_u32 s67, s58, 12910592
    buffer_load_dwordx4 v6, s[12:15], s67 offen offset:0 sc1 lds
    ds_read_b128 v[192:195], v10 offset:58368
    ds_read_b128 v[196:199], v10 offset:59392
    ds_read_b128 v[200:203], v10 offset:60416
    ds_read_b128 v[204:207], v11 offset:0
    ds_read_b128 v[208:211], v11 offset:1024
    buffer_load_dwordx4 v6, s[12:15], s67 offen offset:1024 sc1 lds
    ds_read_b128 v[212:215], v11 offset:2048
    ds_read_b128 v[216:219], v11 offset:3072
    ds_read_b128 v[220:223], v11 offset:4096
    ds_read_b128 v[224:227], v11 offset:5120
    ds_read_b128 v[228:231], v11 offset:6144
    buffer_load_dwordx4 v6, s[12:15], s67 offen offset:2048 sc1 lds
    ds_read_b128 v[232:235], v11 offset:7168
    ds_read_b128 v[236:239], v11 offset:8192
    ds_read_b128 v[240:243], v11 offset:9216
    ds_read_b128 v[244:247], v11 offset:10240
    ds_read_b128 v[248:251], v11 offset:11264
    buffer_load_dwordx4 v6, s[12:15], s67 offen offset:3072 sc1 lds
    ds_read_b128 v[252:255], v11 offset:12288
    ds_read_b128 v[148:151], v11 offset:13312
    ds_read_b128 v[152:155], v11 offset:14336
    ds_read_b128 v[156:159], v11 offset:15360
    ds_read_b128 v[160:163], v11 offset:16384
    s_add_u32 m0, s59, 45056
    s_add_u32 s67, s58, 12914688
    buffer_load_dwordx4 v6, s[12:15], s67 offen offset:0 sc1 lds
    ds_read_b128 v[164:167], v11 offset:17408
    ds_read_b128 v[168:171], v11 offset:18432
    ds_read_b128 v[112:115], v11 offset:19456
    ds_read_b128 v[116:119], v11 offset:20480
    ds_read_b128 v[120:123], v11 offset:21504
    s_add_u32 m0, s59, 61440
    s_add_u32 s67, s58, 13074432
    buffer_load_dwordx4 v6, s[12:15], s67 offen offset:0 sc1 lds
    ds_read_b128 v[124:127], v11 offset:22528
    ds_read_b128 v[128:131], v11 offset:23552
    ds_read_b128 v[132:135], v11 offset:24576
    s_lshr_b32 s70, s49, 1
    s_add_u32 s71, s49, 1
    s_lshr_b32 s71, s71, 1
    s_max_i32 s70, s70, 0
    s_min_i32 s71, s71, 7
    s_sub_u32 s71, s71, s70
    s_add_u32 s71, s71, 1
    s_bfm_b32 s74, s71, s70
    s_mul_i32 s74, s74, 0x01010101
    s_mov_b32 s75, s74
    s_lshl_b32 s66, s49, 8
    s_add_u32 s66, s66, s50
    s_add_u32 s66, s66, 368832
    s_mul_i32 s72, s48, 640
    s_add_u32 s72, s72, 15360
    s_lshr_b32 s73, s46, 1
    s_mul_i32 s73, s73, 768
    s_add_u32 s73, s73, 20480
    buffer_load_dwordx2 v[84:85], v8, s[12:15], s72 offen offset:0 sc1
    buffer_load_dwordx2 v[86:87], v8, s[12:15], s72 offen offset:512 sc1
    buffer_load_dwordx2 v[88:89], v8, s[12:15], s73 offen offset:0 sc1
    buffer_load_dwordx2 v[90:91], v8, s[12:15], s73 offen offset:512 sc1
    s_mov_b64 exec, s[74:75]
    s_mov_b32 s56, 0
L_sp_52:
    buffer_load_dwordx2 v[48:49], v8, s[12:15], s53 offen sc1
    s_add_u32 s56, s56, 1
    s_waitcnt vmcnt(0)
    v_min_u32 v48, v48, v49
    v_cmp_gt_u32 vcc, 3, v48
    s_cmp_gt_u32 s56, 200000
    s_cbranch_scc1 L_spo_53
    s_cbranch_vccnz L_sp_52
L_spo_53:
    s_mov_b64 exec, -1
    buffer_load_dwordx4 a[0:3], v3, s[12:15], s66 offen offset:64 sc1
    s_add_u32 s66, s66, 18432
    buffer_load_dwordx4 a[4:7], v3, s[12:15], s66 offen offset:64 sc1
    s_add_u32 s66, s66, 18432
    buffer_load_dwordx4 a[8:11], v3, s[12:15], s66 offen offset:64 sc1
    s_add_u32 s66, s66, 18432
    buffer_load_dwordx4 a[12:15], v3, s[12:15], s66 offen offset:64 sc1
    s_add_u32 s66, s66, 18432
    buffer_load_dwordx4 a[16:19], v3, s[12:15], s66 offen offset:64 sc1
    s_add_u32 s66, s66, 18432
    buffer_load_dwordx4 a[20:23], v3, s[12:15], s66 offen offset:64 sc1
    s_add_u32 s66, s66, 18432
    buffer_load_dwordx4 a[24:27], v3, s[12:15], s66 offen offset:64 sc1
    s_add_u32 s66, s66, 18432
    buffer_load_dwordx4 a[28:31], v3, s[12:15], s66 offen offset:64 sc1
    s_add_u32 s66, s66, 18432
    s_waitcnt vmcnt(7)
    v_mfma_f32_16x16x32_bf16 v[64:67], a[48:51], a[0:3], 0
    buffer_load_dwordx4 a[32:35], v3, s[12:15], s66 offen offset:64 sc1
    ds_read_b128 a[48:51], v11 offset:25600
    v_mfma_f32_16x16x32_bf16 v[68:71], a[52:55], a[0:3], 0
    s_add_u32 s66, s66, 18432
    ds_read_b128 a[52:55], v11 offset:26624
    v_mfma_f32_16x16x32_bf16 v[72:75], a[56:59], a[0:3], 0
    ds_read_b128 a[56:59], v11 offset:27648
    v_mfma_f32_16x16x32_bf16 v[76:79], a[60:63], a[0:3], 0
    ds_read_b128 a[60:63], v11 offset:28672
    v_mfma_f32_16x16x32_bf16 v[80:83], a[64:67], a[0:3], 0
    ds_read_b128 a[64:67], v11 offset:29696
    s_waitcnt vmcnt(7)
    v_mfma_f32_16x16x32_bf16 v[64:67], a[68:71], a[4:7], v[64:67]
    buffer_load_dwordx4 a[36:39], v3, s[12:15], s66 offen offset:64 sc1
    ds_read_b128 a[68:71], v11 offset:30720
    v_mfma_f32_16x16x32_bf16 v[68:71], a[72:75], a[4:7], v[68:71]
    s_add_u32 s66, s66, 18432
    ds_read_b128 a[72:75], v11 offset:31744
    v_mfma_f32_16x16x32_bf16 v[72:75], a[76:79], a[4:7], v[72:75]
    ds_read_b128 a[76:79], v11 offset:32768
    v_mfma_f32_16x16x32_bf16 v[76:79], a[80:83], a[4:7], v[76:79]
    ds_read_b128 a[80:83], v11 offset:33792
    v_mfma_f32_16x16x32_bf16 v[80:83], a[84:87], a[4:7], v[80:83]
    ds_read_b128 a[84:87], v11 offset:34816
    s_waitcnt vmcnt(7)
    v_mfma_f32_16x16x32_bf16 v[64:67], a[88:91], a[8:11], v[64:67]
    buffer_load_dwordx4 a[0:3], v3, s[12:15], s66 offen offset:64 sc1
    ds_read_b128 a[88:91], v11 offset:35840
    v_mfma_f32_16x16x32_bf16 v[68:71], a[92:95], a[8:11], v[68:71]
    s_add_u32 s66, s66, 18432
    ds_read_b128 a[92:95], v11 offset:36864
    v_mfma_f32_16x16x32_bf16 v[72:75], a[96:99], a[8:11], v[72:75]
    ds_read_b128 a[96:99], v11 offset:37888
    v_mfma_f32_16x16x32_bf16 v[76:79], a[100:103], a[8:11], v[76:79]
    ds_read_b128 a[100:103], v11 offset:38912
    v_mfma_f32_16x16x32_bf16 v[80:83], a[104:107], a[8:11], v[80:83]
    ds_read_b128 a[104:107], v11 offset:39936
    s_waitcnt vmcnt(7)
    v_mfma_f32_16x16x32_bf16 v[64:67], a[108:111], a[12:15], v[64:67]
    buffer_load_dwordx4 a[4:7], v3, s[12:15], s66 offen offset:64 sc1
    v_mfma_f32_16x16x32_bf16 v[68:71], a[112:115], a[12:15], v[68:71]
    s_add_u32 s66, s66, 18432
    v_mfma_f32_16x16x32_bf16 v[72:75], a[116:119], a[12:15], v[72:75]
    v_mfma_f32_16x16x32_bf16 v[76:79], a[120:123], a[12:15], v[76:79]
    v_mfma_f32_16x16x32_bf16 v[80:83], a[124:127], a[12:15], v[80:83]
    s_waitcnt vmcnt(7)
    v_mfma_f32_16x16x32_bf16 v[64:67], a[128:131], a[16:19], v[64:67]
    buffer_load_dwordx4 a[8:11], v3, s[12:15], s66 offen offset:64 sc1
    v_mfma_f32_16x16x32_bf16 v[68:71], a[132:135], a[16:19], v[68:71]
    s_add_u32 s66, s66, 18432
    v_mfma_f32_16x16x32_bf16 v[72:75], a[136:139], a[16:19], v[72:75]
    v_mfma_f32_16x16x32_bf16 v[76:79], a[140:143], a[16:19], v[76:79]
    v_mfma_f32_16x16x32_bf16 v[80:83], a[144:147], a[16:19], v[80:83]
    s_waitcnt vmcnt(7)
    v_mfma_f32_16x16x32_bf16 v[64:67], a[148:151], a[20:23], v[64:67]
    buffer_load_dwordx4 a[12:15], v3, s[12:15], s66 offen offset:64 sc1
    v_mfma_f32_16x16x32_bf16 v[68:71], a[152:155], a[20:23], v[68:71]
    s_add_u32 s66, s66, 18432
    v_mfma_f32_16x16x32_bf16 v[72:75], a[156:159], a[20:23], v[72:75]
    v_mfma_f32_16x16x32_bf16 v[76:79], a[160:163], a[20:23], v[76:79]
    v_mfma_f32_16x16x32_bf16 v[80:83], a[164:167], a[20:23], v[80:83]
    s_waitcnt lgkmcnt(0)
    s_barrier
    s_waitcnt vmcnt(7)
    v_mfma_f32_16x16x32_bf16 v[64:67], a[168:171], a[24:27], v[64:67]
    buffer_load_dwordx4 a[16:19], v3, s[12:15], s66 offen offset:64 sc1
    ds_read_b128 a[108:111], v6 offset:0
    v_mfma_f32_16x16x32_bf16 v[68:71], a[172:175], a[24:27], v[68:71]
    s_add_u32 s66, s66, 18432
    ds_read_b128 a[112:115], v6 offset:1024
    v_mfma_f32_16x16x32_bf16 v[72:75], a[176:179], a[24:27], v[72:75]
    ds_read_b128 a[116:119], v6 offset:2048
    v_mfma_f32_16x16x32_bf16 v[76:79], a[180:183], a[24:27], v[76:79]
    ds_read_b128 a[120:123], v6 offset:3072
    v_mfma_f32_16x16x32_bf16 v[80:83], a[184:187], a[24:27], v[80:83]
    ds_read_b128 a[124:127], v6 offset:4096
    s_waitcnt vmcnt(7)
    v_mfma_f32_16x16x32_bf16 v[64:67], a[188:191], a[28:31], v[64:67]
    buffer_load_dwordx4 a[20:23], v3, s[12:15], s66 offen offset:64 sc1
    ds_read_b128 a[128:131], v6 offset:5120
    v_mfma_f32_16x16x32_bf16 v[68:71], a[192:195], a[28:31], v[68:71]
    s_add_u32 s66, s66, 18432
    ds_read_b128 a[132:135], v6 offset:6144
    v_mfma_f32_16x16x32_bf16 v[72:75], a[196:199], a[28:31], v[72:75]
    ds_read_b128 a[136:139], v6 offset:7168
    v_mfma_f32_16x16x32_bf16 v[76:79], a[200:203], a[28:31], v[76:79]
    ds_read_b128 a[140:143], v6 offset:8192
    v_mfma_f32_16x16x32_bf16 v[80:83], a[204:207], a[28:31], v[80:83]
    ds_read_b128 a[144:147], v6 offset:9216
    s_waitcnt vmcnt(7)
    v_mfma_f32_16x16x32_bf16 v[64:67], a[208:211], a[32:35], v[64:67]
    buffer_load_dwordx4 a[24:27], v3, s[12:15], s66 offen offset:64 sc1
    ds_read_b128 a[148:151], v6 offset:10240
    v_mfma_f32_16x16x32_bf16 v[68:71], a[212:215], a[32:35], v[68:71]
    s_add_u32 s66, s66, 18432
    ds_read_b128 a[152:155], v6 offset:11264
    v_mfma_f32_16x16x32_bf16 v[72:75], a[216:219], a[32:35], v[72:75]
    ds_read_b128 a[156:159], v6 offset:12288
    v_mfma_f32_16x16x32_bf16 v[76:79], a[220:223], a[32:35], v[76:79]
    ds_read_b128 a[160:163], v6 offset:13312
    v_mfma_f32_16x16x32_bf16 v[80:83], a[224:227], a[32:35], v[80:83]
    ds_read_b128 a[164:167], v6 offset:14336
    s_waitcnt vmcnt(7)
    v_mfma_f32_16x16x32_bf16 v[64:67], a[228:231], a[36:39], v[64:67]
    buffer_load_dwordx4 a[28:31], v3, s[12:15], s66 offen offset:64 sc1
    ds_read_b128 a[168:171], v6 offset:15360
    v_mfma_f32_16x16x32_bf16 v[68:71], a[232:235], a[36:39], v[68:71]
    s_add_u32 s66, s66, 18432
    ds_read_b128 a[172:175], v6 offset:16384
    v_mfma_f32_16x16x32_bf16 v[72:75], a[236:239], a[36:39], v[72:75]
    ds_read_b128 a[176:179], v6 offset:17408
    v_mfma_f32_16x16x32_bf16 v[76:79], a[240:243], a[36:39], v[76:79]
    ds_read_b128 a[180:183], v6 offset:18432
    v_mfma_f32_16x16x32_bf16 v[80:83], a[244:247], a[36:39], v[80:83]
    ds_read_b128 a[184:187], v6 offset:19456
    s_waitcnt vmcnt(7)
    v_mfma_f32_16x16x32_bf16 v[64:67], a[248:251], a[0:3], v[64:67]
    buffer_load_dwordx4 a[32:35], v3, s[12:15], s66 offen offset:64 sc1
    ds_read_b128 a[188:191], v6 offset:20480
    v_mfma_f32_16x16x32_bf16 v[68:71], a[252:255], a[0:3], v[68:71]
    s_add_u32 s66, s66, 18432
    ds_read_b128 a[192:195], v6 offset:21504
    v_mfma_f32_16x16x32_bf16 v[72:75], v[172:175], a[0:3], v[72:75]
    buffer_load_dwordx4 v6, s[12:15], s67 offen offset:1024 sc1 lds
    s_branch L_sk4
L_stub4:
    s_setpc_b64 s[98:99]
L_sk4:
    ds_read_b128 a[196:199], v6 offset:22528
    v_mfma_f32_16x16x32_bf16 v[76:79], v[176:179], a[0:3], v[76:79]
    ds_read_b128 a[200:203], v6 offset:23552
    v_mfma_f32_16x16x32_bf16 v[80:83], v[180:183], a[0:3], v[80:83]
    ds_read_b128 a[204:207], v6 offset:24576
    s_waitcnt vmcnt(8)
    v_mfma_f32_16x16x32_bf16 v[64:67], v[184:187], a[4:7], v[64:67]
    buffer_load_dwordx4 a[36:39], v3, s[12:15], s66 offen offset:64 sc1
    ds_read_b128 a[208:211], v6 offset:25600
    v_mfma_f32_16x16x32_bf16 v[68:71], v[188:191], a[4:7], v[68:71]
    ds_read_b128 a[212:215], v6 offset:26624
    v_mfma_f32_16x16x32_bf16 v[72:75], v[192:195], a[4:7], v[72:75]
    buffer_load_dwordx4 v6, s[12:15], s67 offen offset:2048 sc1 lds
    ds_read_b128 a[216:219], v6 offset:27648
    v_mfma_f32_16x16x32_bf16 v[76:79], v[196:199], a[4:7], v[76:79]
    ds_read_b128 a[220:223], v6 offset:28672
    v_mfma_f32_16x16x32_bf16 v[80:83], v[200:203], a[4:7], v[80:83]
    ds_read_b128 a[224:227], v6 offset:29696
    s_waitcnt vmcnt(9)
    v_mfma_f32_16x16x32_bf16 v[64:67], v[204:207], a[8:11], v[64:67]
    ds_read_b128 a[228:231], v6 offset:30720
    v_mfma_f32_16x16x32_bf16 v[68:71], v[208:211], a[8:11], v[68:71]
    ds_read_b128 a[232:235], v6 offset:31744
    v_mfma_f32_16x16x32_bf16 v[72:75], v[212:215], a[8:11], v[72:75]
    buffer_load_dwordx4 v6, s[12:15], s67 offen offset:3072 sc1 lds
    ds_read_b128 a[236:239], v6 offset:32768
    v_mfma_f32_16x16x32_bf16 v[76:79], v[216:219], a[8:11], v[76:79]
    ds_read_b128 a[240:243], v6 offset:33792
    v_mfma_f32_16x16x32_bf16 v[80:83], v[220:223], a[8:11], v[80:83]
    ds_read_b128 a[244:247], v6 offset:34816
    s_waitcnt vmcnt(9)
    v_mfma_f32_16x16x32_bf16 v[64:67], v[224:227], a[12:15], v[64:67]
    ds_read_b128 a[248:251], v6 offset:35840
    v_mfma_f32_16x16x32_bf16 v[68:71], v[228:231], a[12:15], v[68:71]
    ds_read_b128 a[252:255], v6 offset:36864
    v_mfma_f32_16x16x32_bf16 v[72:75], v[232:235], a[12:15], v[72:75]
    s_add_u32 m0, s59, 65536
    s_add_u32 s67, s58, 13078528
    buffer_load_dwordx4 v6, s[12:15], s67 offen offset:0 sc1 lds
    ds_read_b128 v[172:175], v6 offset:37888
    v_mfma_f32_16x16x32_bf16 v[76:79], v[236:239], a[12:15], v[76:79]
    ds_read_b128 v[176:179], v6 offset:38912
    v_mfma_f32_16x16x32_bf16 v[80:83], v[240:243], a[12:15], v[80:83]
    ds_read_b128 v[180:183], v6 offset:39936
    s_waitcnt vmcnt(9)
    v_mfma_f32_16x16x32_bf16 v[64:67], v[244:247], a[16:19], v[64:67]
    ds_read_b128 v[184:187], v6 offset:40960
    v_mfma_f32_16x16x32_bf16 v[68:71], v[248:251], a[16:19], v[68:71]
    ds_read_b128 v[188:191], v6 offset:41984
    v_mfma_f32_16x16x32_bf16 v[72:75], v[252:255], a[16:19], v[72:75]
    s_add_u32 m0, s59, 81920
    s_add_u32 s67, s58, 13238272
    buffer_load_dwordx4 v6, s[12:15], s67 offen offset:0 sc1 lds
    ds_read_b128 v[192:195], v6 offset:43008
    v_mfma_f32_16x16x32_bf16 v[76:79], v[148:151], a[16:19], v[76:79]
    ds_read_b128 v[196:199], v6 offset:44032
    v_mfma_f32_16x16x32_bf16 v[80:83], v[152:155], a[16:19], v[80:83]
    ds_read_b128 v[200:203], v6 offset:45056
    s_waitcnt vmcnt(9)
    v_mfma_f32_16x16x32_bf16 v[64:67], v[156:159], a[20:23], v[64:67]
    ds_read_b128 v[204:207], v6 offset:46080
    v_mfma_f32_16x16x32_bf16 v[68:71], v[160:163], a[20:23], v[68:71]
    ds_read_b128 v[208:211], v6 offset:47104
    v_mfma_f32_16x16x32_bf16 v[72:75], v[164:167], a[20:23], v[72:75]
    buffer_load_dwordx4 v6, s[12:15], s67 offen offset:1024 sc1 lds
    ds_read_b128 v[212:215], v6 offset:48128
    v_mfma_f32_16x16x32_bf16 v[76:79], v[168:171], a[20:23], v[76:79]
    ds_read_b128 v[216:219], v6 offset:49152
    v_mfma_f32_16x16x32_bf16 v[80:83], v[112:115], a[20:23], v[80:83]
    ds_read_b128 v[220:223], v6 offset:50176
    s_waitcnt vmcnt(9)
    v_mfma_f32_16x16x32_bf16 v[64:67], v[116:119], a[24:27], v[64:67]
    ds_read_b128 v[224:227], v6 offset:51200
    v_mfma_f32_16x16x32_bf16 v[68:71], v[120:123], a[24:27], v[68:71]
    ds_read_b128 v[228:231], v6 offset:52224
    v_mfma_f32_16x16x32_bf16 v[72:75], v[124:127], a[24:27], v[72:75]
    buffer_load_dwordx4 v6, s[12:15], s67 offen offset:2048 sc1 lds
    ds_read_b128 v[232:235], v6 offset:53248
    v_mfma_f32_16x16x32_bf16 v[76:79], v[128:131], a[24:27], v[76:79]
    ds_read_b128 v[236:239], v6 offset:54272
    v_mfma_f32_16x16x32_bf16 v[80:83], v[132:135], a[24:27], v[80:83]
    ds_read_b128 v[240:243], v6 offset:55296
    s_waitcnt vmcnt(9)
    v_mfma_f32_16x16x32_bf16 v[64:67], a[48:51], a[28:31], v[64:67]
    ds_read_b128 v[244:247], v6 offset:56320
    v_mfma_f32_16x16x32_bf16 v[68:71], a[52:55], a[28:31], v[68:71]
    ds_read_b128 v[248:251], v6 offset:57344
    v_mfma_f32_16x16x32_bf16 v[72:75], a[56:59], a[28:31], v[72:75]
    buffer_load_dwordx4 v6, s[12:15], s67 offen offset:3072 sc1 lds
    ds_read_b128 v[252:255], v6 offset:58368
    v_mfma_f32_16x16x32_bf16 v[76:79], a[60:63], a[28:31], v[76:79]
    ds_read_b128 v[148:151], v6 offset:59392
    v_mfma_f32_16x16x32_bf16 v[80:83], a[64:67], a[28:31], v[80:83]
    ds_read_b128 v[152:155], v6 offset:60416
    s_waitcnt vmcnt(9)
    v_mfma_f32_16x16x32_bf16 v[64:67], a[68:71], a[32:35], v[64:67]
    v_cvt_f32_f64 v110, v[84:85]
    v_mfma_f32_16x16x32_bf16 v[68:71], a[72:75], a[32:35], v[68:71]
    v_cvt_f32_f64 v111, v[86:87]
    v_mfma_f32_16x16x32_bf16 v[72:75], a[76:79], a[32:35], v[72:75]
    s_add_u32 m0, s59, 86016
    s_add_u32 s67, s58, 13242368
    buffer_load_dwordx4 v6, s[12:15], s67 offen offset:0 sc1 lds
    v_cvt_f32_f64 v9, v[88:89]
    v_mfma_f32_16x16x32_bf16 v[76:79], a[80:83], a[32:35], v[76:79]
    v_cvt_f32_f64 v47, v[90:91]
    v_mfma_f32_16x16x32_bf16 v[80:83], a[84:87], a[32:35], v[80:83]
    s_waitcnt vmcnt(8)
    v_mfma_f32_16x16x32_bf16 v[64:67], a[88:91], a[36:39], v[64:67]
    v_mfma_f32_16x16x32_bf16 v[68:71], a[92:95], a[36:39], v[68:71]
    v_mfma_f32_16x16x32_bf16 v[72:75], a[96:99], a[36:39], v[72:75]
    s_add_u32 m0, s59, 102400
    s_add_u32 s67, s58, 13631488
    buffer_load_dwordx4 v6, s[12:15], s67 offen offset:0 sc1 lds
    v_mfma_f32_16x16x32_bf16 v[76:79], a[100:103], a[36:39], v[76:79]
    v_mfma_f32_16x16x32_bf16 v[80:83], a[104:107], a[36:39], v[80:83]
    v_and_b32 v57, 0xffff0000, v20
    v_lshlrev_b32_e64 v56, 16, v20
    v_pk_add_f32 v[64:65], v[64:65], v[56:57]
    v_and_b32 v59, 0xffff0000, v21
    v_lshlrev_b32_e64 v58, 16, v21
    v_pk_add_f32 v[66:67], v[66:67], v[58:59]
    v_and_b32 v61, 0xffff0000, v22
    v_lshlrev_b32_e64 v60, 16, v22
    v_pk_add_f32 v[68:69], v[68:69], v[60:61]
    v_and_b32 v63, 0xffff0000, v23
    v_lshlrev_b32_e64 v62, 16, v23
    v_pk_add_f32 v[70:71], v[70:71], v[62:63]
    v_and_b32 v57, 0xffff0000, v24
    v_lshlrev_b32_e64 v56, 16, v24
    v_pk_add_f32 v[72:73], v[72:73], v[56:57]
    v_and_b32 v59, 0xffff0000, v25
    v_lshlrev_b32_e64 v58, 16, v25
    v_pk_add_f32 v[74:75], v[74:75], v[58:59]
    buffer_load_dwordx4 v6, s[12:15], s67 offen offset:1024 sc1 lds
    v_and_b32 v61, 0xffff0000, v26
    v_lshlrev_b32_e64 v60, 16, v26
    v_pk_add_f32 v[76:77], v[76:77], v[60:61]
    v_and_b32 v63, 0xffff0000, v27
    v_lshlrev_b32_e64 v62, 16, v27
    v_pk_add_f32 v[78:79], v[78:79], v[62:63]
    v_and_b32 v57, 0xffff0000, v28
    v_lshlrev_b32_e64 v56, 16, v28
    v_pk_add_f32 v[80:81], v[80:81], v[56:57]
    v_and_b32 v59, 0xffff0000, v29
    v_lshlrev_b32_e64 v58, 16, v29
    v_pk_add_f32 v[82:83], v[82:83], v[58:59]
    v_cvt_pk_bf16_f32 v64, v64, v65
    v_cvt_pk_bf16_f32 v65, v66, v67
    v_cvt_pk_bf16_f32 v66, v68, v69
    v_cvt_pk_bf16_f32 v67, v70, v71
    v_cvt_pk_bf16_f32 v68, v72, v73
    v_cvt_pk_bf16_f32 v69, v74, v75
    buffer_load_dwordx4 v6, s[12:15], s67 offen offset:2048 sc1 lds
    v_cvt_pk_bf16_f32 v70, v76, v77
    v_cvt_pk_bf16_f32 v71, v78, v79
    v_cvt_pk_bf16_f32 v72, v80, v81
    v_cvt_pk_bf16_f32 v73, v82, v83
    v_add_u32 v50, 737280, v3
    s_cmp_eq_u32 s51, 1
    s_cbranch_scc0 L_alt_54
    s_bitcmp0_b32 s48, 0
    s_cbranch_scc0 L_alt_56
    buffer_store_dwordx4 v[64:67], v50, s[12:15], s63 offen offset:256
    buffer_store_dwordx4 v[68:71], v50, s[12:15], s64 offen offset:256
    buffer_store_dwordx2 v[72:73], v50, s[12:15], s65 offen offset:256
    s_branch L_altd_57
L_alt_56:
    buffer_store_dwordx2 v[64:65], v50, s[12:15], s63 offen offset:264
    buffer_store_dwordx4 v[66:69], v50, s[12:15], s64 offen offset:256
    buffer_store_dwordx4 v[70:73], v50, s[12:15], s65 offen offset:256
L_altd_57:
    s_branch L_altd_55
L_alt_54:
    s_bitcmp0_b32 s48, 0
    s_cbranch_scc0 L_alt_58
    buffer_store_dwordx4 v[64:67], v50, s[12:15], s63 offen offset:256 sc1
    buffer_store_dwordx4 v[68:71], v50, s[12:15], s64 offen offset:256 sc1
    buffer_store_dwordx2 v[72:73], v50, s[12:15], s65 offen offset:256 sc1
    s_branch L_altd_59
L_alt_58:
    buffer_store_dwordx2 v[64:65], v50, s[12:15], s63 offen offset:264 sc1
    buffer_store_dwordx4 v[66:69], v50, s[12:15], s64 offen offset:256 sc1
    buffer_store_dwordx4 v[70:73], v50, s[12:15], s65 offen offset:256 sc1
L_altd_59:
L_altd_55:
    v_and_b32 v21, 0xffff0000, v64
    v_lshlrev_b32 v20, 16, v64
    v_and_b32 v23, 0xffff0000, v65
    v_lshlrev_b32 v22, 16, v65
    v_and_b32 v25, 0xffff0000, v66
    v_lshlrev_b32 v24, 16, v66
    v_and_b32 v27, 0xffff0000, v67
    v_lshlrev_b32 v26, 16, v67
    v_and_b32 v29, 0xffff0000, v68
    v_lshlrev_b32 v28, 16, v68
    v_and_b32 v31, 0xffff0000, v69
    v_lshlrev_b32 v30, 16, v69
    v_and_b32 v33, 0xffff0000, v70
    v_lshlrev_b32 v32, 16, v70
    v_and_b32 v35, 0xffff0000, v71
    v_lshlrev_b32 v34, 16, v71
    v_and_b32 v37, 0xffff0000, v72
    v_lshlrev_b32 v36, 16, v72
    v_and_b32 v39, 0xffff0000, v73
    v_lshlrev_b32_e64 v38, 16, v73
    v_pk_add_f32 v[52:53], v[20:21], v[22:23]
    v_pk_mul_f32 v[54:55], v[20:21], v[20:21]
    v_pk_fma_f32 v[54:55], v[22:23], v[22:23], v[54:55]
    v_pk_add_f32 v[52:53], v[52:53], v[24:25]
    v_pk_fma_f32 v[54:55], v[24:25], v[24:25], v[54:55]
    v_pk_add_f32 v[52:53], v[52:53], v[26:27]
    v_pk_fma_f32 v[54:55], v[26:27], v[26:27], v[54:55]
    v_pk_add_f32 v[52:53], v[52:53], v[28:29]
    v_pk_fma_f32 v[54:55], v[28:29], v[28:29], v[54:55]
    v_pk_add_f32 v[52:53], v[52:53], v[30:31]
    v_pk_fma_f32 v[54:55], v[30:31], v[30:31], v[54:55]
    v_pk_add_f32 v[52:53], v[52:53], v[32:33]
    v_pk_fma_f32 v[54:55], v[32:33], v[32:33], v[54:55]
    v_pk_add_f32 v[52:53], v[52:53], v[34:35]
    v_pk_fma_f32 v[54:55], v[34:35], v[34:35], v[54:55]
    v_pk_add_f32 v[52:53], v[52:53], v[36:37]
    v_pk_fma_f32 v[54:55], v[36:37], v[36:37], v[54:55]
    v_pk_add_f32 v[52:53], v[52:53], v[38:39]
    v_pk_fma_f32 v[54:55], v[38:39], v[38:39], v[54:55]
    v_add_f32 v52, v52, v53
    v_add_f32 v53, v54, v55
    v_mov_b32 v56, v52
    v_mov_b32 v57, v53
    s_nop 0
    v_permlane16_swap_b32 v52, v56
    v_permlane16_swap_b32 v53, v57
    v_add_f32 v52, v52, v56
    v_add_f32 v53, v53, v57
    v_mov_b32 v56, v52
    v_mov_b32 v57, v53
    s_nop 0
    v_permlane32_swap_b32 v52, v56
    v_permlane32_swap_b32 v53, v57
    v_add_f32 v52, v52, v56
    v_add_f32 v53, v53, v57
    s_lshl_b32 s68, s57, 10
    s_lshl_b32 s69, s48, 3
    s_add_u32 s68, s68, s69
    s_add_u32 s68, s68, 262144
    s_mov_b64 exec, 0xffff
    s_cmp_eq_u32 s51, 1
    s_cbranch_scc0 L_alt_60
    buffer_store_dwordx2 v[52:53], v12, s[12:15], s68 offen
    s_branch L_altd_61
L_alt_60:
    buffer_store_dwordx2 v[52:53], v12, s[12:15], s68 offen sc1
L_altd_61:
    s_mov_b64 exec, -1
    s_waitcnt vmcnt(0)
    v_mov_b32 v48, 4
    v_mov_b32 v49, 0
    s_mov_b64 exec, 1
    s_cmp_eq_u32 s51, 1
    s_cbranch_scc0 L_alt_62
    buffer_store_dword v48, v49, s[12:15], s52 offen
    s_branch L_altd_63
L_alt_62:
    buffer_store_dword v48, v49, s[12:15], s52 offen sc1
L_altd_63:
    s_mov_b64 exec, -1
    s_sub_u32 s70, s49, 1
    s_ashr_i32 s70, s70, 1
    s_add_u32 s71, s49, 1
    s_lshr_b32 s71, s71, 1
    s_max_i32 s70, s70, 0
    s_min_i32 s71, s71, 7
    s_sub_u32 s71, s71, s70
    s_add_u32 s71, s71, 1
    s_bfm_b32 s74, s71, s70
    s_mul_i32 s74, s74, 0x01010101
    s_mov_b32 s75, s74
    s_lshr_b32 s70, s48, 2
    s_add_u32 s70, s70, 1
    s_sub_u32 s71, 0, s70
    s_bitcmp1_b32 s48, 1
    s_cselect_b32 s70, s71, s70
    s_lshl_b32 s71, s49, 4
    s_add_u32 s71, s71, s70
    v_add_u32 v48, s71, v2
    s_lshl_b32 s70, s70, 4
    s_add_u32 s70, s70, 368640
    v_add_u32 v108, s70, v3
    v_mov_b32 v49, 1073741824
    s_movk_i32 s71, 256
    v_cmp_gt_u32 vcc, s71, v48
    s_nop 1
    v_cndmask_b32 v108, v49, v108, vcc
    s_waitcnt lgkmcnt(0)
    s_barrier
    buffer_load_dwordx4 v6, s[12:15], s67 offen offset:3072 sc1 lds
    s_add_u32 m0, s59, 106496
    s_add_u32 s67, s58, 13635584
    buffer_load_dwordx4 v6, s[12:15], s67 offen offset:0 sc1 lds
    s_add_u32 s68, s59, 0
    v_lshl_add_u32 v56, v0, 2, s68
    v_lshl_add_u32 v57, v1, 4, s68
    ds_write_b32 v56, v110 offset:0
    ds_write_b32 v56, v111 offset:256
    s_waitcnt lgkmcnt(0)
    ds_read_b128 v[84:87], v57 offset:0
    ds_read_b128 v[88:91], v57 offset:64
    ds_read_b128 v[92:95], v57 offset:128
    ds_read_b128 v[96:99], v57 offset:192
    ds_read_b128 v[100:103], v57 offset:256
    ds_read_b128 v[156:159], v10 offset:0
    ds_read_b128 v[160:163], v10 offset:1024
    s_add_u32 m0, s59, 122880
    s_add_u32 s67, s58, 13795328
    buffer_load_dwordx4 v6, s[12:15], s67 offen offset:0 sc1 lds
    ds_read_b128 v[164:167], v10 offset:2048
    ds_read_b128 v[168:171], v10 offset:3072
    buffer_load_dwordx4 v6, s[12:15], s67 offen offset:1024 sc1 lds
    ds_read_b128 v[112:115], v10 offset:4096
    ds_read_b128 v[116:119], v10 offset:5120
    buffer_load_dwordx4 v6, s[12:15], s67 offen offset:2048 sc1 lds
    ds_read_b128 v[120:123], v10 offset:6144
    ds_read_b128 v[124:127], v10 offset:7168
    buffer_load_dwordx4 v6, s[12:15], s67 offen offset:3072 sc1 lds
    ds_read_b128 v[128:131], v10 offset:8192
    ds_read_b128 v[132:135], v10 offset:9216
    s_add_u32 m0, s59, 126976
    s_add_u32 s67, s58, 13799424
    buffer_load_dwordx4 v6, s[12:15], s67 offen offset:0 sc1 lds
    ds_read_b128 a[48:51], v10 offset:10240
    ds_read_b128 a[52:55], v10 offset:11264
    s_add_u32 m0, s59, 143360
    s_add_u32 s67, s58, 13959168
    buffer_load_dwordx4 v6, s[12:15], s67 offen offset:0 sc1 lds
    ds_read_b128 a[56:59], v10 offset:12288
    ds_read_b128 a[60:63], v10 offset:13312
    buffer_load_dwordx4 v6, s[12:15], s67 offen offset:1024 sc1 lds
    ds_read_b128 a[64:67], v10 offset:14336
    ds_read_b128 a[68:71], v10 offset:15360
    buffer_load_dwordx4 v6, s[12:15], s67 offen offset:2048 sc1 lds
    ds_read_b128 a[72:75], v10 offset:16384
    ds_read_b128 a[76:79], v10 offset:17408
    buffer_load_dwordx4 v6, s[12:15], s67 offen offset:3072 sc1 lds
    ds_read_b128 a[80:83], v10 offset:18432
    ds_read_b128 a[84:87], v10 offset:19456
    s_add_u32 m0, s59, 147456
    s_add_u32 s67, s58, 13963264
    buffer_load_dwordx4 v6, s[12:15], s67 offen offset:0 sc1 lds
    ds_read_b128 a[88:91], v10 offset:20480
    ds_read_b128 a[92:95], v10 offset:21504
    ds_read_b128 a[96:99], v10 offset:22528
    ds_read_b128 a[100:103], v10 offset:23552
    ds_read_b128 a[104:107], v10 offset:24576
    s_waitcnt lgkmcnt(15)
    s_lshl_b32 s66, s49, 8
    s_add_u32 s66, s66, s50
    s_add_u32 s66, s66, 737472
    s_lshl_b32 s72, s57, 10
    s_add_u32 s72, s72, 262144
    s_mov_b32 s82, 0xbdd2d3e8
    s_mov_b32 s83, 0xbdd2d3e8
    v_mov_b32 v54, 0xc0135761
    s_mov_b64 exec, s[74:75]
    s_mov_b32 s56, 0
L_sp_64:
    buffer_load_dwordx2 v[48:49], v8, s[12:15], s53 offen sc1
    s_add_u32 s56, s56, 1
    s_waitcnt vmcnt(0)
    v_min_u32 v48, v48, v49
    v_cmp_gt_u32 vcc, 4, v48
    s_cmp_gt_u32 s56, 200000
    s_cbranch_scc1 L_spo_65
    s_cbranch_vccnz L_sp_64
L_spo_65:
    s_mov_b64 exec, -1
    buffer_load_dwordx4 a[0:3], v3, s[12:15], s66 offen offset:64 sc1
    s_add_u32 s66, s66, 18432
    buffer_load_dwordx4 a[4:7], v3, s[12:15], s66 offen offset:64 sc1
    s_add_u32 s66, s66, 18432
    buffer_load_dwordx4 a[8:11], v3, s[12:15], s66 offen offset:64 sc1
    s_add_u32 s66, s66, 18432
    buffer_load_dwordx4 a[12:15], v3, s[12:15], s66 offen offset:64 sc1
    s_add_u32 s66, s66, 18432
    buffer_load_dwordx4 a[16:19], v3, s[12:15], s66 offen offset:64 sc1
    s_add_u32 s66, s66, 18432
    buffer_load_dwordx4 a[20:23], v3, s[12:15], s66 offen offset:64 sc1
    s_add_u32 s66, s66, 18432
    buffer_load_dwordx4 a[24:27], v3, s[12:15], s66 offen offset:64 sc1
    s_add_u32 s66, s66, 18432
    buffer_load_dwordx4 a[28:31], v3, s[12:15], s66 offen offset:64 sc1
    s_add_u32 s66, s66, 18432
    buffer_load_dwordx4 v[136:139], v12, s[12:15], s72 offen sc1
    s_waitcnt vmcnt(8)
    v_mfma_f32_16x16x32_bf16 v[64:67], a[108:111], a[0:3], 0
    buffer_load_dwordx4 a[32:35], v3, s[12:15], s66 offen offset:64 sc1
    ds_read_b128 a[108:111], v10 offset:25600
    v_mfma_f32_16x16x32_bf16 v[68:71], a[112:115], a[0:3], 0
    s_add_u32 s66, s66, 18432
    ds_read_b128 a[112:115], v10 offset:26624
    v_mfma_f32_16x16x32_bf16 v[72:75], a[116:119], a[0:3], 0
    ds_read_b128 a[116:119], v10 offset:27648
    v_mfma_f32_16x16x32_bf16 v[76:79], a[120:123], a[0:3], 0
    ds_read_b128 a[120:123], v10 offset:28672
    v_mfma_f32_16x16x32_bf16 v[80:83], a[124:127], a[0:3], 0
    ds_read_b128 a[124:127], v10 offset:29696
    s_waitcnt vmcnt(8)
    v_mfma_f32_16x16x32_bf16 v[64:67], a[128:131], a[4:7], v[64:67]
    buffer_load_dwordx4 a[36:39], v3, s[12:15], s66 offen offset:64 sc1
    ds_read_b128 a[128:131], v10 offset:30720
    v_mfma_f32_16x16x32_bf16 v[68:71], a[132:135], a[4:7], v[68:71]
    s_add_u32 s66, s66, 18432
    ds_read_b128 a[132:135], v10 offset:31744
    v_mfma_f32_16x16x32_bf16 v[72:75], a[136:139], a[4:7], v[72:75]
    ds_read_b128 a[136:139], v10 offset:32768
    v_mfma_f32_16x16x32_bf16 v[76:79], a[140:143], a[4:7], v[76:79]
    ds_read_b128 a[140:143], v10 offset:33792
    v_mfma_f32_16x16x32_bf16 v[80:83], a[144:147], a[4:7], v[80:83]
    ds_read_b128 a[144:147], v10 offset:34816
    s_waitcnt vmcnt(8)
    v_mfma_f32_16x16x32_bf16 v[64:67], a[148:151], a[8:11], v[64:67]
    buffer_load_dwordx4 a[0:3], v3, s[12:15], s66 offen offset:64 sc1
    ds_read_b128 a[148:151], v10 offset:35840
    v_mfma_f32_16x16x32_bf16 v[68:71], a[152:155], a[8:11], v[68:71]
    s_add_u32 s66, s66, 18432
    ds_read_b128 a[152:155], v10 offset:36864
    v_mfma_f32_16x16x32_bf16 v[72:75], a[156:159], a[8:11], v[72:75]
    ds_read_b128 a[156:159], v10 offset:37888
    v_mfma_f32_16x16x32_bf16 v[76:79], a[160:163], a[8:11], v[76:79]
    ds_read_b128 a[160:163], v10 offset:38912
    v_mfma_f32_16x16x32_bf16 v[80:83], a[164:167], a[8:11], v[80:83]
    ds_read_b128 a[164:167], v10 offset:39936
    s_waitcnt vmcnt(8)
    v_mfma_f32_16x16x32_bf16 v[64:67], a[168:171], a[12:15], v[64:67]
    buffer_load_dwordx4 a[4:7], v3, s[12:15], s66 offen offset:64 sc1
    v_mfma_f32_16x16x32_bf16 v[68:71], a[172:175], a[12:15], v[68:71]
    s_add_u32 s66, s66, 18432
    v_mfma_f32_16x16x32_bf16 v[72:75], a[176:179], a[12:15], v[72:75]
    v_mfma_f32_16x16x32_bf16 v[76:79], a[180:183], a[12:15], v[76:79]
    v_mfma_f32_16x16x32_bf16 v[80:83], a[184:187], a[12:15], v[80:83]
    s_waitcnt vmcnt(8)
    v_mfma_f32_16x16x32_bf16 v[64:67], a[188:191], a[16:19], v[64:67]
    buffer_load_dwordx4 a[8:11], v3, s[12:15], s66 offen offset:64 sc1
    v_mfma_f32_16x16x32_bf16 v[68:71], a[192:195], a[16:19], v[68:71]
    s_add_u32 s66, s66, 18432
    v_mfma_f32_16x16x32_bf16 v[72:75], a[196:199], a[16:19], v[72:75]
    v_mfma_f32_16x16x32_bf16 v[76:79], a[200:203], a[16:19], v[76:79]
    v_mfma_f32_16x16x32_bf16 v[80:83], a[204:207], a[16:19], v[80:83]
    s_waitcnt vmcnt(8)
    v_mfma_f32_16x16x32_bf16 v[64:67], a[208:211], a[20:23], v[64:67]
    buffer_load_dwordx4 a[12:15], v3, s[12:15], s66 offen offset:64 sc1
    v_mfma_f32_16x16x32_bf16 v[68:71], a[212:215], a[20:23], v[68:71]
    s_add_u32 s66, s66, 18432
    v_mfma_f32_16x16x32_bf16 v[72:75], a[216:219], a[20:23], v[72:75]
    v_mfma_f32_16x16x32_bf16 v[76:79], a[220:223], a[20:23], v[76:79]
    v_mfma_f32_16x16x32_bf16 v[80:83], a[224:227], a[20:23], v[80:83]
    s_waitcnt lgkmcnt(0)
    s_barrier
    s_waitcnt vmcnt(8)
    v_mfma_f32_16x16x32_bf16 v[64:67], a[228:231], a[24:27], v[64:67]
    buffer_load_dwordx4 a[16:19], v3, s[12:15], s66 offen offset:64 sc1
    ds_read_b128 a[168:171], v10 offset:40960
    v_mfma_f32_16x16x32_bf16 v[68:71], a[232:235], a[24:27], v[68:71]
    s_add_u32 s66, s66, 18432
    ds_read_b128 a[172:175], v10 offset:41984
    v_mfma_f32_16x16x32_bf16 v[72:75], a[236:239], a[24:27], v[72:75]
    ds_read_b128 a[176:179], v10 offset:43008
    v_mfma_f32_16x16x32_bf16 v[76:79], a[240:243], a[24:27], v[76:79]
    ds_read_b128 a[180:183], v10 offset:44032
    v_mfma_f32_16x16x32_bf16 v[80:83], a[244:247], a[24:27], v[80:83]
    ds_read_b128 a[184:187], v10 offset:45056
    s_waitcnt vmcnt(7)
    v_mfma_f32_16x16x32_bf16 v[64:67], a[248:251], a[28:31], v[64:67]
    buffer_load_dwordx4 a[20:23], v3, s[12:15], s66 offen offset:64 sc1
    ds_read_b128 a[188:191], v10 offset:46080
    v_mfma_f32_16x16x32_bf16 v[68:71], a[252:255], a[28:31], v[68:71]
    s_add_u32 s66, s66, 18432
    ds_read_b128 a[192:195], v10 offset:47104
    v_mfma_f32_16x16x32_bf16 v[72:75], v[172:175], a[28:31], v[72:75]
    ds_read_b128 a[196:199], v10 offset:48128
    v_mfma_f32_16x16x32_bf16 v[76:79], v[176:179], a[28:31], v[76:79]
    ds_read_b128 a[200:203], v10 offset:49152
    v_mfma_f32_16x16x32_bf16 v[80:83], v[180:183], a[28:31], v[80:83]
    ds_read_b128 a[204:207], v10 offset:50176
    s_waitcnt vmcnt(7)
    v_mfma_f32_16x16x32_bf16 v[64:67], v[184:187], a[32:35], v[64:67]
    buffer_load_dwordx4 a[24:27], v3, s[12:15], s66 offen offset:64 sc1
    ds_read_b128 a[208:211], v10 offset:51200
    v_mfma_f32_16x16x32_bf16 v[68:71], v[188:191], a[32:35], v[68:71]
    s_add_u32 s66, s66, 18432
    ds_read_b128 a[212:215], v10 offset:52224
    v_mfma_f32_16x16x32_bf16 v[72:75], v[192:195], a[32:35], v[72:75]
    ds_read_b128 a[216:219], v10 offset:53248
    v_mfma_f32_16x16x32_bf16 v[76:79], v[196:199], a[32:35], v[76:79]
    ds_read_b128 a[220:223], v10 offset:54272
    v_mfma_f32_16x16x32_bf16 v[80:83], v[200:203], a[32:35], v[80:83]
    ds_read_b128 a[224:227], v10 offset:55296
    s_waitcnt vmcnt(7)
    v_mfma_f32_16x16x32_bf16 v[64:67], v[204:207], a[36:39], v[64:67]
    buffer_load_dwordx4 a[28:31], v3, s[12:15], s66 offen offset:64 sc1
    ds_read_b128 a[228:231], v10 offset:56320
    v_mfma_f32_16x16x32_bf16 v[68:71], v[208:211], a[36:39], v[68:71]
    s_add_u32 s66, s66, 18432
    ds_read_b128 a[232:235], v10 offset:57344
    v_mfma_f32_16x16x32_bf16 v[72:75], v[212:215], a[36:39], v[72:75]
    ds_read_b128 a[236:239], v10 offset:58368
    v_mfma_f32_16x16x32_bf16 v[76:79], v[216:219], a[36:39], v[76:79]
    ds_read_b128 a[240:243], v10 offset:59392
    v_mfma_f32_16x16x32_bf16 v[80:83], v[220:223], a[36:39], v[80:83]
    ds_read_b128 a[244:247], v10 offset:60416
    s_waitcnt vmcnt(7)
    v_mfma_f32_16x16x32_bf16 v[64:67], v[224:227], a[0:3], v[64:67]
    buffer_load_dwordx4 a[32:35], v3, s[12:15], s66 offen offset:64 sc1
    ds_read_b128 a[248:251], v11 offset:0
    v_mfma_f32_16x16x32_bf16 v[68:71], v[228:231], a[0:3], v[68:71]
    s_add_u32 s66, s66, 18432
    ds_read_b128 a[252:255], v11 offset:1024
    v_mfma_f32_16x16x32_bf16 v[72:75], v[232:235], a[0:3], v[72:75]
    s_add_u32 m0, s59, 0
    s_add_u32 s67, s58, 14123008
    buffer_load_dwordx4 v6, s[12:15], s67 offen offset:0 sc1 lds
    ds_read_b128 v[172:175], v11 offset:2048
    v_mfma_f32_16x16x32_bf16 v[76:79], v[236:239], a[0:3], v[76:79]
    ds_read_b128 v[176:179], v11 offset:3072
    v_mfma_f32_16x16x32_bf16 v[80:83], v[240:243], a[0:3], v[80:83]
    ds_read_b128 v[180:183], v11 offset:4096
    s_waitcnt vmcnt(8)
    v_mfma_f32_16x16x32_bf16 v[64:67], v[244:247], a[4:7], v[64:67]
    buffer_load_dwordx4 a[36:39], v3, s[12:15], s66 offen offset:64 sc1
    ds_read_b128 v[184:187], v11 offset:5120
    v_mfma_f32_16x16x32_bf16 v[68:71], v[248:251], a[4:7], v[68:71]
    ds_read_b128 v[188:191], v11 offset:6144
    v_mfma_f32_16x16x32_bf16 v[72:75], v[252:255], a[4:7], v[72:75]
    buffer_load_dwordx4 v6, s[12:15], s67 offen offset:1024 sc1 lds
    ds_read_b128 v[192:195], v11 offset:7168
    v_mfma_f32_16x16x32_bf16 v[76:79], v[148:151], a[4:7], v[76:79]
    ds_read_b128 v[196:199], v11 offset:8192
    v_mfma_f32_16x16x32_bf16 v[80:83], v[152:155], a[4:7], v[80:83]
    ds_read_b128 v[200:203], v11 offset:9216
    s_waitcnt vmcnt(9)
    v_mfma_f32_16x16x32_bf16 v[64:67], v[156:159], a[8:11], v[64:67]
    ds_read_b128 v[204:207], v11 offset:10240
    v_pk_add_f32 v[136:137], v[136:137], v[138:139]
    v_mfma_f32_16x16x32_bf16 v[68:71], v[160:163], a[8:11], v[68:71]
    ds_read_b128 v[208:211], v11 offset:11264
    v_mov_b32 v56, v136
    v_mfma_f32_16x16x32_bf16 v[72:75], v[164:167], a[8:11], v[72:75]
    buffer_load_dwordx4 v6, s[12:15], s67 offen offset:2048 sc1 lds
    ds_read_b128 v[212:215], v11 offset:12288
    v_mov_b32_e64 v57, v137
    v_mfma_f32_16x16x32_bf16 v[76:79], v[168:171], a[8:11], v[76:79]
    ds_read_b128 v[216:219], v11 offset:13312
    v_permlane16_swap_b32 v136, v56
    v_mfma_f32_16x16x32_bf16 v[80:83], v[112:115], a[8:11], v[80:83]
    ds_read_b128 v[220:223], v11 offset:14336
    v_permlane16_swap_b32 v137, v57
    s_waitcnt vmcnt(9)
    v_mfma_f32_16x16x32_bf16 v[64:67], v[116:119], a[12:15], v[64:67]
    ds_read_b128 v[224:227], v11 offset:15360
    v_add_f32 v136, v136, v56
    v_mfma_f32_16x16x32_bf16 v[68:71], v[120:123], a[12:15], v[68:71]
    ds_read_b128 v[228:231], v11 offset:16384
    v_add_f32_e64 v137, v137, v57
    v_mfma_f32_16x16x32_bf16 v[72:75], v[124:127], a[12:15], v[72:75]
    buffer_load_dwordx4 v6, s[12:15], s67 offen offset:3072 sc1 lds
    ds_read_b128 v[232:235], v11 offset:17408
    v_mov_b32_e64 v56, v136
    v_mfma_f32_16x16x32_bf16 v[76:79], v[128:131], a[12:15], v[76:79]
    ds_read_b128 v[236:239], v11 offset:18432
    v_mov_b32_e64 v57, v137
    v_mfma_f32_16x16x32_bf16 v[80:83], v[132:135], a[12:15], v[80:83]
    ds_read_b128 v[240:243], v11 offset:19456
    v_permlane32_swap_b32 v136, v56
    s_waitcnt vmcnt(9)
    v_mfma_f32_16x16x32_bf16 v[64:67], a[48:51], a[16:19], v[64:67]
    ds_read_b128 v[244:247], v11 offset:20480
    v_permlane32_swap_b32 v137, v57
    v_mfma_f32_16x16x32_bf16 v[68:71], a[52:55], a[16:19], v[68:71]
    ds_read_b128 v[248:251], v11 offset:21504
    v_add_f32 v136, v136, v56
    v_mfma_f32_16x16x32_bf16 v[72:75], a[56:59], a[16:19], v[72:75]
    s_add_u32 m0, s59, 4096
    s_add_u32 s67, s58, 14127104
    buffer_load_dwordx4 v6, s[12:15], s67 offen offset:0 sc1 lds
    ds_read_b128 v[252:255], v11 offset:22528
    v_add_f32_e64 v137, v137, v57
    v_mfma_f32_16x16x32_bf16 v[76:79], a[60:63], a[16:19], v[76:79]
    ds_read_b128 v[148:151], v11 offset:23552
    s_branch L_sk5
L_stub5:
    s_setpc_b64 s[98:99]
L_sk5:
    v_mul_f32 v40, 0x3acccccd, v136
    v_mfma_f32_16x16x32_bf16 v[80:83], a[64:67], a[16:19], v[80:83]
    ds_read_b128 v[152:155], v11 offset:24576
    v_mul_f32 v137, 0x3acccccd, v137
    s_waitcnt vmcnt(9)
    v_mfma_f32_16x16x32_bf16 v[64:67], a[68:71], a[20:23], v[64:67]
    ds_read_b128 v[156:159], v11 offset:25600
    v_fma_f32 v137, -v40, v40, v137
    v_mfma_f32_16x16x32_bf16 v[68:71], a[72:75], a[20:23], v[68:71]
    ds_read_b128 v[160:163], v11 offset:26624
    v_max_f32 v137, 0, v137
    v_mfma_f32_16x16x32_bf16 v[72:75], a[76:79], a[20:23], v[72:75]
    s_add_u32 m0, s59, 20480
    s_add_u32 s67, s58, 14286848
    buffer_load_dwordx4 v6, s[12:15], s67 offen offset:0 sc1 lds
    ds_read_b128 v[164:167], v11 offset:27648
    v_add_f32 v46, 0x3727c5ac, v137
    v_mfma_f32_16x16x32_bf16 v[76:79], a[80:83], a[20:23], v[76:79]
    ds_read_b128 v[168:171], v11 offset:28672
    v_rsq_f32_e64 v46, v46
    v_mfma_f32_16x16x32_bf16 v[80:83], a[84:87], a[20:23], v[80:83]
    ds_read_b128 v[112:115], v11 offset:29696
    v_mul_f32 v138, v46, v46
    s_waitcnt vmcnt(9)
    v_mfma_f32_16x16x32_bf16 v[64:67], a[88:91], a[24:27], v[64:67]
    ds_read_b128 v[116:119], v11 offset:30720
    v_mul_f32_e64 v138, v138, v137
    v_mfma_f32_16x16x32_bf16 v[68:71], a[92:95], a[24:27], v[68:71]
    ds_read_b128 v[120:123], v11 offset:31744
    v_add_f32 v138, 0x3727c5ac, v138
    v_mfma_f32_16x16x32_bf16 v[72:75], a[96:99], a[24:27], v[72:75]
    buffer_load_dwordx4 v6, s[12:15], s67 offen offset:1024 sc1 lds
    ds_read_b128 v[124:127], v11 offset:32768
    v_rsq_f32_e64 v138, v138
    v_mfma_f32_16x16x32_bf16 v[76:79], a[100:103], a[24:27], v[76:79]
    ds_read_b128 v[128:131], v11 offset:33792
    v_mul_f32_e64 v138, v138, v46
    v_mfma_f32_16x16x32_bf16 v[80:83], a[104:107], a[24:27], v[80:83]
    ds_read_b128 v[132:135], v11 offset:34816
    s_waitcnt vmcnt(9)
    v_mfma_f32_16x16x32_bf16 v[64:67], a[108:111], a[28:31], v[64:67]
    ds_read_b128 a[48:51], v11 offset:35840
    v_mfma_f32_16x16x32_bf16 v[68:71], a[112:115], a[28:31], v[68:71]
    ds_read_b128 a[52:55], v11 offset:36864
    v_mfma_f32_16x16x32_bf16 v[72:75], a[116:119], a[28:31], v[72:75]
    buffer_load_dwordx4 v6, s[12:15], s67 offen offset:2048 sc1 lds
    ds_read_b128 a[56:59], v11 offset:37888
    v_mfma_f32_16x16x32_bf16 v[76:79], a[120:123], a[28:31], v[76:79]
    ds_read_b128 a[60:63], v11 offset:38912
    v_mfma_f32_16x16x32_bf16 v[80:83], a[124:127], a[28:31], v[80:83]
    ds_read_b128 a[64:67], v11 offset:39936
    s_waitcnt vmcnt(9)
    v_mfma_f32_16x16x32_bf16 v[64:67], a[128:131], a[32:35], v[64:67]
    v_mfma_f32_16x16x32_bf16 v[68:71], a[132:135], a[32:35], v[68:71]
    v_mfma_f32_16x16x32_bf16 v[72:75], a[136:139], a[32:35], v[72:75]
    buffer_load_dwordx4 v6, s[12:15], s67 offen offset:3072 sc1 lds
    v_mfma_f32_16x16x32_bf16 v[76:79], a[140:143], a[32:35], v[76:79]
    v_mfma_f32_16x16x32_bf16 v[80:83], a[144:147], a[32:35], v[80:83]
    s_waitcnt vmcnt(8)
    v_mfma_f32_16x16x32_bf16 v[64:67], a[148:151], a[36:39], v[64:67]
    v_mfma_f32_16x16x32_bf16 v[68:71], a[152:155], a[36:39], v[68:71]
    v_mfma_f32_16x16x32_bf16 v[72:75], a[156:159], a[36:39], v[72:75]
    s_add_u32 m0, s59, 24576
    s_add_u32 s67, s58, 14290944
    buffer_load_dwordx4 v6, s[12:15], s67 offen offset:0 sc1 lds
    v_mfma_f32_16x16x32_bf16 v[76:79], a[160:163], a[36:39], v[76:79]
    v_mfma_f32_16x16x32_bf16 v[80:83], a[164:167], a[36:39], v[80:83]
    s_nop 0
    v_pk_fma_f32 v[64:65], v[84:85], v[40:41], v[64:65] op_sel_hi:[1,0,1] neg_lo:[0,1,0] neg_hi:[0,1,0]
    v_pk_fma_f32 v[66:67], v[86:87], v[40:41], v[66:67] op_sel_hi:[1,0,1] neg_lo:[0,1,0] neg_hi:[0,1,0]
    v_pk_fma_f32 v[68:69], v[88:89], v[40:41], v[68:69] op_sel_hi:[1,0,1] neg_lo:[0,1,0] neg_hi:[0,1,0]
    v_pk_fma_f32 v[70:71], v[90:91], v[40:41], v[70:71] op_sel_hi:[1,0,1] neg_lo:[0,1,0] neg_hi:[0,1,0]
    v_pk_fma_f32 v[72:73], v[92:93], v[40:41], v[72:73] op_sel_hi:[1,0,1] neg_lo:[0,1,0] neg_hi:[0,1,0]
    v_pk_fma_f32 v[74:75], v[94:95], v[40:41], v[74:75] op_sel_hi:[1,0,1] neg_lo:[0,1,0] neg_hi:[0,1,0]
    v_pk_fma_f32 v[76:77], v[96:97], v[40:41], v[76:77] op_sel_hi:[1,0,1] neg_lo:[0,1,0] neg_hi:[0,1,0]
    v_pk_fma_f32 v[78:79], v[98:99], v[40:41], v[78:79] op_sel_hi:[1,0,1] neg_lo:[0,1,0] neg_hi:[0,1,0]
    v_pk_fma_f32 v[80:81], v[100:101], v[40:41], v[80:81] op_sel_hi:[1,0,1] neg_lo:[0,1,0] neg_hi:[0,1,0]
    v_pk_fma_f32 v[82:83], v[102:103], v[40:41], v[82:83] op_sel_hi:[1,0,1] neg_lo:[0,1,0] neg_hi:[0,1,0]
    v_pk_mul_f32 v[64:65], v[64:65], v[138:139] op_sel_hi:[1,0]
    v_pk_mul_f32 v[66:67], v[66:67], v[138:139] op_sel_hi:[1,0]
    v_pk_mul_f32 v[68:69], v[68:69], v[138:139] op_sel_hi:[1,0]
    v_pk_mul_f32 v[70:71], v[70:71], v[138:139] op_sel_hi:[1,0]
    s_add_u32 m0, s61, 40960
    s_add_u32 s67, s60, 14680064
    buffer_load_dwordx4 v6, s[12:15], s67 offen offset:0 sc1 lds
    v_pk_mul_f32 v[72:73], v[72:73], v[138:139] op_sel_hi:[1,0]
    v_pk_mul_f32 v[74:75], v[74:75], v[138:139] op_sel_hi:[1,0]
    v_pk_mul_f32 v[76:77], v[76:77], v[138:139] op_sel_hi:[1,0]
    v_pk_mul_f32 v[78:79], v[78:79], v[138:139] op_sel_hi:[1,0]
    v_pk_mul_f32 v[80:81], v[80:81], v[138:139] op_sel_hi:[1,0]
    v_pk_mul_f32 v[82:83], v[82:83], v[138:139] op_sel_hi:[1,0]
    v_pk_mul_f32 v[56:57], v[64:65], v[64:65]
    v_pk_mul_f32 v[58:59], v[66:67], v[66:67]
    v_pk_mul_f32 v[60:61], v[68:69], v[68:69]
    v_pk_mul_f32 v[62:63], v[70:71], v[70:71]
    v_pk_fma_f32 v[56:57], v[56:57], s[82:83], v[54:55] op_sel_hi:[1,1,0]
    v_pk_fma_f32 v[58:59], v[58:59], s[82:83], v[54:55] op_sel_hi:[1,1,0]
    v_pk_fma_f32 v[60:61], v[60:61], s[82:83], v[54:55] op_sel_hi:[1,1,0]
    v_pk_fma_f32 v[62:63], v[62:63], s[82:83], v[54:55] op_sel_hi:[1,1,0]
    buffer_load_dwordx4 v6, s[12:15], s67 offen offset:1024 sc1 lds
    v_pk_mul_f32 v[56:57], v[56:57], v[64:65]
    v_pk_mul_f32 v[58:59], v[58:59], v[66:67]
    v_pk_mul_f32 v[60:61], v[60:61], v[68:69]
    v_pk_mul_f32 v[62:63], v[62:63], v[70:71]
    v_exp_f32 v56, v56
    v_exp_f32 v57, v57
    v_exp_f32 v58, v58
    v_exp_f32 v59, v59
    v_exp_f32 v60, v60
    v_exp_f32 v61, v61
    v_exp_f32 v62, v62
    v_exp_f32 v63, v63
    v_pk_add_f32 v[56:57], v[56:57], 1.0 op_sel_hi:[1,0]
    v_pk_add_f32 v[58:59], v[58:59], 1.0 op_sel_hi:[1,0]
    buffer_load_dwordx4 v6, s[12:15], s67 offen offset:2048 sc1 lds
    v_pk_add_f32 v[60:61], v[60:61], 1.0 op_sel_hi:[1,0]
    v_pk_add_f32 v[62:63], v[62:63], 1.0 op_sel_hi:[1,0]
    v_rcp_f32 v56, v56
    v_rcp_f32 v57, v57
    v_rcp_f32 v58, v58
    v_rcp_f32 v59, v59
    v_rcp_f32 v60, v60
    v_rcp_f32 v61, v61
    v_rcp_f32 v62, v62
    v_rcp_f32 v63, v63
    v_pk_mul_f32 v[64:65], v[64:65], v[56:57]
    v_pk_mul_f32 v[66:67], v[66:67], v[58:59]
    v_pk_mul_f32 v[68:69], v[68:69], v[60:61]
    v_pk_mul_f32 v[70:71], v[70:71], v[62:63]
    s_add_u32 m0, s61, 53248
    s_add_u32 s67, s60, 14876672
    buffer_load_dwordx4 v6, s[12:15], s67 offen offset:0 sc1 lds
    v_pk_mul_f32 v[56:57], v[72:73], v[72:73]
    v_pk_mul_f32 v[58:59], v[74:75], v[74:75]
    v_pk_mul_f32 v[60:61], v[76:77], v[76:77]
    v_pk_mul_f32 v[62:63], v[78:79], v[78:79]
    v_pk_fma_f32 v[56:57], v[56:57], s[82:83], v[54:55] op_sel_hi:[1,1,0]
    v_pk_fma_f32 v[58:59], v[58:59], s[82:83], v[54:55] op_sel_hi:[1,1,0]
    v_pk_fma_f32 v[60:61], v[60:61], s[82:83], v[54:55] op_sel_hi:[1,1,0]
    v_pk_fma_f32 v[62:63], v[62:63], s[82:83], v[54:55] op_sel_hi:[1,1,0]
    v_pk_mul_f32 v[56:57], v[56:57], v[72:73]
    v_pk_mul_f32 v[58:59], v[58:59], v[74:75]
    v_pk_mul_f32 v[60:61], v[60:61], v[76:77]
    v_pk_mul_f32 v[62:63], v[62:63], v[78:79]
    v_exp_f32 v56, v56
    v_exp_f32 v57, v57
    buffer_load_dwordx4 v6, s[12:15], s67 offen offset:1024 sc1 lds
    v_exp_f32 v58, v58
    v_exp_f32 v59, v59
    v_exp_f32 v60, v60
    v_exp_f32 v61, v61
    v_exp_f32 v62, v62
    v_exp_f32 v63, v63
    v_pk_add_f32 v[56:57], v[56:57], 1.0 op_sel_hi:[1,0]
    v_pk_add_f32 v[58:59], v[58:59], 1.0 op_sel_hi:[1,0]
    v_pk_add_f32 v[60:61], v[60:61], 1.0 op_sel_hi:[1,0]
    v_pk_add_f32 v[62:63], v[62:63], 1.0 op_sel_hi:[1,0]
    v_rcp_f32 v56, v56
    v_rcp_f32 v57, v57
    v_rcp_f32 v58, v58
    v_rcp_f32 v59, v59
    buffer_load_dwordx4 v6, s[12:15], s67 offen offset:2048 sc1 lds
    v_rcp_f32 v60, v60
    v_rcp_f32 v61, v61
    v_rcp_f32 v62, v62
    v_rcp_f32 v63, v63
    v_pk_mul_f32 v[72:73], v[72:73], v[56:57]
    v_pk_mul_f32 v[74:75], v[74:75], v[58:59]
    v_pk_mul_f32 v[76:77], v[76:77], v[60:61]
    v_pk_mul_f32 v[78:79], v[78:79], v[62:63]
    v_pk_mul_f32 v[56:57], v[80:81], v[80:81]
    v_pk_mul_f32 v[58:59], v[82:83], v[82:83]
    v_pk_fma_f32 v[56:57], v[56:57], s[82:83], v[54:55] op_sel_hi:[1,1,0]
    v_pk_fma_f32 v[58:59], v[58:59], s[82:83], v[54:55] op_sel_hi:[1,1,0]
    v_pk_mul_f32 v[56:57], v[56:57], v[80:81]
    v_pk_mul_f32 v[58:59], v[58:59], v[82:83]
    v_exp_f32 v56, v56
    v_exp_f32 v57, v57
    v_exp_f32 v58, v58
    v_exp_f32 v59, v59
    v_pk_add_f32 v[56:57], v[56:57], 1.0 op_sel_hi:[1,0]
    v_pk_add_f32 v[58:59], v[58:59], 1.0 op_sel_hi:[1,0]
    v_rcp_f32 v56, v56
    v_rcp_f32 v57, v57
    v_rcp_f32 v58, v58
    v_rcp_f32 v59, v59
    v_pk_mul_f32 v[80:81], v[80:81], v[56:57]
    v_pk_mul_f32 v[82:83], v[82:83], v[58:59]
    v_cvt_pk_bf16_f32 v64, v64, v65
    v_cvt_pk_bf16_f32 v65, v66, v67
    v_cvt_pk_bf16_f32 v66, v68, v69
    v_cvt_pk_bf16_f32 v67, v70, v71
    v_cvt_pk_bf16_f32 v68, v72, v73
    v_cvt_pk_bf16_f32 v69, v74, v75
    v_cvt_pk_bf16_f32 v70, v76, v77
    v_cvt_pk_bf16_f32 v71, v78, v79
    v_cvt_pk_bf16_f32 v72, v80, v81
    v_cvt_pk_bf16_f32 v73, v82, v83
    v_add_u32 v50, 368640, v3
    s_cmp_eq_u32 s51, 1
    s_cbranch_scc0 L_alt_66
    s_bitcmp0_b32 s48, 0
    s_cbranch_scc0 L_alt_68
    buffer_store_dwordx4 v[64:67], v108, s[12:15], s63 offen offset:256
    buffer_store_dwordx4 v[68:71], v108, s[12:15], s64 offen offset:256
    buffer_store_dwordx2 v[72:73], v108, s[12:15], s65 offen offset:256
    s_branch L_altd_69
L_alt_68:
    buffer_store_dwordx2 v[64:65], v108, s[12:15], s63 offen offset:264
    buffer_store_dwordx4 v[66:69], v108, s[12:15], s64 offen offset:256
    buffer_store_dwordx4 v[70:73], v108, s[12:15], s65 offen offset:256
L_altd_69:
    s_branch L_altd_67
L_alt_66:
    s_bitcmp0_b32 s48, 0
    s_cbranch_scc0 L_alt_70
    buffer_store_dwordx4 v[64:67], v108, s[12:15], s63 offen offset:256 sc1
    buffer_store_dwordx4 v[68:71], v108, s[12:15], s64 offen offset:256 sc1
    buffer_store_dwordx2 v[72:73], v108, s[12:15], s65 offen offset:256 sc1
    s_branch L_altd_71
L_alt_70:
    buffer_store_dwordx2 v[64:65], v108, s[12:15], s63 offen offset:264 sc1
    buffer_store_dwordx4 v[66:69], v108, s[12:15], s64 offen offset:256 sc1
    buffer_store_dwordx4 v[70:73], v108, s[12:15], s65 offen offset:256 sc1
L_altd_71:
L_altd_67:
    s_cmp_eq_u32 s49, 15
    s_cbranch_scc1 L_edgeb_73
    s_cmp_eq_u32 s49, 0
    s_cbranch_scc0 L_noedge_72
    s_cmp_eq_u32 s45, 0
    s_cbranch_scc1 L_noedge_72
    s_bitcmp1_b32 s48, 1
    s_cbranch_scc0 L_noedge_72
    s_mov_b32 s70, 0xffec1000
    s_mov_b32 s74, 0x00030003
    s_branch L_edgego_74
L_edgeb_73:
    s_cmp_eq_u32 s45, 7
    s_cbranch_scc1 L_noedge_72
    s_bitcmp1_b32 s48, 1
    s_cbranch_scc1 L_noedge_72
    s_mov_b32 s70, 1306624
    s_mov_b32 s74, 0xc000c000
L_edgego_74:
    s_mov_b32 s75, s74
    s_mov_b64 exec, s[74:75]
    s_bitcmp0_b32 s48, 0
    s_cbranch_scc0 L_alt_75
    s_add_u32 s71, s63, s70
    buffer_store_dwordx4 v[64:67], v50, s[12:15], s71 offen offset:256 sc1
    s_add_u32 s71, s64, s70
    buffer_store_dwordx4 v[68:71], v50, s[12:15], s71 offen offset:256 sc1
    s_add_u32 s71, s65, s70
    buffer_store_dwordx2 v[72:73], v50, s[12:15], s71 offen offset:256 sc1
    s_branch L_altd_76
L_alt_75:
    s_add_u32 s71, s63, s70
    buffer_store_dwordx2 v[64:65], v50, s[12:15], s71 offen offset:264 sc1
    s_add_u32 s71, s64, s70
    buffer_store_dwordx4 v[66:69], v50, s[12:15], s71 offen offset:256 sc1
    s_add_u32 s71, s65, s70
    buffer_store_dwordx4 v[70:73], v50, s[12:15], s71 offen offset:256 sc1
L_altd_76:
    s_mov_b64 exec, -1
    s_waitcnt vmcnt(3)
    v_mov_b32 v48, 5
    v_mov_b32 v49, 0
    s_mov_b64 exec, 1
    s_cmp_eq_u32 s51, 1
    s_cbranch_scc0 L_alt_77
    buffer_store_dword v48, v49, s[12:15], s52 offen
    s_branch L_altd_78
L_alt_77:
    buffer_store_dword v48, v49, s[12:15], s52 offen sc1
L_altd_78:
    s_mov_b64 exec, -1
    s_waitcnt vmcnt(1)
    s_lshl_b32 s71, s45, 7
    s_lshl_b32 s72, s48, 2
    s_add_u32 s71, s71, s72
    s_add_u32 s72, s71, 12544
    s_add_u32 s71, s71, 12320
    s_cmp_eq_u32 s49, 0
    s_cselect_b32 s71, s71, s72
    s_mov_b64 exec, 1
    buffer_store_dword v48, v49, s[12:15], s71 offen sc1
    s_mov_b64 exec, -1
    s_branch L_edgeskip_79
L_noedge_72:
    s_waitcnt vmcnt(0)
    v_mov_b32 v48, 5
    v_mov_b32 v49, 0
    s_mov_b64 exec, 1
    s_cmp_eq_u32 s51, 1
    s_cbranch_scc0 L_alt_80
    buffer_store_dword v48, v49, s[12:15], s52 offen
    s_branch L_altd_81
L_alt_80:
    buffer_store_dword v48, v49, s[12:15], s52 offen sc1
L_altd_81:
    s_mov_b64 exec, -1
L_edgeskip_79:
    s_lshl_b32 s68, s57, 4
    v_add_u32 v48, s68, v2
    v_mov_b32 v50, 1073741824
    s_movk_i32 s69, 2048
    v_and_b32 v51, 255, v48
    s_movk_i32 s70, 256
    v_add_u32 v53, 64, v3
    v_subrev_u32 v49, 1, v51
    v_add_u32 v52, 48, v3
    v_cmp_gt_u32 vcc, s70, v49
    s_nop 1
    v_cndmask_b32 v104, v52, v53, vcc
    v_subrev_u32 v49, 1, v48
    v_cmp_gt_u32 vcc, s69, v49
    s_nop 1
    v_cndmask_b32 v104, v50, v104, vcc
    v_subrev_u32 v49, -1, v51
    v_add_u32 v52, 80, v3
    v_cmp_gt_u32 vcc, s70, v49
    s_nop 1
    v_cndmask_b32 v105, v52, v53, vcc
    v_subrev_u32 v49, -1, v48
    v_cmp_gt_u32 vcc, s69, v49
    s_nop 1
    v_cndmask_b32 v105, v50, v105, vcc
    v_subrev_u32 v49, 2, v51
    v_add_u32 v52, 32, v3
    v_cmp_gt_u32 vcc, s70, v49
    s_nop 1
    v_cndmask_b32 v106, v52, v53, vcc
    v_subrev_u32 v49, 2, v48
    v_cmp_gt_u32 vcc, s69, v49
    s_nop 1
    v_cndmask_b32 v106, v50, v106, vcc
    v_subrev_u32 v49, -2, v51
    v_add_u32 v52, 96, v3
    v_cmp_gt_u32 vcc, s70, v49
    s_nop 1
    v_cndmask_b32 v107, v52, v53, vcc
    v_subrev_u32 v49, -2, v48
    v_cmp_gt_u32 vcc, s69, v49
    s_nop 1
    v_cndmask_b32 v107, v50, v107, vcc
    s_sub_u32 s70, s49, 1
    s_ashr_i32 s70, s70, 1
    s_add_u32 s71, s49, 1
    s_lshr_b32 s71, s71, 1
    s_max_i32 s70, s70, 0
    s_min_i32 s71, s71, 7
    s_sub_u32 s71, s71, s70
    s_add_u32 s71, s71, 1
    s_bfm_b32 s74, s71, s70
    s_mul_i32 s74, s74, 0x01010101
    s_mov_b32 s75, s74
    s_waitcnt lgkmcnt(0)
    s_barrier
    ds_read_b128 a[68:71], v6 offset:0
    ds_read_b128 a[72:75], v6 offset:1024
    s_add_u32 m0, s61, 65536
    s_add_u32 s67, s60, 15073280
    buffer_load_dwordx4 v6, s[12:15], s67 offen offset:0 sc1 lds
    ds_read_b128 a[76:79], v6 offset:2048
    ds_read_b128 a[80:83], v6 offset:3072
    buffer_load_dwordx4 v6, s[12:15], s67 offen offset:1024 sc1 lds
    ds_read_b128 a[84:87], v6 offset:4096
    ds_read_b128 a[88:91], v6 offset:5120
    buffer_load_dwordx4 v6, s[12:15], s67 offen offset:2048 sc1 lds
    ds_read_b128 a[92:95], v6 offset:6144
    ds_read_b128 a[96:99], v6 offset:7168
    s_add_u32 m0, s61, 77824
    s_add_u32 s67, s60, 15269888
    buffer_load_dwordx4 v6, s[12:15], s67 offen offset:0 sc1 lds
    ds_read_b128 a[100:103], v6 offset:8192
    ds_read_b128 a[104:107], v6 offset:9216
    buffer_load_dwordx4 v6, s[12:15], s67 offen offset:1024 sc1 lds
    ds_read_b128 a[108:111], v6 offset:10240
    ds_read_b128 a[112:115], v6 offset:11264
    buffer_load_dwordx4 v6, s[12:15], s67 offen offset:2048 sc1 lds
    ds_read_b128 a[116:119], v6 offset:12288
    ds_read_b128 a[120:123], v6 offset:13312
    s_add_u32 m0, s61, 90112
    s_add_u32 s67, s60, 15466496
    buffer_load_dwordx4 v6, s[12:15], s67 offen offset:0 sc1 lds
    ds_read_b128 a[124:127], v6 offset:14336
    ds_read_b128 a[128:131], v6 offset:15360
    buffer_load_dwordx4 v6, s[12:15], s67 offen offset:1024 sc1 lds
    ds_read_b128 a[132:135], v6 offset:16384
    ds_read_b128 a[136:139], v6 offset:17408
    buffer_load_dwordx4 v6, s[12:15], s67 offen offset:2048 sc1 lds
    ds_read_b128 a[140:143], v6 offset:18432
    ds_read_b128 a[144:147], v6 offset:19456
    s_add_u32 m0, s61, 102400
    s_add_u32 s67, s60, 15663104
    buffer_load_dwordx4 v6, s[12:15], s67 offen offset:0 sc1 lds
    ds_read_b128 a[148:151], v6 offset:20480
    ds_read_b128 a[152:155], v6 offset:21504
    buffer_load_dwordx4 v6, s[12:15], s67 offen offset:1024 sc1 lds
    ds_read_b128 a[156:159], v6 offset:22528
    ds_read_b128 a[160:163], v6 offset:23552
    buffer_load_dwordx4 v6, s[12:15], s67 offen offset:2048 sc1 lds
    ds_read_b128 a[164:167], v6 offset:24576
    s_lshl_b32 s66, s49, 8
    s_add_u32 s66, s66, s50
    s_add_u32 s66, s66, 368832
    s_cmp_lg_u32 s44, 0
    s_cbranch_scc1 L_nt8
    s_call_b64 s[98:99], L_stub8
L_nt8:
    s_cmp_lg_u32 s44, 1
    s_cbranch_scc1 L_nt9
    s_call_b64 s[98:99], L_stub9
L_nt9:
    s_mov_b64 exec, s[74:75]
    s_mov_b32 s56, 0
L_sp_82:
    buffer_load_dwordx2 v[48:49], v8, s[12:15], s53 offen sc1
    s_add_u32 s56, s56, 1
    s_waitcnt vmcnt(0)
    v_min_u32 v48, v48, v49
    v_cmp_gt_u32 vcc, 5, v48
    s_cmp_gt_u32 s56, 200000
    s_cbranch_scc1 L_spo_83
    s_cbranch_vccnz L_sp_82
L_spo_83:
    s_mov_b64 exec, -1
    s_mov_b32 s75, 0
    s_cmp_eq_u32 s49, 0
    s_cselect_b32 s74, 0x33, 0
    s_cmp_eq_u32 s49, 15
    s_cselect_b32 s74, 0xcc00, s74
    s_cmp_eq_u32 s57, 0
    s_cselect_b32 s74, 0, s74
    s_cmp_eq_u32 s57, 127
    s_cselect_b32 s74, 0, s74
    s_cmp_eq_u32 s74, 0
    s_cbranch_scc1 L_noep_84
    v_lshlrev_b32 v51, 2, v0
    s_lshl_b32 s71, s45, 7
    s_add_u32 s71, s71, 12416
    s_mov_b64 exec, s[74:75]
    s_mov_b32 s56, 0
L_sp_85:
    buffer_load_dword v48, v51, s[12:15], s71 offen sc1
    s_add_u32 s56, s56, 1
    s_waitcnt vmcnt(0)
    v_cmp_eq_u32 vcc, 0, v48
    s_cmp_gt_u32 s56, 200000
    s_cbranch_scc1 L_spo_86
    s_cbranch_vccnz L_sp_85
L_spo_86:
    s_mov_b64 exec, -1
L_noep_84:
    buffer_load_dwordx4 a[0:3], v104, s[12:15], s66 offen offset:0 sc1
    s_add_u32 s66, s66, 18432
    buffer_load_dwordx4 a[4:7], v104, s[12:15], s66 offen offset:0 sc1
    s_add_u32 s66, s66, 18432
    buffer_load_dwordx4 a[8:11], v104, s[12:15], s66 offen offset:0 sc1
    s_add_u32 s66, s66, 18432
    buffer_load_dwordx4 a[12:15], v104, s[12:15], s66 offen offset:0 sc1
    s_add_u32 s66, s66, 18432
    buffer_load_dwordx4 a[16:19], v104, s[12:15], s66 offen offset:0 sc1
    s_add_u32 s66, s66, 18432
    buffer_load_dwordx4 a[20:23], v105, s[12:15], s66 offen offset:0 sc1
    s_add_u32 s66, s66, 18432
    buffer_load_dwordx4 a[24:27], v105, s[12:15], s66 offen offset:0 sc1
    s_add_u32 s66, s66, 18432
    buffer_load_dwordx4 a[28:31], v105, s[12:15], s66 offen offset:0 sc1
    s_add_u32 s66, s66, 18432
    s_waitcnt vmcnt(7)
    v_mfma_f32_16x16x32_bf16 v[64:67], a[168:171], a[0:3], 0
    buffer_load_dwordx4 a[32:35], v105, s[12:15], s66 offen offset:0 sc1
    ds_read_b128 a[168:171], v6 offset:25600
    v_mfma_f32_16x16x32_bf16 v[68:71], a[172:175], a[0:3], 0
    s_add_u32 s66, s66, 18432
    ds_read_b128 a[172:175], v6 offset:26624
    v_mfma_f32_16x16x32_bf16 v[72:75], a[176:179], a[0:3], 0
    ds_read_b128 a[176:179], v6 offset:27648
    v_mfma_f32_16x16x32_bf16 v[76:79], a[180:183], a[0:3], 0
    ds_read_b128 a[180:183], v6 offset:28672
    v_mfma_f32_16x16x32_bf16 v[80:83], a[184:187], a[0:3], 0
    ds_read_b128 a[184:187], v6 offset:29696
    s_waitcnt vmcnt(7)
    v_mfma_f32_16x16x32_bf16 v[64:67], a[188:191], a[4:7], v[64:67]
    buffer_load_dwordx4 a[36:39], v105, s[12:15], s66 offen offset:0 sc1
    ds_read_b128 a[188:191], v6 offset:30720
    v_mfma_f32_16x16x32_bf16 v[68:71], a[192:195], a[4:7], v[68:71]
    s_add_u32 s66, s66, 18432
    ds_read_b128 a[192:195], v6 offset:31744
    v_mfma_f32_16x16x32_bf16 v[72:75], a[196:199], a[4:7], v[72:75]
    ds_read_b128 a[196:199], v6 offset:32768
    v_mfma_f32_16x16x32_bf16 v[76:79], a[200:203], a[4:7], v[76:79]
    ds_read_b128 a[200:203], v6 offset:33792
    v_mfma_f32_16x16x32_bf16 v[80:83], a[204:207], a[4:7], v[80:83]
    ds_read_b128 a[204:207], v6 offset:34816
    s_waitcnt vmcnt(7)
    v_mfma_f32_16x16x32_bf16 v[64:67], a[208:211], a[8:11], v[64:67]
    buffer_load_dwordx4 a[0:3], v106, s[12:15], s66 offen offset:0 sc1
    ds_read_b128 a[208:211], v6 offset:35840
    v_mfma_f32_16x16x32_bf16 v[68:71], a[212:215], a[8:11], v[68:71]
    s_add_u32 s66, s66, 18432
    ds_read_b128 a[212:215], v6 offset:36864
    v_mfma_f32_16x16x32_bf16 v[72:75], a[216:219], a[8:11], v[72:75]
    ds_read_b128 a[216:219], v6 offset:37888
    v_mfma_f32_16x16x32_bf16 v[76:79], a[220:223], a[8:11], v[76:79]
    ds_read_b128 a[220:223], v6 offset:38912
    v_mfma_f32_16x16x32_bf16 v[80:83], a[224:227], a[8:11], v[80:83]
    ds_read_b128 a[224:227], v6 offset:39936
    s_waitcnt vmcnt(7)
    v_mfma_f32_16x16x32_bf16 v[64:67], a[228:231], a[12:15], v[64:67]
    buffer_load_dwordx4 a[4:7], v106, s[12:15], s66 offen offset:0 sc1
    ds_read_b128 a[228:231], v7 offset:40960
    v_mfma_f32_16x16x32_bf16 v[68:71], a[232:235], a[12:15], v[68:71]
    s_add_u32 s66, s66, 18432
    ds_read_b128 a[232:235], v7 offset:43008
    v_mfma_f32_16x16x32_bf16 v[72:75], a[236:239], a[12:15], v[72:75]
    ds_read_b128 a[236:239], v7 offset:45056
    v_mfma_f32_16x16x32_bf16 v[76:79], a[240:243], a[12:15], v[76:79]
    ds_read_b128 a[240:243], v7 offset:41472
    v_mfma_f32_16x16x32_bf16 v[80:83], a[244:247], a[12:15], v[80:83]
    ds_read_b128 a[244:247], v7 offset:43520
    s_waitcnt vmcnt(7)
    v_mfma_f32_16x16x32_bf16 v[64:67], a[248:251], a[16:19], v[64:67]
    buffer_load_dwordx4 a[8:11], v106, s[12:15], s66 offen offset:0 sc1
    ds_read_b128 a[248:251], v7 offset:45568
    v_mfma_f32_16x16x32_bf16 v[68:71], a[252:255], a[16:19], v[68:71]
    s_add_u32 s66, s66, 18432
    ds_read_b128 a[252:255], v7 offset:47104
    v_mfma_f32_16x16x32_bf16 v[72:75], v[172:175], a[16:19], v[72:75]
    ds_read_b128 v[172:175], v7 offset:49152
    v_mfma_f32_16x16x32_bf16 v[76:79], v[176:179], a[16:19], v[76:79]
    ds_read_b128 v[176:179], v7 offset:51200
    v_mfma_f32_16x16x32_bf16 v[80:83], v[180:183], a[16:19], v[80:83]
    ds_read_b128 v[180:183], v7 offset:47616
    s_waitcnt vmcnt(7)
    v_mfma_f32_16x16x32_bf16 v[64:67], v[184:187], a[20:23], v[64:67]
    buffer_load_dwordx4 a[12:15], v106, s[12:15], s66 offen offset:0 sc1
    ds_read_b128 v[184:187], v7 offset:49664
    v_mfma_f32_16x16x32_bf16 v[68:71], v[188:191], a[20:23], v[68:71]
    s_add_u32 s66, s66, 18432
    ds_read_b128 v[188:191], v7 offset:51712
    v_mfma_f32_16x16x32_bf16 v[72:75], v[192:195], a[20:23], v[72:75]
    ds_read_b128 v[192:195], v7 offset:53248
    v_mfma_f32_16x16x32_bf16 v[76:79], v[196:199], a[20:23], v[76:79]
    ds_read_b128 v[196:199], v7 offset:55296
    v_mfma_f32_16x16x32_bf16 v[80:83], v[200:203], a[20:23], v[80:83]
    ds_read_b128 v[200:203], v7 offset:57344
    s_waitcnt lgkmcnt(15)
    s_barrier
    s_waitcnt vmcnt(7)
    v_mfma_f32_16x16x32_bf16 v[64:67], v[204:207], a[24:27], v[64:67]
    buffer_load_dwordx4 a[16:19], v106, s[12:15], s66 offen offset:0 sc1
    ds_read_b128 v[204:207], v7 offset:53760
    v_mfma_f32_16x16x32_bf16 v[68:71], v[208:211], a[24:27], v[68:71]
    s_add_u32 s66, s66, 18432
    ds_read_b128 v[208:211], v7 offset:55808
    v_mfma_f32_16x16x32_bf16 v[72:75], v[212:215], a[24:27], v[72:75]
    ds_read_b128 v[212:215], v7 offset:57856
    v_mfma_f32_16x16x32_bf16 v[76:79], v[216:219], a[24:27], v[76:79]
    ds_read_b128 v[216:219], v7 offset:59392
    v_mfma_f32_16x16x32_bf16 v[80:83], v[220:223], a[24:27], v[80:83]
    ds_read_b128 v[220:223], v16 offset:0
    s_waitcnt vmcnt(7)
    v_mfma_f32_16x16x32_bf16 v[64:67], v[224:227], a[28:31], v[64:67]
    buffer_load_dwordx4 a[20:23], v107, s[12:15], s66 offen offset:0 sc1
    ds_read_b128 v[224:227], v16 offset:2048
    v_mfma_f32_16x16x32_bf16 v[68:71], v[228:231], a[28:31], v[68:71]
    s_add_u32 s66, s66, 18432
    ds_read_b128 v[228:231], v7 offset:59904
    v_mfma_f32_16x16x32_bf16 v[72:75], v[232:235], a[28:31], v[72:75]
    ds_read_b128 v[232:235], v16 offset:512
    v_mfma_f32_16x16x32_bf16 v[76:79], v[236:239], a[28:31], v[76:79]
    ds_read_b128 v[236:239], v16 offset:2560
    v_mfma_f32_16x16x32_bf16 v[80:83], v[240:243], a[28:31], v[80:83]
    ds_read_b128 v[240:243], v16 offset:4096
    s_waitcnt vmcnt(7)
    v_mfma_f32_16x16x32_bf16 v[64:67], v[244:247], a[32:35], v[64:67]
    buffer_load_dwordx4 a[24:27], v107, s[12:15], s66 offen offset:0 sc1
    ds_read_b128 v[244:247], v16 offset:6144
    v_mfma_f32_16x16x32_bf16 v[68:71], v[248:251], a[32:35], v[68:71]
    s_add_u32 s66, s66, 18432
    ds_read_b128 v[248:251], v16 offset:8192
    v_mfma_f32_16x16x32_bf16 v[72:75], v[252:255], a[32:35], v[72:75]
    ds_read_b128 v[252:255], v16 offset:4608
    v_mfma_f32_16x16x32_bf16 v[76:79], v[148:151], a[32:35], v[76:79]
    v_mfma_f32_16x16x32_bf16 v[80:83], v[152:155], a[32:35], v[80:83]
    s_waitcnt vmcnt(7)
    v_mfma_f32_16x16x32_bf16 v[64:67], v[156:159], a[36:39], v[64:67]
    buffer_load_dwordx4 a[28:31], v107, s[12:15], s66 offen offset:0 sc1
    v_mfma_f32_16x16x32_bf16 v[68:71], v[160:163], a[36:39], v[68:71]
    s_add_u32 s66, s66, 18432
    v_mfma_f32_16x16x32_bf16 v[72:75], v[164:167], a[36:39], v[72:75]
    v_mfma_f32_16x16x32_bf16 v[76:79], v[168:171], a[36:39], v[76:79]
    v_mfma_f32_16x16x32_bf16 v[80:83], v[112:115], a[36:39], v[80:83]
    s_waitcnt vmcnt(7)
    v_mfma_f32_16x16x32_bf16 v[64:67], v[116:119], a[0:3], v[64:67]
    buffer_load_dwordx4 a[32:35], v107, s[12:15], s66 offen offset:0 sc1
    v_mfma_f32_16x16x32_bf16 v[68:71], v[120:123], a[0:3], v[68:71]
    s_add_u32 s66, s66, 18432
    v_mfma_f32_16x16x32_bf16 v[72:75], v[124:127], a[0:3], v[72:75]
    s_add_u32 m0, s61, 114688
    s_add_u32 s67, s60, 15859712
    buffer_load_dwordx4 v6, s[12:15], s67 offen offset:0 sc1 lds
    v_mfma_f32_16x16x32_bf16 v[76:79], v[128:131], a[0:3], v[76:79]
    v_mfma_f32_16x16x32_bf16 v[80:83], v[132:135], a[0:3], v[80:83]
    s_waitcnt vmcnt(8)
    v_mfma_f32_16x16x32_bf16 v[64:67], a[48:51], a[4:7], v[64:67]
    buffer_load_dwordx4 a[36:39], v107, s[12:15], s66 offen offset:0 sc1
    ds_read_b128 a[48:51], v16 offset:6656
    v_mfma_f32_16x16x32_bf16 v[68:71], a[52:55], a[4:7], v[68:71]
    ds_read_b128 a[52:55], v16 offset:8704
    v_mfma_f32_16x16x32_bf16 v[72:75], a[56:59], a[4:7], v[72:75]
    buffer_load_dwordx4 v6, s[12:15], s67 offen offset:1024 sc1 lds
    ds_read_b128 a[56:59], v16 offset:10240
    v_mfma_f32_16x16x32_bf16 v[76:79], a[60:63], a[4:7], v[76:79]
    ds_read_b128 a[60:63], v16 offset:12288
    v_mfma_f32_16x16x32_bf16 v[80:83], a[64:67], a[4:7], v[80:83]
    ds_read_b128 a[64:67], v16 offset:14336
    s_waitcnt vmcnt(9)
    v_mfma_f32_16x16x32_bf16 v[64:67], a[68:71], a[8:11], v[64:67]
    ds_read_b128 a[68:71], v16 offset:10752
    v_mfma_f32_16x16x32_bf16 v[68:71], a[72:75], a[8:11], v[68:71]
    ds_read_b128 a[72:75], v16 offset:12800
    v_mfma_f32_16x16x32_bf16 v[72:75], a[76:79], a[8:11], v[72:75]
    buffer_load_dwordx4 v6, s[12:15], s67 offen offset:2048 sc1 lds
    ds_read_b128 a[76:79], v16 offset:14848
    v_mfma_f32_16x16x32_bf16 v[76:79], a[80:83], a[8:11], v[76:79]
    ds_read_b128 a[80:83], v16 offset:16384
    v_mfma_f32_16x16x32_bf16 v[80:83], a[84:87], a[8:11], v[80:83]
    ds_read_b128 a[84:87], v16 offset:18432
    s_waitcnt vmcnt(9)
    v_mfma_f32_16x16x32_bf16 v[64:67], a[88:91], a[12:15], v[64:67]
    ds_read_b128 a[88:91], v16 offset:20480
    v_mfma_f32_16x16x32_bf16 v[68:71], a[92:95], a[12:15], v[68:71]
    ds_read_b128 a[92:95], v16 offset:16896
    v_mfma_f32_16x16x32_bf16 v[72:75], a[96:99], a[12:15], v[72:75]
    s_add_u32 m0, s61, 126976
    s_add_u32 s67, s60, 16056320
    s_branch L_sk6
L_stub6:
    s_setpc_b64 s[98:99]
L_sk6:
    buffer_load_dwordx4 v6, s[12:15], s67 offen offset:0 sc1 lds
    ds_read_b128 a[96:99], v16 offset:18944
    v_mfma_f32_16x16x32_bf16 v[76:79], a[100:103], a[12:15], v[76:79]
    ds_read_b128 a[100:103], v16 offset:20992
    v_mfma_f32_16x16x32_bf16 v[80:83], a[104:107], a[12:15], v[80:83]
    ds_read_b128 a[104:107], v16 offset:22528
    s_waitcnt vmcnt(9)
    v_mfma_f32_16x16x32_bf16 v[64:67], a[108:111], a[16:19], v[64:67]
    ds_read_b128 a[108:111], v16 offset:24576
    v_mfma_f32_16x16x32_bf16 v[68:71], a[112:115], a[16:19], v[68:71]
    ds_read_b128 a[112:115], v16 offset:26624
    v_mfma_f32_16x16x32_bf16 v[72:75], a[116:119], a[16:19], v[72:75]
    buffer_load_dwordx4 v6, s[12:15], s67 offen offset:1024 sc1 lds
    ds_read_b128 a[116:119], v16 offset:23040
    v_mfma_f32_16x16x32_bf16 v[76:79], a[120:123], a[16:19], v[76:79]
    ds_read_b128 a[120:123], v16 offset:25088
    v_mfma_f32_16x16x32_bf16 v[80:83], a[124:127], a[16:19], v[80:83]
    ds_read_b128 a[124:127], v16 offset:27136
    s_waitcnt vmcnt(9)
    v_mfma_f32_16x16x32_bf16 v[64:67], a[128:131], a[20:23], v[64:67]
    ds_read_b128 a[128:131], v16 offset:28672
    v_mfma_f32_16x16x32_bf16 v[68:71], a[132:135], a[20:23], v[68:71]
    ds_read_b128 a[132:135], v16 offset:30720
    v_mfma_f32_16x16x32_bf16 v[72:75], a[136:139], a[20:23], v[72:75]
    buffer_load_dwordx4 v6, s[12:15], s67 offen offset:2048 sc1 lds
    ds_read_b128 a[136:139], v16 offset:32768
    v_mfma_f32_16x16x32_bf16 v[76:79], a[140:143], a[20:23], v[76:79]
    ds_read_b128 a[140:143], v16 offset:29184
    v_mfma_f32_16x16x32_bf16 v[80:83], a[144:147], a[20:23], v[80:83]
    ds_read_b128 a[144:147], v16 offset:31232
    s_waitcnt vmcnt(9)
    v_mfma_f32_16x16x32_bf16 v[64:67], a[148:151], a[24:27], v[64:67]
    ds_read_b128 a[148:151], v16 offset:33280
    v_mfma_f32_16x16x32_bf16 v[68:71], a[152:155], a[24:27], v[68:71]
    ds_read_b128 a[152:155], v16 offset:34816
    v_mfma_f32_16x16x32_bf16 v[72:75], a[156:159], a[24:27], v[72:75]
    s_add_u32 m0, s61, 139264
    s_add_u32 s67, s60, 16252928
    buffer_load_dwordx4 v6, s[12:15], s67 offen offset:0 sc1 lds
    ds_read_b128 a[156:159], v16 offset:36864
    v_mfma_f32_16x16x32_bf16 v[76:79], a[160:163], a[24:27], v[76:79]
    ds_read_b128 a[160:163], v16 offset:38912
    v_mfma_f32_16x16x32_bf16 v[80:83], a[164:167], a[24:27], v[80:83]
    ds_read_b128 a[164:167], v16 offset:35328
    s_waitcnt vmcnt(9)
    v_mfma_f32_16x16x32_bf16 v[64:67], a[168:171], a[28:31], v[64:67]
    ds_read_b128 a[168:171], v16 offset:37376
    v_mfma_f32_16x16x32_bf16 v[68:71], a[172:175], a[28:31], v[68:71]
    ds_read_b128 a[172:175], v16 offset:39424
    v_mfma_f32_16x16x32_bf16 v[72:75], a[176:179], a[28:31], v[72:75]
    buffer_load_dwordx4 v6, s[12:15], s67 offen offset:1024 sc1 lds
    ds_read_b128 a[176:179], v16 offset:40960
    v_mfma_f32_16x16x32_bf16 v[76:79], a[180:183], a[28:31], v[76:79]
    ds_read_b128 a[180:183], v16 offset:43008
    v_mfma_f32_16x16x32_bf16 v[80:83], a[184:187], a[28:31], v[80:83]
    ds_read_b128 a[184:187], v16 offset:45056
    s_waitcnt vmcnt(9)
    v_mfma_f32_16x16x32_bf16 v[64:67], a[188:191], a[32:35], v[64:67]
    ds_read_b128 a[188:191], v16 offset:41472
    v_mfma_f32_16x16x32_bf16 v[68:71], a[192:195], a[32:35], v[68:71]
    ds_read_b128 a[192:195], v16 offset:43520
    v_mfma_f32_16x16x32_bf16 v[72:75], a[196:199], a[32:35], v[72:75]
    buffer_load_dwordx4 v6, s[12:15], s67 offen offset:2048 sc1 lds
    ds_read_b128 a[196:199], v16 offset:45568
    v_mfma_f32_16x16x32_bf16 v[76:79], a[200:203], a[32:35], v[76:79]
    ds_read_b128 a[200:203], v16 offset:47104
    v_mfma_f32_16x16x32_bf16 v[80:83], a[204:207], a[32:35], v[80:83]
    ds_read_b128 a[204:207], v16 offset:49152
    s_waitcnt vmcnt(8)
    v_mfma_f32_16x16x32_bf16 v[64:67], a[208:211], a[36:39], v[64:67]
    ds_read_b128 a[208:211], v16 offset:51200
    v_mfma_f32_16x16x32_bf16 v[68:71], a[212:215], a[36:39], v[68:71]
    ds_read_b128 a[212:215], v16 offset:47616
    v_mfma_f32_16x16x32_bf16 v[72:75], a[216:219], a[36:39], v[72:75]
    s_add_u32 m0, s61, 151552
    s_add_u32 s67, s60, 16449536
    buffer_load_dwordx4 v6, s[12:15], s67 offen offset:0 sc1 lds
    ds_read_b128 a[216:219], v16 offset:49664
    v_mfma_f32_16x16x32_bf16 v[76:79], a[220:223], a[36:39], v[76:79]
    ds_read_b128 a[220:223], v16 offset:51712
    v_mfma_f32_16x16x32_bf16 v[80:83], a[224:227], a[36:39], v[80:83]
    v_pk_add_f32 v[56:57], v[20:21], v[40:41] op_sel_hi:[1,0] neg_lo:[0,1] neg_hi:[0,1]
    v_pk_fma_f32 v[64:65], v[56:57], v[46:47], v[64:65] op_sel_hi:[1,0,1]
    v_pk_add_f32 v[58:59], v[22:23], v[40:41] op_sel_hi:[1,0] neg_lo:[0,1] neg_hi:[0,1]
    v_pk_fma_f32 v[66:67], v[58:59], v[46:47], v[66:67] op_sel_hi:[1,0,1]
    v_pk_add_f32 v[60:61], v[24:25], v[40:41] op_sel_hi:[1,0] neg_lo:[0,1] neg_hi:[0,1]
    v_pk_fma_f32 v[68:69], v[60:61], v[46:47], v[68:69] op_sel_hi:[1,0,1]
    v_pk_add_f32 v[62:63], v[26:27], v[40:41] op_sel_hi:[1,0] neg_lo:[0,1] neg_hi:[0,1]
    v_pk_fma_f32 v[70:71], v[62:63], v[46:47], v[70:71] op_sel_hi:[1,0,1]
    v_pk_add_f32 v[56:57], v[28:29], v[40:41] op_sel_hi:[1,0] neg_lo:[0,1] neg_hi:[0,1]
    v_pk_fma_f32 v[72:73], v[56:57], v[46:47], v[72:73] op_sel_hi:[1,0,1]
    v_pk_add_f32 v[58:59], v[30:31], v[40:41] op_sel_hi:[1,0] neg_lo:[0,1] neg_hi:[0,1]
    v_pk_fma_f32 v[74:75], v[58:59], v[46:47], v[74:75] op_sel_hi:[1,0,1]
    v_pk_add_f32 v[60:61], v[32:33], v[40:41] op_sel_hi:[1,0] neg_lo:[0,1] neg_hi:[0,1]
    v_pk_fma_f32 v[76:77], v[60:61], v[46:47], v[76:77] op_sel_hi:[1,0,1]
    v_pk_add_f32 v[62:63], v[34:35], v[40:41] op_sel_hi:[1,0] neg_lo:[0,1] neg_hi:[0,1]
    v_pk_fma_f32 v[78:79], v[62:63], v[46:47], v[78:79] op_sel_hi:[1,0,1]
    v_pk_add_f32 v[56:57], v[36:37], v[40:41] op_sel_hi:[1,0] neg_lo:[0,1] neg_hi:[0,1]
    v_pk_fma_f32 v[80:81], v[56:57], v[46:47], v[80:81] op_sel_hi:[1,0,1]
    v_pk_add_f32 v[58:59], v[38:39], v[40:41] op_sel_hi:[1,0] neg_lo:[0,1] neg_hi:[0,1]
    v_pk_fma_f32 v[82:83], v[58:59], v[46:47], v[82:83] op_sel_hi:[1,0,1]
    v_cvt_pk_bf16_f32 v64, v64, v65
    v_cvt_pk_bf16_f32 v65, v66, v67
    v_cvt_pk_bf16_f32 v66, v68, v69
    v_cvt_pk_bf16_f32 v67, v70, v71
    v_cvt_pk_bf16_f32 v68, v72, v73
    v_cvt_pk_bf16_f32 v69, v74, v75
    v_cvt_pk_bf16_f32 v70, v76, v77
    v_cvt_pk_bf16_f32 v71, v78, v79
    v_cvt_pk_bf16_f32 v72, v80, v81
    v_cvt_pk_bf16_f32 v73, v82, v83
    v_add_u32 v50, 0, v3
    s_cmp_eq_u32 s51, 1
    s_cbranch_scc0 L_alt_87
    s_bitcmp0_b32 s48, 0
    s_cbranch_scc0 L_alt_89
    buffer_store_dwordx4 v[64:67], v50, s[12:15], s63 offen offset:256
    buffer_store_dwordx4 v[68:71], v50, s[12:15], s64 offen offset:256
    buffer_store_dwordx2 v[72:73], v50, s[12:15], s65 offen offset:256
    s_branch L_altd_90
L_alt_89:
    buffer_store_dwordx2 v[64:65], v50, s[12:15], s63 offen offset:264
    buffer_store_dwordx4 v[66:69], v50, s[12:15], s64 offen offset:256
    buffer_store_dwordx4 v[70:73], v50, s[12:15], s65 offen offset:256
L_altd_90:
    s_branch L_altd_88
L_alt_87:
    s_bitcmp0_b32 s48, 0
    s_cbranch_scc0 L_alt_91
    buffer_store_dwordx4 v[64:67], v50, s[12:15], s63 offen offset:256 sc1
    buffer_store_dwordx4 v[68:71], v50, s[12:15], s64 offen offset:256 sc1
    buffer_store_dwordx2 v[72:73], v50, s[12:15], s65 offen offset:256 sc1
    s_branch L_altd_92
L_alt_91:
    buffer_store_dwordx2 v[64:65], v50, s[12:15], s63 offen offset:264 sc1
    buffer_store_dwordx4 v[66:69], v50, s[12:15], s64 offen offset:256 sc1
    buffer_store_dwordx4 v[70:73], v50, s[12:15], s65 offen offset:256 sc1
L_altd_92:
L_altd_88:
    v_and_b32 v85, 0xffff0000, v64
    v_lshlrev_b32 v84, 16, v64
    v_and_b32 v87, 0xffff0000, v65
    v_lshlrev_b32 v86, 16, v65
    v_and_b32 v89, 0xffff0000, v66
    v_lshlrev_b32 v88, 16, v66
    v_and_b32 v91, 0xffff0000, v67
    v_lshlrev_b32 v90, 16, v67
    v_and_b32 v93, 0xffff0000, v68
    v_lshlrev_b32 v92, 16, v68
    v_and_b32 v95, 0xffff0000, v69
    v_lshlrev_b32 v94, 16, v69
    v_and_b32 v97, 0xffff0000, v70
    v_lshlrev_b32 v96, 16, v70
    v_and_b32 v99, 0xffff0000, v71
    v_lshlrev_b32 v98, 16, v71
    v_and_b32 v101, 0xffff0000, v72
    v_lshlrev_b32 v100, 16, v72
    v_and_b32 v103, 0xffff0000, v73
    v_lshlrev_b32_e64 v102, 16, v73
    v_pk_add_f32 v[52:53], v[84:85], v[86:87]
    v_pk_mul_f32 v[54:55], v[84:85], v[84:85]
    v_pk_fma_f32 v[54:55], v[86:87], v[86:87], v[54:55]
    v_pk_add_f32 v[52:53], v[52:53], v[88:89]
    v_pk_fma_f32 v[54:55], v[88:89], v[88:89], v[54:55]
    v_pk_add_f32 v[52:53], v[52:53], v[90:91]
    v_pk_fma_f32 v[54:55], v[90:91], v[90:91], v[54:55]
    v_pk_add_f32 v[52:53], v[52:53], v[92:93]
    v_pk_fma_f32 v[54:55], v[92:93], v[92:93], v[54:55]
    v_pk_add_f32 v[52:53], v[52:53], v[94:95]
    v_pk_fma_f32 v[54:55], v[94:95], v[94:95], v[54:55]
    v_pk_add_f32 v[52:53], v[52:53], v[96:97]
    v_pk_fma_f32 v[54:55], v[96:97], v[96:97], v[54:55]
    v_pk_add_f32 v[52:53], v[52:53], v[98:99]
    v_pk_fma_f32 v[54:55], v[98:99], v[98:99], v[54:55]
    v_pk_add_f32 v[52:53], v[52:53], v[100:101]
    v_pk_fma_f32 v[54:55], v[100:101], v[100:101], v[54:55]
    v_pk_add_f32 v[52:53], v[52:53], v[102:103]
    v_pk_fma_f32 v[54:55], v[102:103], v[102:103], v[54:55]
    v_add_f32 v52, v52, v53
    v_add_f32 v53, v54, v55
    v_mov_b32 v56, v52
    v_mov_b32 v57, v53
    s_nop 0
    v_permlane16_swap_b32 v52, v56
    v_permlane16_swap_b32 v53, v57
    v_add_f32 v52, v52, v56
    v_add_f32 v53, v53, v57
    v_mov_b32 v56, v52
    v_mov_b32 v57, v53
    s_nop 0
    v_permlane32_swap_b32 v52, v56
    v_permlane32_swap_b32 v53, v57
    v_add_f32 v52, v52, v56
    v_add_f32 v53, v53, v57
    s_lshl_b32 s68, s57, 10
    s_lshl_b32 s69, s48, 3
    s_add_u32 s68, s68, s69
    s_add_u32 s68, s68, 262144
    s_mov_b64 exec, 0xffff
    s_cmp_eq_u32 s51, 1
    s_cbranch_scc0 L_alt_93
    buffer_store_dwordx2 v[52:53], v12, s[12:15], s68 offen
    s_branch L_altd_94
L_alt_93:
    buffer_store_dwordx2 v[52:53], v12, s[12:15], s68 offen sc1
L_altd_94:
    s_mov_b64 exec, -1
    v_pk_add_f32 v[20:21], v[20:21], v[84:85]
    v_pk_add_f32 v[22:23], v[22:23], v[86:87]
    v_pk_add_f32 v[24:25], v[24:25], v[88:89]
    v_pk_add_f32 v[26:27], v[26:27], v[90:91]
    v_pk_add_f32 v[28:29], v[28:29], v[92:93]
    v_pk_add_f32 v[30:31], v[30:31], v[94:95]
    v_pk_add_f32 v[32:33], v[32:33], v[96:97]
    v_pk_add_f32 v[34:35], v[34:35], v[98:99]
    v_pk_add_f32 v[36:37], v[36:37], v[100:101]
    v_pk_add_f32 v[38:39], v[38:39], v[102:103]
    s_waitcnt vmcnt(0)
    v_mov_b32 v48, 6
    v_mov_b32 v49, 0
    s_mov_b64 exec, 1
    s_cmp_eq_u32 s51, 1
    s_cbranch_scc0 L_alt_95
    buffer_store_dword v48, v49, s[12:15], s52 offen
    s_branch L_altd_96
L_alt_95:
    buffer_store_dword v48, v49, s[12:15], s52 offen sc1
L_altd_96:
    s_mov_b64 exec, -1
    buffer_load_dwordx4 v6, s[12:15], s67 offen offset:1024 sc1 lds
    buffer_load_dwordx4 v6, s[12:15], s67 offen offset:2048 sc1 lds
    s_sub_u32 s70, s62, 1
    s_add_u32 s71, s62, 1
    s_max_i32 s70, s70, 0
    s_min_i32 s71, s71, 7
    s_sub_u32 s71, s71, s70
    s_add_u32 s71, s71, 1
    s_bfm_b32 s74, s71, s70
    s_mul_i32 s74, s74, 0x01010101
    s_mov_b32 s75, s74
    v_lshrrev_b32 v50, 5, v0
    v_lshlrev_b32 v51, 4, v50
    v_and_b32 v52, 31, v0
    v_lshlrev_b32 v52, 6, v52
    v_lshl_add_u32 v52, v50, 5, v52
    s_waitcnt vmcnt(0) lgkmcnt(0)
    s_barrier
    s_add_u32 m0, s59, 0
    s_add_u32 s67, s58, 16777216
    buffer_load_dwordx4 v6, s[12:15], s67 offen offset:0 sc1 lds
    buffer_load_dwordx4 v6, s[12:15], s67 offen offset:1024 sc1 lds
    s_add_u32 s68, s59, 40960
    v_lshl_add_u32 v56, v0, 2, s68
    v_lshl_add_u32 v57, v50, 4, s68
    ds_write_b32 v56, v9 offset:0
    ds_write_b32 v56, v47 offset:256
    s_waitcnt lgkmcnt(0)
    ds_read_b128 v[112:115], v57 offset:0
    ds_read_b128 v[116:119], v57 offset:32
    ds_read_b128 v[120:123], v57 offset:64
    ds_read_b128 v[124:127], v57 offset:96
    ds_read_b128 v[128:131], v57 offset:128
    ds_read_b128 v[132:135], v57 offset:160
    ds_read_b128 v[136:139], v57 offset:192
    ds_read_b128 v[140:143], v57 offset:224
    ds_read_b128 v[144:147], v57 offset:256
    ds_read_b128 v[148:151], v57 offset:288
    ds_read_b128 v[152:155], v57 offset:320
    ds_read_b128 v[156:159], v57 offset:352
    ds_read_b128 a[224:227], v16 offset:53248
    s_waitcnt lgkmcnt(1)
    buffer_load_dwordx4 v6, s[12:15], s67 offen offset:2048 sc1 lds
    buffer_load_dwordx4 v6, s[12:15], s67 offen offset:3072 sc1 lds
    s_add_u32 m0, s59, 4096
    s_add_u32 s67, s58, 16781312
    buffer_load_dwordx4 v6, s[12:15], s67 offen offset:0 sc1 lds
    s_add_u32 m0, s59, 20480
    s_add_u32 s67, s58, 16941056
    buffer_load_dwordx4 v6, s[12:15], s67 offen offset:0 sc1 lds
    s_lshl_b32 s66, s62, 9
    s_add_u32 s66, s66, s50
    s_add_u32 s66, s66, 256
    s_lshl_b32 s72, s45, 14
    s_lshl_b32 s73, s62, 11
    s_add_u32 s72, s72, s73
    s_add_u32 s72, s72, 262144
    s_mov_b32 s82, 0xbdd2d3e8
    s_mov_b32 s83, 0xbdd2d3e8
    v_mov_b32 v54, 0xc0135761
    s_mov_b64 exec, s[74:75]
    s_mov_b32 s56, 0
L_sp_97:
    buffer_load_dwordx2 v[48:49], v8, s[12:15], s53 offen sc1
    s_add_u32 s56, s56, 1
    s_waitcnt vmcnt(0)
    v_min_u32 v48, v48, v49
    v_cmp_gt_u32 vcc, 6, v48
    s_cmp_gt_u32 s56, 200000
    s_cbranch_scc1 L_spo_98
    s_cbranch_vccnz L_sp_97
L_spo_98:
    s_mov_b64 exec, -1
    buffer_load_dwordx4 a[0:3], v19, s[12:15], s66 offen sc1
    s_add_u32 s66, s66, 9216
    buffer_load_dwordx4 a[4:7], v19, s[12:15], s66 offen sc1
    s_add_u32 s66, s66, 9216
    buffer_load_dwordx4 a[8:11], v19, s[12:15], s66 offen sc1
    s_add_u32 s66, s66, 9216
    buffer_load_dwordx4 a[12:15], v19, s[12:15], s66 offen sc1
    s_add_u32 s66, s66, 9216
    buffer_load_dwordx4 a[16:19], v19, s[12:15], s66 offen sc1
    s_add_u32 s66, s66, 9216
    buffer_load_dwordx4 a[20:23], v19, s[12:15], s66 offen sc1
    s_add_u32 s66, s66, 9216
    buffer_load_dwordx4 a[24:27], v19, s[12:15], s66 offen sc1
    s_add_u32 s66, s66, 9216
    buffer_load_dwordx4 a[28:31], v19, s[12:15], s66 offen sc1
    s_add_u32 s66, s66, 9216
    buffer_load_dwordx4 a[32:35], v19, s[12:15], s66 offen sc1
    s_add_u32 s66, s66, 9216
    buffer_load_dwordx4 v[160:163], v52, s[12:15], s72 offen offset:0 sc1
    buffer_load_dwordx4 v[164:167], v52, s[12:15], s72 offen offset:16 sc1
    s_waitcnt vmcnt(10)
    v_mfma_f32_32x32x16_bf16 v[64:79], a[228:231], a[0:3], 0
    buffer_load_dwordx4 a[36:39], v19, s[12:15], s66 offen sc1
    s_add_u32 s66, s66, 9216
    ds_read_b128 a[228:231], v16 offset:55296
    v_mfma_f32_32x32x16_bf16 v[80:95], a[232:235], a[0:3], 0
    buffer_load_dwordx4 v6, s[12:15], s67 offen offset:1024 sc1 lds
    ds_read_b128 a[232:235], v16 offset:57344
    v_mfma_f32_32x32x16_bf16 v[96:111], a[236:239], a[0:3], 0
    ds_read_b128 a[236:239], v16 offset:53760
    s_waitcnt vmcnt(11)
    v_mfma_f32_32x32x16_bf16 v[64:79], a[240:243], a[4:7], v[64:79]
    buffer_load_dwordx4 a[40:43], v19, s[12:15], s66 offen sc1
    s_add_u32 s66, s66, 9216
    ds_read_b128 a[240:243], v16 offset:55808
    v_mfma_f32_32x32x16_bf16 v[80:95], a[244:247], a[4:7], v[80:95]
    buffer_load_dwordx4 v6, s[12:15], s67 offen offset:2048 sc1 lds
    ds_read_b128 a[244:247], v16 offset:57856
    v_mfma_f32_32x32x16_bf16 v[96:111], a[248:251], a[4:7], v[96:111]
    ds_read_b128 a[248:251], v16 offset:59392
    s_waitcnt vmcnt(12)
    v_mfma_f32_32x32x16_bf16 v[64:79], a[252:255], a[8:11], v[64:79]
    buffer_load_dwordx4 a[44:47], v19, s[12:15], s66 offen sc1
    s_add_u32 s66, s66, 9216
    ds_read_b128 a[252:255], v17 offset:0
    v_mfma_f32_32x32x16_bf16 v[80:95], v[172:175], a[8:11], v[80:95]
    buffer_load_dwordx4 v6, s[12:15], s67 offen offset:3072 sc1 lds
    ds_read_b128 v[172:175], v17 offset:2048
    v_mfma_f32_32x32x16_bf16 v[96:111], v[176:179], a[8:11], v[96:111]
    ds_read_b128 v[176:179], v16 offset:59904
    s_waitcnt vmcnt(13)
    v_mfma_f32_32x32x16_bf16 v[64:79], v[180:183], a[12:15], v[64:79]
    buffer_load_dwordx4 a[0:3], v19, s[12:15], s66 offen sc1
    s_add_u32 s66, s66, 9216
    ds_read_b128 v[180:183], v17 offset:512
    v_mfma_f32_32x32x16_bf16 v[80:95], v[184:187], a[12:15], v[80:95]
    s_add_u32 m0, s59, 24576
    s_add_u32 s67, s58, 16945152
    buffer_load_dwordx4 v6, s[12:15], s67 offen offset:0 sc1 lds
    ds_read_b128 v[184:187], v17 offset:2560
    v_mfma_f32_32x32x16_bf16 v[96:111], v[188:191], a[12:15], v[96:111]
    ds_read_b128 v[188:191], v17 offset:4096
    s_waitcnt vmcnt(14)
    v_mfma_f32_32x32x16_bf16 v[64:79], v[192:195], a[16:19], v[64:79]
    buffer_load_dwordx4 a[4:7], v19, s[12:15], s66 offen sc1
    s_add_u32 s66, s66, 9216
    ds_read_b128 v[192:195], v17 offset:6144
    v_mfma_f32_32x32x16_bf16 v[80:95], v[196:199], a[16:19], v[80:95]
    s_add_u32 m0, s59, 40960
    s_add_u32 s67, s58, 17104896
    buffer_load_dwordx4 v6, s[12:15], s67 offen offset:0 sc1 lds
    ds_read_b128 v[196:199], v17 offset:8192
    v_mfma_f32_32x32x16_bf16 v[96:111], v[200:203], a[16:19], v[96:111]
    ds_read_b128 v[200:203], v17 offset:4608
    s_waitcnt vmcnt(15)
    v_mfma_f32_32x32x16_bf16 v[64:79], v[204:207], a[20:23], v[64:79]
    buffer_load_dwordx4 a[8:11], v19, s[12:15], s66 offen sc1
    s_add_u32 s66, s66, 9216
    ds_read_b128 v[204:207], v17 offset:6656
    v_mfma_f32_32x32x16_bf16 v[80:95], v[208:211], a[20:23], v[80:95]
    buffer_load_dwordx4 v6, s[12:15], s67 offen offset:1024 sc1 lds
    ds_read_b128 v[208:211], v17 offset:8704
    v_mfma_f32_32x32x16_bf16 v[96:111], v[212:215], a[20:23], v[96:111]
    ds_read_b128 v[212:215], v17 offset:10240
    s_waitcnt vmcnt(16)
    v_mfma_f32_32x32x16_bf16 v[64:79], v[216:219], a[24:27], v[64:79]
    buffer_load_dwordx4 a[12:15], v19, s[12:15], s66 offen sc1
    s_add_u32 s66, s66, 9216
    ds_read_b128 v[216:219], v17 offset:12288
    v_mfma_f32_32x32x16_bf16 v[80:95], v[220:223], a[24:27], v[80:95]
    buffer_load_dwordx4 v6, s[12:15], s67 offen offset:2048 sc1 lds
    ds_read_b128 v[220:223], v17 offset:14336
    v_mfma_f32_32x32x16_bf16 v[96:111], v[224:227], a[24:27], v[96:111]
    ds_read_b128 v[224:227], v17 offset:10752
    s_waitcnt vmcnt(17)
    v_mfma_f32_32x32x16_bf16 v[64:79], v[228:231], a[28:31], v[64:79]
    buffer_load_dwordx4 a[16:19], v19, s[12:15], s66 offen sc1
    s_add_u32 s66, s66, 9216
    ds_read_b128 v[228:231], v17 offset:12800
    v_mfma_f32_32x32x16_bf16 v[80:95], v[232:235], a[28:31], v[80:95]
    buffer_load_dwordx4 v6, s[12:15], s67 offen offset:3072 sc1 lds
    ds_read_b128 v[232:235], v17 offset:14848
    v_mfma_f32_32x32x16_bf16 v[96:111], v[236:239], a[28:31], v[96:111]
    ds_read_b128 v[236:239], v17 offset:16384
    s_waitcnt vmcnt(16)
    v_mfma_f32_32x32x16_bf16 v[64:79], v[240:243], a[32:35], v[64:79]
    buffer_load_dwordx4 a[20:23], v19, s[12:15], s66 offen sc1
    s_add_u32 s66, s66, 9216
    ds_read_b128 v[240:243], v17 offset:18432
    v_mfma_f32_32x32x16_bf16 v[80:95], v[244:247], a[32:35], v[80:95]
    s_add_u32 m0, s59, 45056
    s_add_u32 s67, s58, 17108992
    buffer_load_dwordx4 v6, s[12:15], s67 offen offset:0 sc1 lds
    ds_read_b128 v[244:247], v17 offset:20480
    v_mfma_f32_32x32x16_bf16 v[96:111], v[248:251], a[32:35], v[96:111]
    ds_read_b128 v[248:251], v17 offset:16896
    s_waitcnt vmcnt(17)
    v_mfma_f32_32x32x16_bf16 v[64:79], v[252:255], a[36:39], v[64:79]
    buffer_load_dwordx4 a[24:27], v19, s[12:15], s66 offen sc1
    s_add_u32 s66, s66, 9216
    ds_read_b128 v[252:255], v17 offset:18944
    v_mfma_f32_32x32x16_bf16 v[80:95], a[48:51], a[36:39], v[80:95]
    s_add_u32 m0, s59, 61440
    s_add_u32 s67, s58, 17268736
    buffer_load_dwordx4 v6, s[12:15], s67 offen offset:0 sc1 lds
    ds_read_b128 a[48:51], v17 offset:20992
    v_mfma_f32_32x32x16_bf16 v[96:111], a[52:55], a[36:39], v[96:111]
    ds_read_b128 a[52:55], v17 offset:22528
    s_waitcnt vmcnt(17)
    v_mfma_f32_32x32x16_bf16 v[64:79], a[56:59], a[40:43], v[64:79]
    buffer_load_dwordx4 a[28:31], v19, s[12:15], s66 offen sc1
    s_add_u32 s66, s66, 9216
    ds_read_b128 a[56:59], v17 offset:24576
    v_mfma_f32_32x32x16_bf16 v[80:95], a[60:63], a[40:43], v[80:95]
    buffer_load_dwordx4 v6, s[12:15], s67 offen offset:1024 sc1 lds
    ds_read_b128 a[60:63], v17 offset:26624
    v_mfma_f32_32x32x16_bf16 v[96:111], a[64:67], a[40:43], v[96:111]
    ds_read_b128 a[64:67], v17 offset:23040
    s_waitcnt vmcnt(17)
    v_mfma_f32_32x32x16_bf16 v[64:79], a[68:71], a[44:47], v[64:79]
    buffer_load_dwordx4 a[32:35], v19, s[12:15], s66 offen sc1
    s_add_u32 s66, s66, 9216
    ds_read_b128 a[68:71], v17 offset:25088
    v_mfma_f32_32x32x16_bf16 v[80:95], a[72:75], a[44:47], v[80:95]
    buffer_load_dwordx4 v6, s[12:15], s67 offen offset:2048 sc1 lds
    ds_read_b128 a[72:75], v17 offset:27136
    v_mfma_f32_32x32x16_bf16 v[96:111], a[76:79], a[44:47], v[96:111]
    ds_read_b128 a[76:79], v17 offset:28672
    s_waitcnt vmcnt(17)
    v_mfma_f32_32x32x16_bf16 v[64:79], a[80:83], a[0:3], v[64:79]
    buffer_load_dwordx4 a[36:39], v19, s[12:15], s66 offen sc1
    s_add_u32 s66, s66, 9216
    ds_read_b128 a[80:83], v17 offset:30720
    v_mfma_f32_32x32x16_bf16 v[80:95], a[84:87], a[0:3], v[80:95]
    buffer_load_dwordx4 v6, s[12:15], s67 offen offset:3072 sc1 lds
    ds_read_b128 a[84:87], v17 offset:32768
    v_mfma_f32_32x32x16_bf16 v[96:111], a[88:91], a[0:3], v[96:111]
    ds_read_b128 a[88:91], v17 offset:29184
    s_waitcnt vmcnt(17)
    v_mfma_f32_32x32x16_bf16 v[64:79], a[92:95], a[4:7], v[64:79]
    buffer_load_dwordx4 a[40:43], v19, s[12:15], s66 offen sc1
    s_add_u32 s66, s66, 9216
    ds_read_b128 a[92:95], v17 offset:31232
    v_mfma_f32_32x32x16_bf16 v[80:95], a[96:99], a[4:7], v[80:95]
    s_add_u32 m0, s59, 65536
    s_add_u32 s67, s58, 17272832
    buffer_load_dwordx4 v6, s[12:15], s67 offen offset:0 sc1 lds
    ds_read_b128 a[96:99], v17 offset:33280
    v_mfma_f32_32x32x16_bf16 v[96:111], a[100:103], a[4:7], v[96:111]
    ds_read_b128 a[100:103], v17 offset:34816
    s_waitcnt vmcnt(17)
    v_mfma_f32_32x32x16_bf16 v[64:79], a[104:107], a[8:11], v[64:79]
    buffer_load_dwordx4 a[44:47], v19, s[12:15], s66 offen sc1
    s_add_u32 s66, s66, 9216
    ds_read_b128 a[104:107], v17 offset:36864
    v_mfma_f32_32x32x16_bf16 v[80:95], a[108:111], a[8:11], v[80:95]
    s_add_u32 m0, s59, 81920
    s_add_u32 s67, s58, 17432576
    buffer_load_dwordx4 v6, s[12:15], s67 offen offset:0 sc1 lds
    ds_read_b128 a[108:111], v17 offset:38912
    v_mfma_f32_32x32x16_bf16 v[96:111], a[112:115], a[8:11], v[96:111]
    ds_read_b128 a[112:115], v17 offset:35328
    s_waitcnt vmcnt(17)
    v_mfma_f32_32x32x16_bf16 v[64:79], a[116:119], a[12:15], v[64:79]
    buffer_load_dwordx4 a[0:3], v19, s[12:15], s66 offen sc1
    s_add_u32 s66, s66, 9216
    ds_read_b128 a[116:119], v17 offset:37376
    v_mfma_f32_32x32x16_bf16 v[80:95], a[120:123], a[12:15], v[80:95]
    buffer_load_dwordx4 v6, s[12:15], s67 offen offset:1024 sc1 lds
    ds_read_b128 a[120:123], v17 offset:39424
    v_mfma_f32_32x32x16_bf16 v[96:111], a[124:127], a[12:15], v[96:111]
    s_waitcnt vmcnt(17)
    v_mfma_f32_32x32x16_bf16 v[64:79], a[128:131], a[16:19], v[64:79]
    buffer_load_dwordx4 a[4:7], v19, s[12:15], s66 offen sc1
    s_add_u32 s66, s66, 9216
    v_pk_add_f32 v[160:161], v[160:161], v[162:163]
    v_mfma_f32_32x32x16_bf16 v[80:95], a[132:135], a[16:19], v[80:95]
    buffer_load_dwordx4 v6, s[12:15], s67 offen offset:2048 sc1 lds
    v_pk_add_f32 v[164:165], v[164:165], v[166:167]
    v_mfma_f32_32x32x16_bf16 v[96:111], a[136:139], a[16:19], v[96:111]
    v_pk_add_f32 v[160:161], v[160:161], v[164:165]
    s_waitcnt vmcnt(17)
    v_mfma_f32_32x32x16_bf16 v[64:79], a[140:143], a[20:23], v[64:79]
    buffer_load_dwordx4 a[8:11], v19, s[12:15], s66 offen sc1
    s_add_u32 s66, s66, 9216
    v_mov_b32_e64 v56, v160
    v_mfma_f32_32x32x16_bf16 v[80:95], a[144:147], a[20:23], v[80:95]
    buffer_load_dwordx4 v6, s[12:15], s67 offen offset:3072 sc1 lds
    v_mov_b32 v57, v161
    v_mfma_f32_32x32x16_bf16 v[96:111], a[148:151], a[20:23], v[96:111]
    v_permlane32_swap_b32 v160, v56
    s_waitcnt vmcnt(17)
    v_mfma_f32_32x32x16_bf16 v[64:79], a[152:155], a[24:27], v[64:79]
    buffer_load_dwordx4 a[12:15], v19, s[12:15], s66 offen sc1
    s_add_u32 s66, s66, 9216
    v_permlane32_swap_b32 v161, v57
    v_mfma_f32_32x32x16_bf16 v[80:95], a[156:159], a[24:27], v[80:95]
    s_add_u32 m0, s59, 86016
    s_add_u32 s67, s58, 17436672
    buffer_load_dwordx4 v6, s[12:15], s67 offen offset:0 sc1 lds
    v_add_f32 v160, v160, v56
    v_mfma_f32_32x32x16_bf16 v[96:111], a[160:163], a[24:27], v[96:111]
    v_add_f32 v161, v161, v57
    s_waitcnt vmcnt(17)
    v_mfma_f32_32x32x16_bf16 v[64:79], a[164:167], a[28:31], v[64:79]
    buffer_load_dwordx4 a[16:19], v19, s[12:15], s66 offen sc1
    s_add_u32 s66, s66, 9216
    v_mul_f32 v168, 0x3acccccd, v160
    v_mfma_f32_32x32x16_bf16 v[80:95], a[168:171], a[28:31], v[80:95]
    v_mul_f32 v161, 0x3acccccd, v161
    v_mfma_f32_32x32x16_bf16 v[96:111], a[172:175], a[28:31], v[96:111]
    v_fma_f32 v161, -v168, v168, v161
    s_waitcnt vmcnt(16)
    v_mfma_f32_32x32x16_bf16 v[64:79], a[176:179], a[32:35], v[64:79]
    buffer_load_dwordx4 a[20:23], v19, s[12:15], s66 offen sc1
    s_add_u32 s66, s66, 9216
    v_max_f32_e64 v161, 0, v161
    v_mfma_f32_32x32x16_bf16 v[80:95], a[180:183], a[32:35], v[80:95]
    v_add_f32 v170, 0x3727c5ac, v161
    v_mfma_f32_32x32x16_bf16 v[96:111], a[184:187], a[32:35], v[96:111]
    v_rsq_f32 v170, v170
    s_waitcnt vmcnt(15)
    v_mfma_f32_32x32x16_bf16 v[64:79], a[188:191], a[36:39], v[64:79]
    buffer_load_dwordx4 a[24:27], v19, s[12:15], s66 offen sc1
    s_add_u32 s66, s66, 9216
    v_mfma_f32_32x32x16_bf16 v[80:95], a[192:195], a[36:39], v[80:95]
    v_mfma_f32_32x32x16_bf16 v[96:111], a[196:199], a[36:39], v[96:111]
    s_waitcnt vmcnt(14)
    v_mfma_f32_32x32x16_bf16 v[64:79], a[200:203], a[40:43], v[64:79]
    buffer_load_dwordx4 a[28:31], v19, s[12:15], s66 offen sc1
    s_add_u32 s66, s66, 9216
    v_mfma_f32_32x32x16_bf16 v[80:95], a[204:207], a[40:43], v[80:95]
    v_mfma_f32_32x32x16_bf16 v[96:111], a[208:211], a[40:43], v[96:111]
    s_waitcnt vmcnt(13)
    v_mfma_f32_32x32x16_bf16 v[64:79], a[212:215], a[44:47], v[64:79]
    buffer_load_dwordx4 a[32:35], v19, s[12:15], s66 offen sc1
    s_add_u32 s66, s66, 9216
    v_mfma_f32_32x32x16_bf16 v[80:95], a[216:219], a[44:47], v[80:95]
    v_mfma_f32_32x32x16_bf16 v[96:111], a[220:223], a[44:47], v[96:111]
    s_waitcnt vmcnt(12) lgkmcnt(15)
    v_mfma_f32_32x32x16_bf16 v[64:79], a[224:227], a[0:3], v[64:79]
    buffer_load_dwordx4 a[36:39], v19, s[12:15], s66 offen sc1
    s_add_u32 s66, s66, 9216
    v_mfma_f32_32x32x16_bf16 v[80:95], a[228:231], a[0:3], v[80:95]
    v_mfma_f32_32x32x16_bf16 v[96:111], a[232:235], a[0:3], v[96:111]
    s_waitcnt vmcnt(11)
    v_mfma_f32_32x32x16_bf16 v[64:79], a[236:239], a[4:7], v[64:79]
    buffer_load_dwordx4 a[40:43], v19, s[12:15], s66 offen sc1
    s_add_u32 s66, s66, 9216
    v_mfma_f32_32x32x16_bf16 v[80:95], a[240:243], a[4:7], v[80:95]
    v_mfma_f32_32x32x16_bf16 v[96:111], a[244:247], a[4:7], v[96:111]
    s_waitcnt vmcnt(7) lgkmcnt(0)
    s_barrier
    v_mfma_f32_32x32x16_bf16 v[64:79], a[248:251], a[8:11], v[64:79]
    buffer_load_dwordx4 a[44:47], v19, s[12:15], s66 offen sc1
    s_add_u32 s66, s66, 9216
    ds_read_b128 a[124:127], v6 offset:0
    ds_read_b128 a[128:131], v6 offset:1024
    v_mfma_f32_32x32x16_bf16 v[80:95], a[252:255], a[8:11], v[80:95]
    s_add_u32 m0, s59, 102400
    s_add_u32 s67, s58, 17596416
    s_branch L_sk7
L_stub7:
    s_setpc_b64 s[98:99]
L_sk7:
    buffer_load_dwordx4 v6, s[12:15], s67 offen offset:0 sc1 lds
    ds_read_b128 a[132:135], v6 offset:2048
    ds_read_b128 a[136:139], v6 offset:3072
    v_mfma_f32_32x32x16_bf16 v[96:111], v[172:175], a[8:11], v[96:111]
    ds_read_b128 a[140:143], v6 offset:4096
    ds_read_b128 a[144:147], v6 offset:5120
    v_mfma_f32_32x32x16_bf16 v[64:79], v[176:179], a[12:15], v[64:79]
    buffer_load_dwordx4 a[0:3], v19, s[12:15], s66 offen sc1
    s_add_u32 s66, s66, 9216
    ds_read_b128 a[148:151], v6 offset:6144
    ds_read_b128 a[152:155], v6 offset:7168
    v_mfma_f32_32x32x16_bf16 v[80:95], v[180:183], a[12:15], v[80:95]
    buffer_load_dwordx4 v6, s[12:15], s67 offen offset:1024 sc1 lds
    ds_read_b128 a[156:159], v6 offset:8192
    ds_read_b128 a[160:163], v6 offset:9216
    v_mfma_f32_32x32x16_bf16 v[96:111], v[184:187], a[12:15], v[96:111]
    ds_read_b128 a[164:167], v6 offset:10240
    ds_read_b128 a[168:171], v6 offset:11264
    s_waitcnt vmcnt(10)
    v_mfma_f32_32x32x16_bf16 v[64:79], v[188:191], a[16:19], v[64:79]
    buffer_load_dwordx4 a[4:7], v19, s[12:15], s66 offen sc1
    s_add_u32 s66, s66, 9216
    ds_read_b128 a[172:175], v6 offset:12288
    ds_read_b128 a[176:179], v6 offset:13312
    v_mfma_f32_32x32x16_bf16 v[80:95], v[192:195], a[16:19], v[80:95]
    buffer_load_dwordx4 v6, s[12:15], s67 offen offset:2048 sc1 lds
    ds_read_b128 a[180:183], v6 offset:14336
    ds_read_b128 a[184:187], v6 offset:15360
    v_mfma_f32_32x32x16_bf16 v[96:111], v[196:199], a[16:19], v[96:111]
    ds_read_b128 a[188:191], v6 offset:16384
    ds_read_b128 a[192:195], v6 offset:17408
    s_waitcnt vmcnt(11)
    v_mfma_f32_32x32x16_bf16 v[64:79], v[200:203], a[20:23], v[64:79]
    buffer_load_dwordx4 a[8:11], v19, s[12:15], s66 offen sc1
    s_add_u32 s66, s66, 9216
    ds_read_b128 a[196:199], v6 offset:18432
    ds_read_b128 a[200:203], v6 offset:19456
    v_mfma_f32_32x32x16_bf16 v[80:95], v[204:207], a[20:23], v[80:95]
    buffer_load_dwordx4 v6, s[12:15], s67 offen offset:3072 sc1 lds
    ds_read_b128 a[204:207], v6 offset:20480
    ds_read_b128 a[208:211], v6 offset:21504
    v_mfma_f32_32x32x16_bf16 v[96:111], v[208:211], a[20:23], v[96:111]
    ds_read_b128 a[212:215], v6 offset:22528
    ds_read_b128 a[216:219], v6 offset:23552
    s_waitcnt vmcnt(12)
    v_mfma_f32_32x32x16_bf16 v[64:79], v[212:215], a[24:27], v[64:79]
    buffer_load_dwordx4 a[12:15], v19, s[12:15], s66 offen sc1
    ds_read_b128 a[220:223], v6 offset:24576
    ds_read_b128 a[224:227], v6 offset:25600
    v_mfma_f32_32x32x16_bf16 v[80:95], v[216:219], a[24:27], v[80:95]
    s_add_u32 m0, s59, 106496
    s_add_u32 s67, s58, 17600512
    buffer_load_dwordx4 v6, s[12:15], s67 offen offset:0 sc1 lds
    ds_read_b128 a[228:231], v6 offset:26624
    ds_read_b128 a[232:235], v6 offset:27648
    v_mfma_f32_32x32x16_bf16 v[96:111], v[220:223], a[24:27], v[96:111]
    ds_read_b128 a[236:239], v6 offset:28672
    ds_read_b128 a[240:243], v6 offset:29696
    s_waitcnt vmcnt(13)
    v_mfma_f32_32x32x16_bf16 v[64:79], v[224:227], a[28:31], v[64:79]
    ds_read_b128 a[244:247], v6 offset:30720
    ds_read_b128 a[248:251], v6 offset:31744
    v_mfma_f32_32x32x16_bf16 v[80:95], v[228:231], a[28:31], v[80:95]
    s_add_u32 m0, s59, 122880
    s_add_u32 s67, s58, 17760256
    buffer_load_dwordx4 v6, s[12:15], s67 offen offset:0 sc1 lds
    ds_read_b128 a[252:255], v6 offset:32768
    ds_read_b128 v[172:175], v6 offset:33792
    v_mfma_f32_32x32x16_bf16 v[96:111], v[232:235], a[28:31], v[96:111]
    ds_read_b128 v[176:179], v6 offset:34816
    ds_read_b128 v[180:183], v6 offset:35840
    s_waitcnt vmcnt(13)
    v_mfma_f32_32x32x16_bf16 v[64:79], v[236:239], a[32:35], v[64:79]
    ds_read_b128 v[184:187], v6 offset:36864
    ds_read_b128 v[188:191], v6 offset:37888
    v_mfma_f32_32x32x16_bf16 v[80:95], v[240:243], a[32:35], v[80:95]
    buffer_load_dwordx4 v6, s[12:15], s67 offen offset:1024 sc1 lds
    ds_read_b128 v[192:195], v6 offset:38912
    ds_read_b128 v[196:199], v6 offset:39936
    v_mfma_f32_32x32x16_bf16 v[96:111], v[244:247], a[32:35], v[96:111]
    ds_read_b128 v[200:203], v6 offset:40960
    ds_read_b128 v[204:207], v6 offset:41984
    s_waitcnt vmcnt(13)
    v_mfma_f32_32x32x16_bf16 v[64:79], v[248:251], a[36:39], v[64:79]
    ds_read_b128 v[208:211], v6 offset:43008
    ds_read_b128 v[212:215], v6 offset:44032
    v_mfma_f32_32x32x16_bf16 v[80:95], v[252:255], a[36:39], v[80:95]
    buffer_load_dwordx4 v6, s[12:15], s67 offen offset:2048 sc1 lds
    ds_read_b128 v[216:219], v6 offset:45056
    ds_read_b128 v[220:223], v6 offset:46080
    v_mfma_f32_32x32x16_bf16 v[96:111], a[48:51], a[36:39], v[96:111]
    ds_read_b128 v[224:227], v6 offset:47104
    ds_read_b128 v[228:231], v6 offset:48128
    s_waitcnt vmcnt(13)
    v_mfma_f32_32x32x16_bf16 v[64:79], a[52:55], a[40:43], v[64:79]
    ds_read_b128 v[232:235], v6 offset:49152
    ds_read_b128 v[236:239], v6 offset:50176
    v_mfma_f32_32x32x16_bf16 v[80:95], a[56:59], a[40:43], v[80:95]
    buffer_load_dwordx4 v6, s[12:15], s67 offen offset:3072 sc1 lds
    ds_read_b128 v[240:243], v6 offset:51200
    ds_read_b128 v[244:247], v6 offset:52224
    v_mfma_f32_32x32x16_bf16 v[96:111], a[60:63], a[40:43], v[96:111]
    ds_read_b128 v[248:251], v6 offset:53248
    ds_read_b128 v[252:255], v6 offset:54272
    s_waitcnt vmcnt(13)
    v_mfma_f32_32x32x16_bf16 v[64:79], a[64:67], a[44:47], v[64:79]
    ds_read_b128 a[48:51], v6 offset:55296
    ds_read_b128 a[52:55], v6 offset:56320
    v_mfma_f32_32x32x16_bf16 v[80:95], a[68:71], a[44:47], v[80:95]
    s_add_u32 m0, s59, 126976
    s_add_u32 s67, s58, 17764352
    buffer_load_dwordx4 v6, s[12:15], s67 offen offset:0 sc1 lds
    ds_read_b128 a[56:59], v6 offset:57344
    ds_read_b128 a[60:63], v6 offset:58368
    v_mfma_f32_32x32x16_bf16 v[96:111], a[72:75], a[44:47], v[96:111]
    ds_read_b128 a[64:67], v6 offset:59392
    ds_read_b128 a[68:71], v6 offset:60416
    s_waitcnt vmcnt(12)
    v_mfma_f32_32x32x16_bf16 v[64:79], a[76:79], a[0:3], v[64:79]
    ds_read_b128 a[72:75], v10 offset:0
    ds_read_b128 a[76:79], v10 offset:1024
    v_mfma_f32_32x32x16_bf16 v[80:95], a[80:83], a[0:3], v[80:95]
    s_add_u32 m0, s59, 143360
    s_add_u32 s67, s58, 17924096
    buffer_load_dwordx4 v6, s[12:15], s67 offen offset:0 sc1 lds
    ds_read_b128 a[80:83], v10 offset:2048
    v_mfma_f32_32x32x16_bf16 v[96:111], a[84:87], a[0:3], v[96:111]
    ds_read_b128 a[84:87], v10 offset:3072
    s_waitcnt vmcnt(11)
    v_mfma_f32_32x32x16_bf16 v[64:79], a[88:91], a[4:7], v[64:79]
    ds_read_b128 a[88:91], v10 offset:4096
    v_mfma_f32_32x32x16_bf16 v[80:95], a[92:95], a[4:7], v[80:95]
    buffer_load_dwordx4 v6, s[12:15], s67 offen offset:1024 sc1 lds
    ds_read_b128 a[92:95], v10 offset:5120
    v_mfma_f32_32x32x16_bf16 v[96:111], a[96:99], a[4:7], v[96:111]
    ds_read_b128 a[96:99], v10 offset:6144
    s_waitcnt vmcnt(10)
    v_mfma_f32_32x32x16_bf16 v[64:79], a[100:103], a[8:11], v[64:79]
    ds_read_b128 a[100:103], v10 offset:7168
    v_mfma_f32_32x32x16_bf16 v[80:95], a[104:107], a[8:11], v[80:95]
    buffer_load_dwordx4 v6, s[12:15], s67 offen offset:2048 sc1 lds
    ds_read_b128 a[104:107], v10 offset:8192
    v_mfma_f32_32x32x16_bf16 v[96:111], a[108:111], a[8:11], v[96:111]
    ds_read_b128 a[108:111], v10 offset:9216
    s_waitcnt vmcnt(9)
    v_mfma_f32_32x32x16_bf16 v[64:79], a[112:115], a[12:15], v[64:79]
    ds_read_b128 a[112:115], v10 offset:10240
    v_mfma_f32_32x32x16_bf16 v[80:95], a[116:119], a[12:15], v[80:95]
    buffer_load_dwordx4 v6, s[12:15], s67 offen offset:3072 sc1 lds
    ds_read_b128 a[116:119], v10 offset:11264
    v_mfma_f32_32x32x16_bf16 v[96:111], a[120:123], a[12:15], v[96:111]
    ds_read_b128 a[120:123], v10 offset:12288
    s_lshr_b32 s68, s46, 1
    s_mul_i32 s68, s68, 55296
    s_lshl_b32 s69, s62, 9
    s_add_u32 s68, s68, s69
    s_add_u32 s68, s68, s50
    s_add_u32 s68, s68, 368896
    s_waitcnt lgkmcnt(0)
    s_barrier
    v_pk_fma_f32 v[64:65], v[112:113], v[168:169], v[64:65] op_sel_hi:[1,0,1] neg_lo:[0,1,0] neg_hi:[0,1,0]
    v_pk_fma_f32 v[66:67], v[114:115], v[168:169], v[66:67] op_sel_hi:[1,0,1] neg_lo:[0,1,0] neg_hi:[0,1,0]
    v_pk_fma_f32 v[68:69], v[116:117], v[168:169], v[68:69] op_sel_hi:[1,0,1] neg_lo:[0,1,0] neg_hi:[0,1,0]
    v_pk_fma_f32 v[70:71], v[118:119], v[168:169], v[70:71] op_sel_hi:[1,0,1] neg_lo:[0,1,0] neg_hi:[0,1,0]
    v_pk_fma_f32 v[72:73], v[120:121], v[168:169], v[72:73] op_sel_hi:[1,0,1] neg_lo:[0,1,0] neg_hi:[0,1,0]
    v_pk_fma_f32 v[74:75], v[122:123], v[168:169], v[74:75] op_sel_hi:[1,0,1] neg_lo:[0,1,0] neg_hi:[0,1,0]
    v_pk_fma_f32 v[76:77], v[124:125], v[168:169], v[76:77] op_sel_hi:[1,0,1] neg_lo:[0,1,0] neg_hi:[0,1,0]
    v_pk_fma_f32 v[78:79], v[126:127], v[168:169], v[78:79] op_sel_hi:[1,0,1] neg_lo:[0,1,0] neg_hi:[0,1,0]
    v_pk_mul_f32 v[64:65], v[64:65], v[170:171] op_sel_hi:[1,0]
    v_pk_mul_f32 v[66:67], v[66:67], v[170:171] op_sel_hi:[1,0]
    s_add_u32 m0, s59, 147456
    s_add_u32 s67, s58, 17928192
    buffer_load_dwordx4 v6, s[12:15], s67 offen offset:0 sc1 lds
    v_pk_mul_f32 v[68:69], v[68:69], v[170:171] op_sel_hi:[1,0]
    v_pk_mul_f32 v[70:71], v[70:71], v[170:171] op_sel_hi:[1,0]
    v_pk_mul_f32 v[72:73], v[72:73], v[170:171] op_sel_hi:[1,0]
    v_pk_mul_f32 v[74:75], v[74:75], v[170:171] op_sel_hi:[1,0]
    v_pk_mul_f32 v[76:77], v[76:77], v[170:171] op_sel_hi:[1,0]
    v_pk_mul_f32 v[78:79], v[78:79], v[170:171] op_sel_hi:[1,0]
    v_pk_mul_f32 v[56:57], v[64:65], v[64:65]
    v_pk_mul_f32 v[58:59], v[66:67], v[66:67]
    v_pk_mul_f32 v[60:61], v[68:69], v[68:69]
    v_pk_mul_f32 v[62:63], v[70:71], v[70:71]
    s_add_u32 m0, s59, 0
    s_add_u32 s67, s58, 18087936
    buffer_load_dwordx4 v6, s[12:15], s67 offen offset:0 sc1 lds
    v_pk_fma_f32 v[56:57], v[56:57], s[82:83], v[54:55] op_sel_hi:[1,1,0]
    v_pk_fma_f32 v[58:59], v[58:59], s[82:83], v[54:55] op_sel_hi:[1,1,0]
    v_pk_fma_f32 v[60:61], v[60:61], s[82:83], v[54:55] op_sel_hi:[1,1,0]
    v_pk_fma_f32 v[62:63], v[62:63], s[82:83], v[54:55] op_sel_hi:[1,1,0]
    v_pk_mul_f32 v[56:57], v[56:57], v[64:65]
    v_pk_mul_f32 v[58:59], v[58:59], v[66:67]
    v_pk_mul_f32 v[60:61], v[60:61], v[68:69]
    v_pk_mul_f32 v[62:63], v[62:63], v[70:71]
    v_exp_f32 v56, v56
    v_exp_f32 v57, v57
    buffer_load_dwordx4 v6, s[12:15], s67 offen offset:1024 sc1 lds
    v_exp_f32 v58, v58
    v_exp_f32 v59, v59
    v_exp_f32 v60, v60
    v_exp_f32 v61, v61
    v_exp_f32 v62, v62
    v_exp_f32_e64 v63, v63
    v_pk_add_f32 v[56:57], v[56:57], 1.0 op_sel_hi:[1,0]
    v_pk_add_f32 v[58:59], v[58:59], 1.0 op_sel_hi:[1,0]
    v_pk_add_f32 v[60:61], v[60:61], 1.0 op_sel_hi:[1,0]
    v_pk_add_f32 v[62:63], v[62:63], 1.0 op_sel_hi:[1,0]
    buffer_load_dwordx4 v6, s[12:15], s67 offen offset:2048 sc1 lds
    v_rcp_f32 v56, v56
    v_rcp_f32 v57, v57
    v_rcp_f32 v58, v58
    v_rcp_f32 v59, v59
    v_rcp_f32 v60, v60
    v_rcp_f32 v61, v61
    v_rcp_f32 v62, v62
    v_rcp_f32 v63, v63
    v_pk_mul_f32 v[64:65], v[64:65], v[56:57]
    v_pk_mul_f32 v[66:67], v[66:67], v[58:59]
    buffer_load_dwordx4 v6, s[12:15], s67 offen offset:3072 sc1 lds
    v_pk_mul_f32 v[68:69], v[68:69], v[60:61]
    v_pk_mul_f32 v[70:71], v[70:71], v[62:63]
    v_pk_mul_f32 v[56:57], v[72:73], v[72:73]
    v_pk_mul_f32 v[58:59], v[74:75], v[74:75]
    v_pk_mul_f32 v[60:61], v[76:77], v[76:77]
    v_pk_mul_f32 v[62:63], v[78:79], v[78:79]
    v_pk_fma_f32 v[56:57], v[56:57], s[82:83], v[54:55] op_sel_hi:[1,1,0]
    v_pk_fma_f32 v[58:59], v[58:59], s[82:83], v[54:55] op_sel_hi:[1,1,0]
    v_pk_fma_f32 v[60:61], v[60:61], s[82:83], v[54:55] op_sel_hi:[1,1,0]
    v_pk_fma_f32 v[62:63], v[62:63], s[82:83], v[54:55] op_sel_hi:[1,1,0]
    s_add_u32 m0, s59, 4096
    s_add_u32 s67, s58, 18092032
    buffer_load_dwordx4 v6, s[12:15], s67 offen offset:0 sc1 lds
    v_pk_mul_f32 v[56:57], v[56:57], v[72:73]
    v_pk_mul_f32 v[58:59], v[58:59], v[74:75]
    v_pk_mul_f32 v[60:61], v[60:61], v[76:77]
    v_pk_mul_f32 v[62:63], v[62:63], v[78:79]
    v_exp_f32 v56, v56
    v_exp_f32 v57, v57
    v_exp_f32 v58, v58
    v_exp_f32 v59, v59
    v_exp_f32 v60, v60
    v_exp_f32 v61, v61
    s_add_u32 m0, s59, 20480
    s_add_u32 s67, s58, 18251776
    buffer_load_dwordx4 v6, s[12:15], s67 offen offset:0 sc1 lds
    v_exp_f32 v62, v62
    v_exp_f32 v63, v63
    v_pk_add_f32 v[56:57], v[56:57], 1.0 op_sel_hi:[1,0]
    v_pk_add_f32 v[58:59], v[58:59], 1.0 op_sel_hi:[1,0]
    v_pk_add_f32 v[60:61], v[60:61], 1.0 op_sel_hi:[1,0]
    v_pk_add_f32 v[62:63], v[62:63], 1.0 op_sel_hi:[1,0]
    v_rcp_f32 v56, v56
    v_rcp_f32 v57, v57
    v_rcp_f32 v58, v58
    v_rcp_f32 v59, v59
    buffer_load_dwordx4 v6, s[12:15], s67 offen offset:1024 sc1 lds
    v_rcp_f32 v60, v60
    v_rcp_f32 v61, v61
    v_rcp_f32 v62, v62
    v_rcp_f32 v63, v63
    v_pk_mul_f32 v[72:73], v[72:73], v[56:57]
    v_pk_mul_f32 v[74:75], v[74:75], v[58:59]
    v_pk_mul_f32 v[76:77], v[76:77], v[60:61]
    v_pk_mul_f32 v[78:79], v[78:79], v[62:63]
    v_cvt_pk_bf16_f32 v64, v64, v65
    v_cvt_pk_bf16_f32 v65, v66, v67
    buffer_load_dwordx4 v6, s[12:15], s67 offen offset:2048 sc1 lds
    v_cvt_pk_bf16_f32 v66, v72, v73
    v_cvt_pk_bf16_f32 v67, v74, v75
    v_cvt_pk_bf16_f32 v68, v68, v69
    v_cvt_pk_bf16_f32 v69, v70, v71
    v_cvt_pk_bf16_f32 v70, v76, v77
    v_cvt_pk_bf16_f32 v71, v78, v79
    s_add_u32 s69, s68, 0
    s_add_u32 s70, s68, 9216
    s_cmp_eq_u32 s51, 1
    s_cbranch_scc0 L_alt_99
    buffer_store_dwordx4 v[64:67], v19, s[12:15], s69 offen
    buffer_store_dwordx4 v[68:71], v19, s[12:15], s70 offen
    s_branch L_altd_100
L_alt_99:
    buffer_store_dwordx4 v[64:67], v19, s[12:15], s69 offen sc1
    buffer_store_dwordx4 v[68:71], v19, s[12:15], s70 offen sc1
L_altd_100:
    v_pk_fma_f32 v[80:81], v[128:129], v[168:169], v[80:81] op_sel_hi:[1,0,1] neg_lo:[0,1,0] neg_hi:[0,1,0]
    v_pk_fma_f32 v[82:83], v[130:131], v[168:169], v[82:83] op_sel_hi:[1,0,1] neg_lo:[0,1,0] neg_hi:[0,1,0]
    v_pk_fma_f32 v[84:85], v[132:133], v[168:169], v[84:85] op_sel_hi:[1,0,1] neg_lo:[0,1,0] neg_hi:[0,1,0]
    v_pk_fma_f32 v[86:87], v[134:135], v[168:169], v[86:87] op_sel_hi:[1,0,1] neg_lo:[0,1,0] neg_hi:[0,1,0]
    v_pk_fma_f32 v[88:89], v[136:137], v[168:169], v[88:89] op_sel_hi:[1,0,1] neg_lo:[0,1,0] neg_hi:[0,1,0]
    v_pk_fma_f32 v[90:91], v[138:139], v[168:169], v[90:91] op_sel_hi:[1,0,1] neg_lo:[0,1,0] neg_hi:[0,1,0]
    v_pk_fma_f32 v[92:93], v[140:141], v[168:169], v[92:93] op_sel_hi:[1,0,1] neg_lo:[0,1,0] neg_hi:[0,1,0]
    v_pk_fma_f32 v[94:95], v[142:143], v[168:169], v[94:95] op_sel_hi:[1,0,1] neg_lo:[0,1,0] neg_hi:[0,1,0]
    v_pk_mul_f32 v[80:81], v[80:81], v[170:171] op_sel_hi:[1,0]
    v_pk_mul_f32 v[82:83], v[82:83], v[170:171] op_sel_hi:[1,0]
    buffer_load_dwordx4 v6, s[12:15], s67 offen offset:3072 sc1 lds
    v_pk_mul_f32 v[84:85], v[84:85], v[170:171] op_sel_hi:[1,0]
    v_pk_mul_f32 v[86:87], v[86:87], v[170:171] op_sel_hi:[1,0]
    v_pk_mul_f32 v[88:89], v[88:89], v[170:171] op_sel_hi:[1,0]
    v_pk_mul_f32 v[90:91], v[90:91], v[170:171] op_sel_hi:[1,0]
    v_pk_mul_f32 v[92:93], v[92:93], v[170:171] op_sel_hi:[1,0]
    v_pk_mul_f32 v[94:95], v[94:95], v[170:171] op_sel_hi:[1,0]
    v_pk_mul_f32 v[56:57], v[80:81], v[80:81]
    v_pk_mul_f32 v[58:59], v[82:83], v[82:83]
    v_pk_mul_f32 v[60:61], v[84:85], v[84:85]
    v_pk_mul_f32 v[62:63], v[86:87], v[86:87]
    s_add_u32 m0, s59, 24576
    s_add_u32 s67, s58, 18255872
    buffer_load_dwordx4 v6, s[12:15], s67 offen offset:0 sc1 lds
    v_pk_fma_f32 v[56:57], v[56:57], s[82:83], v[54:55] op_sel_hi:[1,1,0]
    v_pk_fma_f32 v[58:59], v[58:59], s[82:83], v[54:55] op_sel_hi:[1,1,0]
    v_pk_fma_f32 v[60:61], v[60:61], s[82:83], v[54:55] op_sel_hi:[1,1,0]
    v_pk_fma_f32 v[62:63], v[62:63], s[82:83], v[54:55] op_sel_hi:[1,1,0]
    v_pk_mul_f32 v[56:57], v[56:57], v[80:81]
    v_pk_mul_f32 v[58:59], v[58:59], v[82:83]
    v_pk_mul_f32 v[60:61], v[60:61], v[84:85]
    v_pk_mul_f32 v[62:63], v[62:63], v[86:87]
    v_exp_f32 v56, v56
    v_exp_f32 v57, v57
    s_add_u32 m0, s59, 40960
    s_add_u32 s67, s58, 18415616
    buffer_load_dwordx4 v6, s[12:15], s67 offen offset:0 sc1 lds
    v_exp_f32 v58, v58
    v_exp_f32 v59, v59
    v_exp_f32 v60, v60
    v_exp_f32 v61, v61
    v_exp_f32 v62, v62
    v_exp_f32 v63, v63
    v_pk_add_f32 v[56:57], v[56:57], 1.0 op_sel_hi:[1,0]
    v_pk_add_f32 v[58:59], v[58:59], 1.0 op_sel_hi:[1,0]
    v_pk_add_f32 v[60:61], v[60:61], 1.0 op_sel_hi:[1,0]
    v_pk_add_f32 v[62:63], v[62:63], 1.0 op_sel_hi:[1,0]
    buffer_load_dwordx4 v6, s[12:15], s67 offen offset:1024 sc1 lds
    v_rcp_f32 v56, v56
    v_rcp_f32 v57, v57
    v_rcp_f32 v58, v58
    v_rcp_f32 v59, v59
    v_rcp_f32 v60, v60
    v_rcp_f32 v61, v61
    v_rcp_f32 v62, v62
    v_rcp_f32 v63, v63
    v_pk_mul_f32 v[80:81], v[80:81], v[56:57]
    v_pk_mul_f32 v[82:83], v[82:83], v[58:59]
    buffer_load_dwordx4 v6, s[12:15], s67 offen offset:2048 sc1 lds
    v_pk_mul_f32 v[84:85], v[84:85], v[60:61]
    v_pk_mul_f32 v[86:87], v[86:87], v[62:63]
    v_pk_mul_f32 v[56:57], v[88:89], v[88:89]
    v_pk_mul_f32 v[58:59], v[90:91], v[90:91]
    v_pk_mul_f32 v[60:61], v[92:93], v[92:93]
    v_pk_mul_f32 v[62:63], v[94:95], v[94:95]
    v_pk_fma_f32 v[56:57], v[56:57], s[82:83], v[54:55] op_sel_hi:[1,1,0]
    v_pk_fma_f32 v[58:59], v[58:59], s[82:83], v[54:55] op_sel_hi:[1,1,0]
    v_pk_fma_f32 v[60:61], v[60:61], s[82:83], v[54:55] op_sel_hi:[1,1,0]
    v_pk_fma_f32 v[62:63], v[62:63], s[82:83], v[54:55] op_sel_hi:[1,1,0]
    buffer_load_dwordx4 v6, s[12:15], s67 offen offset:3072 sc1 lds
    v_pk_mul_f32 v[56:57], v[56:57], v[88:89]
    v_pk_mul_f32 v[58:59], v[58:59], v[90:91]
    v_pk_mul_f32 v[60:61], v[60:61], v[92:93]
    v_pk_mul_f32 v[62:63], v[62:63], v[94:95]
    v_exp_f32 v56, v56
    v_exp_f32 v57, v57
    v_exp_f32 v58, v58
    v_exp_f32 v59, v59
    v_exp_f32 v60, v60
    v_exp_f32 v61, v61
    s_add_u32 m0, s59, 45056
    s_add_u32 s67, s58, 18419712
    buffer_load_dwordx4 v6, s[12:15], s67 offen offset:0 sc1 lds
    v_exp_f32 v62, v62
    v_exp_f32 v63, v63
    v_pk_add_f32 v[56:57], v[56:57], 1.0 op_sel_hi:[1,0]
    v_pk_add_f32 v[58:59], v[58:59], 1.0 op_sel_hi:[1,0]
    v_pk_add_f32 v[60:61], v[60:61], 1.0 op_sel_hi:[1,0]
    v_pk_add_f32 v[62:63], v[62:63], 1.0 op_sel_hi:[1,0]
    v_rcp_f32 v56, v56
    v_rcp_f32 v57, v57
    v_rcp_f32 v58, v58
    v_rcp_f32 v59, v59
    v_rcp_f32 v60, v60
    v_rcp_f32 v61, v61
    v_rcp_f32 v62, v62
    v_rcp_f32 v63, v63
    v_pk_mul_f32 v[88:89], v[88:89], v[56:57]
    v_pk_mul_f32 v[90:91], v[90:91], v[58:59]
    v_pk_mul_f32 v[92:93], v[92:93], v[60:61]
    v_pk_mul_f32 v[94:95], v[94:95], v[62:63]
    v_cvt_pk_bf16_f32 v80, v80, v81
    v_cvt_pk_bf16_f32 v81, v82, v83
    v_cvt_pk_bf16_f32 v82, v88, v89
    v_cvt_pk_bf16_f32 v83, v90, v91
    v_cvt_pk_bf16_f32 v84, v84, v85
    v_cvt_pk_bf16_f32 v85, v86, v87
    v_cvt_pk_bf16_f32 v86, v92, v93
    v_cvt_pk_bf16_f32 v87, v94, v95
    s_add_u32 s69, s68, 18432
    s_add_u32 s70, s68, 27648
    s_cmp_eq_u32 s51, 1
    s_cbranch_scc0 L_alt_101
    buffer_store_dwordx4 v[80:83], v19, s[12:15], s69 offen
    buffer_store_dwordx4 v[84:87], v19, s[12:15], s70 offen
    s_branch L_altd_102
L_alt_101:
    buffer_store_dwordx4 v[80:83], v19, s[12:15], s69 offen sc1
    buffer_store_dwordx4 v[84:87], v19, s[12:15], s70 offen sc1
L_altd_102:
    v_pk_fma_f32 v[96:97], v[144:145], v[168:169], v[96:97] op_sel_hi:[1,0,1] neg_lo:[0,1,0] neg_hi:[0,1,0]
    v_pk_fma_f32 v[98:99], v[146:147], v[168:169], v[98:99] op_sel_hi:[1,0,1] neg_lo:[0,1,0] neg_hi:[0,1,0]
    v_pk_fma_f32 v[100:101], v[148:149], v[168:169], v[100:101] op_sel_hi:[1,0,1] neg_lo:[0,1,0] neg_hi:[0,1,0]
    v_pk_fma_f32 v[102:103], v[150:151], v[168:169], v[102:103] op_sel_hi:[1,0,1] neg_lo:[0,1,0] neg_hi:[0,1,0]
    v_pk_fma_f32 v[104:105], v[152:153], v[168:169], v[104:105] op_sel_hi:[1,0,1] neg_lo:[0,1,0] neg_hi:[0,1,0]
    v_pk_fma_f32 v[106:107], v[154:155], v[168:169], v[106:107] op_sel_hi:[1,0,1] neg_lo:[0,1,0] neg_hi:[0,1,0]
    v_pk_fma_f32 v[108:109], v[156:157], v[168:169], v[108:109] op_sel_hi:[1,0,1] neg_lo:[0,1,0] neg_hi:[0,1,0]
    v_pk_fma_f32 v[110:111], v[158:159], v[168:169], v[110:111] op_sel_hi:[1,0,1] neg_lo:[0,1,0] neg_hi:[0,1,0]
    v_pk_mul_f32 v[96:97], v[96:97], v[170:171] op_sel_hi:[1,0]
    v_pk_mul_f32 v[98:99], v[98:99], v[170:171] op_sel_hi:[1,0]
    v_pk_mul_f32 v[100:101], v[100:101], v[170:171] op_sel_hi:[1,0]
    v_pk_mul_f32 v[102:103], v[102:103], v[170:171] op_sel_hi:[1,0]
    v_pk_mul_f32 v[104:105], v[104:105], v[170:171] op_sel_hi:[1,0]
    v_pk_mul_f32 v[106:107], v[106:107], v[170:171] op_sel_hi:[1,0]
    v_pk_mul_f32 v[108:109], v[108:109], v[170:171] op_sel_hi:[1,0]
    v_pk_mul_f32 v[110:111], v[110:111], v[170:171] op_sel_hi:[1,0]
    v_pk_mul_f32 v[56:57], v[96:97], v[96:97]
    v_pk_mul_f32 v[58:59], v[98:99], v[98:99]
    v_pk_mul_f32 v[60:61], v[100:101], v[100:101]
    v_pk_mul_f32 v[62:63], v[102:103], v[102:103]
    v_pk_fma_f32 v[56:57], v[56:57], s[82:83], v[54:55] op_sel_hi:[1,1,0]
    v_pk_fma_f32 v[58:59], v[58:59], s[82:83], v[54:55] op_sel_hi:[1,1,0]
    v_pk_fma_f32 v[60:61], v[60:61], s[82:83], v[54:55] op_sel_hi:[1,1,0]
    v_pk_fma_f32 v[62:63], v[62:63], s[82:83], v[54:55] op_sel_hi:[1,1,0]
    v_pk_mul_f32 v[56:57], v[56:57], v[96:97]
    v_pk_mul_f32 v[58:59], v[58:59], v[98:99]
    v_pk_mul_f32 v[60:61], v[60:61], v[100:101]
    v_pk_mul_f32 v[62:63], v[62:63], v[102:103]
    v_exp_f32 v56, v56
    v_exp_f32 v57, v57
    v_exp_f32 v58, v58
    v_exp_f32 v59, v59
    v_exp_f32 v60, v60
    v_exp_f32 v61, v61
    v_exp_f32 v62, v62
    v_exp_f32_e64 v63, v63
    v_pk_add_f32 v[56:57], v[56:57], 1.0 op_sel_hi:[1,0]
    v_pk_add_f32 v[58:59], v[58:59], 1.0 op_sel_hi:[1,0]
    v_pk_add_f32 v[60:61], v[60:61], 1.0 op_sel_hi:[1,0]
    v_pk_add_f32 v[62:63], v[62:63], 1.0 op_sel_hi:[1,0]
    v_rcp_f32 v56, v56
    v_rcp_f32 v57, v57
    v_rcp_f32 v58, v58
    v_rcp_f32 v59, v59
    v_rcp_f32 v60, v60
    v_rcp_f32 v61, v61
    v_rcp_f32 v62, v62
    v_rcp_f32 v63, v63
    v_pk_mul_f32 v[96:97], v[96:97], v[56:57]
    v_pk_mul_f32 v[98:99], v[98:99], v[58:59]
    v_pk_mul_f32 v[100:101], v[100:101], v[60:61]
    v_pk_mul_f32 v[102:103], v[102:103], v[62:63]
    v_pk_mul_f32 v[56:57], v[104:105], v[104:105]
    v_pk_mul_f32 v[58:59], v[106:107], v[106:107]
    v_pk_mul_f32 v[60:61], v[108:109], v[108:109]
    v_pk_mul_f32 v[62:63], v[110:111], v[110:111]
    v_pk_fma_f32 v[56:57], v[56:57], s[82:83], v[54:55] op_sel_hi:[1,1,0]
    v_pk_fma_f32 v[58:59], v[58:59], s[82:83], v[54:55] op_sel_hi:[1,1,0]
    v_pk_fma_f32 v[60:61], v[60:61], s[82:83], v[54:55] op_sel_hi:[1,1,0]
    v_pk_fma_f32 v[62:63], v[62:63], s[82:83], v[54:55] op_sel_hi:[1,1,0]
    v_pk_mul_f32 v[56:57], v[56:57], v[104:105]
    v_pk_mul_f32 v[58:59], v[58:59], v[106:107]
    v_pk_mul_f32 v[60:61], v[60:61], v[108:109]
    v_pk_mul_f32 v[62:63], v[62:63], v[110:111]
    v_exp_f32 v56, v56
    v_exp_f32 v57, v57
    v_exp_f32 v58, v58
    v_exp_f32 v59, v59
    v_exp_f32 v60, v60
    v_exp_f32 v61, v61
    v_exp_f32 v62, v62
    v_exp_f32 v63, v63
    v_pk_add_f32 v[56:57], v[56:57], 1.0 op_sel_hi:[1,0]
    v_pk_add_f32 v[58:59], v[58:59], 1.0 op_sel_hi:[1,0]
    v_pk_add_f32 v[60:61], v[60:61], 1.0 op_sel_hi:[1,0]
    v_pk_add_f32 v[62:63], v[62:63], 1.0 op_sel_hi:[1,0]
    v_rcp_f32 v56, v56
    v_rcp_f32 v57, v57
    v_rcp_f32 v58, v58
    v_rcp_f32 v59, v59
    v_rcp_f32 v60, v60
    v_rcp_f32 v61, v61
    v_rcp_f32 v62, v62
    v_rcp_f32 v63, v63
    v_pk_mul_f32 v[104:105], v[104:105], v[56:57]
    v_pk_mul_f32 v[106:107], v[106:107], v[58:59]
    v_pk_mul_f32 v[108:109], v[108:109], v[60:61]
    v_pk_mul_f32 v[110:111], v[110:111], v[62:63]
    v_cvt_pk_bf16_f32 v96, v96, v97
    v_cvt_pk_bf16_f32 v97, v98, v99
    v_cvt_pk_bf16_f32 v98, v104, v105
    v_cvt_pk_bf16_f32 v99, v106, v107
    v_cvt_pk_bf16_f32 v100, v100, v101
    v_cvt_pk_bf16_f32 v101, v102, v103
    v_cvt_pk_bf16_f32 v102, v108, v109
    v_cvt_pk_bf16_f32 v103, v110, v111
    s_add_u32 s69, s68, 36864
    s_add_u32 s70, s68, 46080
    s_cmp_eq_u32 s51, 1
    s_cbranch_scc0 L_alt_103
    buffer_store_dwordx4 v[96:99], v19, s[12:15], s69 offen
    buffer_store_dwordx4 v[100:103], v19, s[12:15], s70 offen
    s_branch L_altd_104
L_alt_103:
    buffer_store_dwordx4 v[96:99], v19, s[12:15], s69 offen sc1
    buffer_store_dwordx4 v[100:103], v19, s[12:15], s70 offen sc1
L_altd_104:
    s_waitcnt vmcnt(0)
    v_mov_b32 v48, 7
    v_mov_b32 v49, 0
    s_mov_b64 exec, 1
    s_cmp_eq_u32 s51, 1
    s_cbranch_scc0 L_alt_105
    buffer_store_dword v48, v49, s[12:15], s52 offen
    s_branch L_altd_106
L_alt_105:
    buffer_store_dword v48, v49, s[12:15], s52 offen sc1
L_altd_106:
    s_mov_b64 exec, -1
    ds_read_b128 v[84:87], v10 offset:13312
    ds_read_b128 v[88:91], v10 offset:14336
    ds_read_b128 v[92:95], v10 offset:15360
    ds_read_b128 v[96:99], v10 offset:16384
    ds_read_b128 v[100:103], v10 offset:17408
    ds_read_b128 v[104:107], v10 offset:18432
    ds_read_b128 v[108:111], v10 offset:19456
    ds_read_b128 v[112:115], v10 offset:20480
    ds_read_b128 v[116:119], v10 offset:21504
    ds_read_b128 v[120:123], v10 offset:22528
    ds_read_b128 v[124:127], v10 offset:23552
    ds_read_b128 v[128:131], v10 offset:24576
    ds_read_b128 v[132:135], v10 offset:25600
    ds_read_b128 v[136:139], v10 offset:26624
    ds_read_b128 v[140:143], v10 offset:27648
    ds_read_b128 v[144:147], v10 offset:28672
    ds_read_b128 v[148:151], v10 offset:29696
    ds_read_b128 v[152:155], v10 offset:30720
    ds_read_b128 v[156:159], v10 offset:31744
    ds_read_b128 v[160:163], v10 offset:32768
    ds_read_b128 v[164:167], v10 offset:33792
    ds_read_b128 v[168:171], v10 offset:34816
    s_lshr_b32 s68, s49, 2
    s_lshl_b32 s74, 0x11111111, s68
    s_mov_b32 s75, s74
    s_waitcnt lgkmcnt(0)
    s_barrier
    s_add_u32 m0, s59, 61440
    s_add_u32 s67, s58, 18579456
    buffer_load_dwordx4 v6, s[12:15], s67 offen offset:0 sc1 lds
    buffer_load_dwordx4 v6, s[12:15], s67 offen offset:1024 sc1 lds
    buffer_load_dwordx4 v6, s[12:15], s67 offen offset:2048 sc1 lds
    buffer_load_dwordx4 v6, s[12:15], s67 offen offset:3072 sc1 lds
    s_add_u32 m0, s59, 65536
    s_add_u32 s67, s58, 18583552
    buffer_load_dwordx4 v6, s[12:15], s67 offen offset:0 sc1 lds
    s_lshl_b32 s66, s49, 8
    s_add_u32 s66, s66, s50
    s_add_u32 s66, s66, 368832
    s_mov_b64 exec, s[74:75]
    s_mov_b32 s56, 0
L_sp_107:
    buffer_load_dwordx2 v[48:49], v8, s[12:15], s53 offen sc1
    s_add_u32 s56, s56, 1
    s_waitcnt vmcnt(0)
    v_min_u32 v48, v48, v49
    v_cmp_gt_u32 vcc, 7, v48
    s_cmp_gt_u32 s56, 200000
    s_cbranch_scc1 L_spo_108
    s_cbranch_vccnz L_sp_107
L_spo_108:
    s_mov_b64 exec, -1
    buffer_load_dwordx4 a[0:3], v3, s[12:15], s66 offen offset:64 sc1
    s_add_u32 s66, s66, 18432
    buffer_load_dwordx4 a[4:7], v3, s[12:15], s66 offen offset:64 sc1
    s_add_u32 s66, s66, 18432
    buffer_load_dwordx4 a[8:11], v3, s[12:15], s66 offen offset:64 sc1
    s_add_u32 s66, s66, 18432
    buffer_load_dwordx4 a[12:15], v3, s[12:15], s66 offen offset:64 sc1
    s_add_u32 s66, s66, 18432
    buffer_load_dwordx4 a[16:19], v3, s[12:15], s66 offen offset:64 sc1
    s_add_u32 s66, s66, 18432
    buffer_load_dwordx4 a[20:23], v3, s[12:15], s66 offen offset:64 sc1
    s_add_u32 s66, s66, 18432
    buffer_load_dwordx4 a[24:27], v3, s[12:15], s66 offen offset:64 sc1
    s_add_u32 s66, s66, 18432
    buffer_load_dwordx4 a[28:31], v3, s[12:15], s66 offen offset:64 sc1
    s_add_u32 s66, s66, 18432
    buffer_load_dwordx4 a[32:35], v3, s[12:15], s66 offen offset:64 sc1
    s_add_u32 s66, s66, 18432
    buffer_load_dwordx4 a[36:39], v3, s[12:15], s66 offen offset:64 sc1
    s_branch L_sk8
L_stub8:
    s_setpc_b64 s[98:99]
L_sk8:
    s_add_u32 s66, s66, 18432
    s_waitcnt vmcnt(9)
    v_mfma_f32_16x16x32_bf16 v[64:67], a[124:127], a[0:3], 0
    buffer_load_dwordx4 a[40:43], v3, s[12:15], s66 offen offset:64 sc1
    ds_read_b128 a[124:127], v10 offset:35840
    v_mfma_f32_16x16x32_bf16 v[68:71], a[128:131], a[0:3], 0
    s_add_u32 s66, s66, 18432
    ds_read_b128 a[128:131], v10 offset:36864
    v_mfma_f32_16x16x32_bf16 v[72:75], a[132:135], a[0:3], 0
    ds_read_b128 a[132:135], v10 offset:37888
    v_mfma_f32_16x16x32_bf16 v[76:79], a[136:139], a[0:3], 0
    ds_read_b128 a[136:139], v10 offset:38912
    v_mfma_f32_16x16x32_bf16 v[80:83], a[140:143], a[0:3], 0
    ds_read_b128 a[140:143], v10 offset:39936
    s_waitcnt vmcnt(9)
    v_mfma_f32_16x16x32_bf16 v[64:67], a[144:147], a[4:7], v[64:67]
    buffer_load_dwordx4 a[44:47], v3, s[12:15], s66 offen offset:64 sc1
    ds_read_b128 a[144:147], v10 offset:40960
    v_mfma_f32_16x16x32_bf16 v[68:71], a[148:151], a[4:7], v[68:71]
    s_add_u32 s66, s66, 18432
    ds_read_b128 a[148:151], v10 offset:41984
    v_mfma_f32_16x16x32_bf16 v[72:75], a[152:155], a[4:7], v[72:75]
    ds_read_b128 a[152:155], v10 offset:43008
    v_mfma_f32_16x16x32_bf16 v[76:79], a[156:159], a[4:7], v[76:79]
    ds_read_b128 a[156:159], v10 offset:44032
    v_mfma_f32_16x16x32_bf16 v[80:83], a[160:163], a[4:7], v[80:83]
    ds_read_b128 a[160:163], v10 offset:45056
    s_waitcnt vmcnt(9)
    v_mfma_f32_16x16x32_bf16 v[64:67], a[164:167], a[8:11], v[64:67]
    buffer_load_dwordx4 a[0:3], v3, s[12:15], s66 offen offset:64 sc1
    ds_read_b128 a[164:167], v10 offset:46080
    v_mfma_f32_16x16x32_bf16 v[68:71], a[168:171], a[8:11], v[68:71]
    s_add_u32 s66, s66, 18432
    ds_read_b128 a[168:171], v10 offset:47104
    v_mfma_f32_16x16x32_bf16 v[72:75], a[172:175], a[8:11], v[72:75]
    ds_read_b128 a[172:175], v10 offset:48128
    v_mfma_f32_16x16x32_bf16 v[76:79], a[176:179], a[8:11], v[76:79]
    ds_read_b128 a[176:179], v10 offset:49152
    v_mfma_f32_16x16x32_bf16 v[80:83], a[180:183], a[8:11], v[80:83]
    ds_read_b128 a[180:183], v10 offset:50176
    s_waitcnt vmcnt(9)
    v_mfma_f32_16x16x32_bf16 v[64:67], a[184:187], a[12:15], v[64:67]
    buffer_load_dwordx4 a[4:7], v3, s[12:15], s66 offen offset:64 sc1
    ds_read_b128 a[184:187], v10 offset:51200
    v_mfma_f32_16x16x32_bf16 v[68:71], a[188:191], a[12:15], v[68:71]
    s_add_u32 s66, s66, 18432
    ds_read_b128 a[188:191], v10 offset:52224
    v_mfma_f32_16x16x32_bf16 v[72:75], a[192:195], a[12:15], v[72:75]
    ds_read_b128 a[192:195], v10 offset:53248
    v_mfma_f32_16x16x32_bf16 v[76:79], a[196:199], a[12:15], v[76:79]
    ds_read_b128 a[196:199], v10 offset:54272
    v_mfma_f32_16x16x32_bf16 v[80:83], a[200:203], a[12:15], v[80:83]
    ds_read_b128 a[200:203], v10 offset:55296
    s_waitcnt vmcnt(9)
    v_mfma_f32_16x16x32_bf16 v[64:67], a[204:207], a[16:19], v[64:67]
    buffer_load_dwordx4 a[8:11], v3, s[12:15], s66 offen offset:64 sc1
    ds_read_b128 a[204:207], v10 offset:56320
    v_mfma_f32_16x16x32_bf16 v[68:71], a[208:211], a[16:19], v[68:71]
    s_add_u32 s66, s66, 18432
    ds_read_b128 a[208:211], v10 offset:57344
    v_mfma_f32_16x16x32_bf16 v[72:75], a[212:215], a[16:19], v[72:75]
    ds_read_b128 a[212:215], v10 offset:58368
    v_mfma_f32_16x16x32_bf16 v[76:79], a[216:219], a[16:19], v[76:79]
    ds_read_b128 a[216:219], v10 offset:59392
    v_mfma_f32_16x16x32_bf16 v[80:83], a[220:223], a[16:19], v[80:83]
    ds_read_b128 a[220:223], v10 offset:60416
    s_barrier
    s_waitcnt vmcnt(9)
    v_mfma_f32_16x16x32_bf16 v[64:67], a[224:227], a[20:23], v[64:67]
    buffer_load_dwordx4 a[12:15], v3, s[12:15], s66 offen offset:64 sc1
    ds_read_b128 a[224:227], v11 offset:0
    v_mfma_f32_16x16x32_bf16 v[68:71], a[228:231], a[20:23], v[68:71]
    s_add_u32 s66, s66, 18432
    ds_read_b128 a[228:231], v11 offset:1024
    v_mfma_f32_16x16x32_bf16 v[72:75], a[232:235], a[20:23], v[72:75]
    ds_read_b128 a[232:235], v11 offset:2048
    v_mfma_f32_16x16x32_bf16 v[76:79], a[236:239], a[20:23], v[76:79]
    ds_read_b128 a[236:239], v11 offset:3072
    v_mfma_f32_16x16x32_bf16 v[80:83], a[240:243], a[20:23], v[80:83]
    ds_read_b128 a[240:243], v11 offset:4096
    s_waitcnt vmcnt(9)
    v_mfma_f32_16x16x32_bf16 v[64:67], a[244:247], a[24:27], v[64:67]
    buffer_load_dwordx4 a[16:19], v3, s[12:15], s66 offen offset:64 sc1
    ds_read_b128 a[244:247], v11 offset:5120
    v_mfma_f32_16x16x32_bf16 v[68:71], a[248:251], a[24:27], v[68:71]
    s_add_u32 s66, s66, 18432
    ds_read_b128 a[248:251], v11 offset:6144
    v_mfma_f32_16x16x32_bf16 v[72:75], a[252:255], a[24:27], v[72:75]
    ds_read_b128 a[252:255], v11 offset:7168
    v_mfma_f32_16x16x32_bf16 v[76:79], v[172:175], a[24:27], v[76:79]
    ds_read_b128 v[172:175], v11 offset:8192
    v_mfma_f32_16x16x32_bf16 v[80:83], v[176:179], a[24:27], v[80:83]
    ds_read_b128 v[176:179], v11 offset:9216
    s_waitcnt vmcnt(9)
    v_mfma_f32_16x16x32_bf16 v[64:67], v[180:183], a[28:31], v[64:67]
    buffer_load_dwordx4 a[20:23], v3, s[12:15], s66 offen offset:64 sc1
    ds_read_b128 v[180:183], v11 offset:10240
    v_mfma_f32_16x16x32_bf16 v[68:71], v[184:187], a[28:31], v[68:71]
    s_add_u32 s66, s66, 18432
    ds_read_b128 v[184:187], v11 offset:11264
    v_mfma_f32_16x16x32_bf16 v[72:75], v[188:191], a[28:31], v[72:75]
    ds_read_b128 v[188:191], v11 offset:12288
    v_mfma_f32_16x16x32_bf16 v[76:79], v[192:195], a[28:31], v[76:79]
    ds_read_b128 v[192:195], v11 offset:13312
    v_mfma_f32_16x16x32_bf16 v[80:83], v[196:199], a[28:31], v[80:83]
    ds_read_b128 v[196:199], v11 offset:14336
    s_waitcnt vmcnt(9)
    v_mfma_f32_16x16x32_bf16 v[64:67], v[200:203], a[32:35], v[64:67]
    buffer_load_dwordx4 a[24:27], v3, s[12:15], s66 offen offset:64 sc1
    ds_read_b128 v[200:203], v11 offset:15360
    v_mfma_f32_16x16x32_bf16 v[68:71], v[204:207], a[32:35], v[68:71]
    s_add_u32 s66, s66, 18432
    ds_read_b128 v[204:207], v11 offset:16384
    v_mfma_f32_16x16x32_bf16 v[72:75], v[208:211], a[32:35], v[72:75]
    ds_read_b128 v[208:211], v11 offset:17408
    v_mfma_f32_16x16x32_bf16 v[76:79], v[212:215], a[32:35], v[76:79]
    ds_read_b128 v[212:215], v11 offset:18432
    v_mfma_f32_16x16x32_bf16 v[80:83], v[216:219], a[32:35], v[80:83]
    ds_read_b128 v[216:219], v11 offset:19456
    s_waitcnt vmcnt(9)
    v_mfma_f32_16x16x32_bf16 v[64:67], v[220:223], a[36:39], v[64:67]
    buffer_load_dwordx4 a[28:31], v3, s[12:15], s66 offen offset:64 sc1
    ds_read_b128 v[220:223], v11 offset:20480
    v_mfma_f32_16x16x32_bf16 v[68:71], v[224:227], a[36:39], v[68:71]
    s_add_u32 s66, s66, 18432
    ds_read_b128 v[224:227], v11 offset:21504
    v_mfma_f32_16x16x32_bf16 v[72:75], v[228:231], a[36:39], v[72:75]
    ds_read_b128 v[228:231], v11 offset:22528
    v_mfma_f32_16x16x32_bf16 v[76:79], v[232:235], a[36:39], v[76:79]
    ds_read_b128 v[232:235], v11 offset:23552
    v_mfma_f32_16x16x32_bf16 v[80:83], v[236:239], a[36:39], v[80:83]
    ds_read_b128 v[236:239], v11 offset:24576
    s_waitcnt vmcnt(9)
    v_mfma_f32_16x16x32_bf16 v[64:67], v[240:243], a[40:43], v[64:67]
    buffer_load_dwordx4 a[32:35], v3, s[12:15], s66 offen offset:64 sc1
    ds_read_b128 v[240:243], v11 offset:25600
    v_mfma_f32_16x16x32_bf16 v[68:71], v[244:247], a[40:43], v[68:71]
    s_add_u32 s66, s66, 18432
    ds_read_b128 v[244:247], v11 offset:26624
    v_mfma_f32_16x16x32_bf16 v[72:75], v[248:251], a[40:43], v[72:75]
    ds_read_b128 v[248:251], v11 offset:27648
    v_mfma_f32_16x16x32_bf16 v[76:79], v[252:255], a[40:43], v[76:79]
    ds_read_b128 v[252:255], v11 offset:28672
    v_mfma_f32_16x16x32_bf16 v[80:83], a[48:51], a[40:43], v[80:83]
    ds_read_b128 a[48:51], v11 offset:29696
    s_waitcnt vmcnt(9)
    v_mfma_f32_16x16x32_bf16 v[64:67], a[52:55], a[44:47], v[64:67]
    buffer_load_dwordx4 a[36:39], v3, s[12:15], s66 offen offset:64 sc1
    ds_read_b128 a[52:55], v11 offset:30720
    v_mfma_f32_16x16x32_bf16 v[68:71], a[56:59], a[44:47], v[68:71]
    s_add_u32 s66, s66, 18432
    ds_read_b128 a[56:59], v11 offset:31744
    v_mfma_f32_16x16x32_bf16 v[72:75], a[60:63], a[44:47], v[72:75]
    ds_read_b128 a[60:63], v11 offset:32768
    v_mfma_f32_16x16x32_bf16 v[76:79], a[64:67], a[44:47], v[76:79]
    ds_read_b128 a[64:67], v11 offset:33792
    v_mfma_f32_16x16x32_bf16 v[80:83], a[68:71], a[44:47], v[80:83]
    ds_read_b128 a[68:71], v11 offset:34816
    s_waitcnt vmcnt(9)
    v_mfma_f32_16x16x32_bf16 v[64:67], a[72:75], a[0:3], v[64:67]
    buffer_load_dwordx4 a[40:43], v3, s[12:15], s66 offen offset:64 sc1
    ds_read_b128 a[72:75], v11 offset:35840
    v_mfma_f32_16x16x32_bf16 v[68:71], a[76:79], a[0:3], v[68:71]
    s_add_u32 s66, s66, 18432
    ds_read_b128 a[76:79], v11 offset:36864
    v_mfma_f32_16x16x32_bf16 v[72:75], a[80:83], a[0:3], v[72:75]
    ds_read_b128 a[80:83], v11 offset:37888
    v_mfma_f32_16x16x32_bf16 v[76:79], a[84:87], a[0:3], v[76:79]
    ds_read_b128 a[84:87], v11 offset:38912
    v_mfma_f32_16x16x32_bf16 v[80:83], a[88:91], a[0:3], v[80:83]
    ds_read_b128 a[88:91], v11 offset:39936
    s_waitcnt vmcnt(9)
    v_mfma_f32_16x16x32_bf16 v[64:67], a[92:95], a[4:7], v[64:67]
    buffer_load_dwordx4 a[44:47], v3, s[12:15], s66 offen offset:64 sc1
    ds_read_b128 a[92:95], v6 offset:0
    v_mfma_f32_16x16x32_bf16 v[68:71], a[96:99], a[4:7], v[68:71]
    s_add_u32 s66, s66, 18432
    ds_read_b128 a[96:99], v6 offset:1024
    v_mfma_f32_16x16x32_bf16 v[72:75], a[100:103], a[4:7], v[72:75]
    ds_read_b128 a[100:103], v6 offset:2048
    v_mfma_f32_16x16x32_bf16 v[76:79], a[104:107], a[4:7], v[76:79]
    ds_read_b128 a[104:107], v6 offset:3072
    v_mfma_f32_16x16x32_bf16 v[80:83], a[108:111], a[4:7], v[80:83]
    ds_read_b128 a[108:111], v6 offset:4096
    s_waitcnt vmcnt(9)
    v_mfma_f32_16x16x32_bf16 v[64:67], a[112:115], a[8:11], v[64:67]
    buffer_load_dwordx4 a[0:3], v3, s[12:15], s66 offen offset:64 sc1
    ds_read_b128 a[112:115], v6 offset:5120
    v_mfma_f32_16x16x32_bf16 v[68:71], a[116:119], a[8:11], v[68:71]
    s_add_u32 s66, s66, 18432
    ds_read_b128 a[116:119], v6 offset:6144
    v_mfma_f32_16x16x32_bf16 v[72:75], a[120:123], a[8:11], v[72:75]
    ds_read_b128 a[120:123], v6 offset:7168
    v_mfma_f32_16x16x32_bf16 v[76:79], v[84:87], a[8:11], v[76:79]
    ds_read_b128 v[84:87], v6 offset:8192
    v_mfma_f32_16x16x32_bf16 v[80:83], v[88:91], a[8:11], v[80:83]
    ds_read_b128 v[88:91], v6 offset:9216
    s_waitcnt vmcnt(9)
    v_mfma_f32_16x16x32_bf16 v[64:67], v[92:95], a[12:15], v[64:67]
    buffer_load_dwordx4 a[4:7], v3, s[12:15], s66 offen offset:64 sc1
    ds_read_b128 v[92:95], v6 offset:10240
    v_mfma_f32_16x16x32_bf16 v[68:71], v[96:99], a[12:15], v[68:71]
    s_add_u32 s66, s66, 18432
    ds_read_b128 v[96:99], v6 offset:11264
    v_mfma_f32_16x16x32_bf16 v[72:75], v[100:103], a[12:15], v[72:75]
    ds_read_b128 v[100:103], v6 offset:12288
    v_mfma_f32_16x16x32_bf16 v[76:79], v[104:107], a[12:15], v[76:79]
    ds_read_b128 v[104:107], v6 offset:13312
    v_mfma_f32_16x16x32_bf16 v[80:83], v[108:111], a[12:15], v[80:83]
    ds_read_b128 v[108:111], v6 offset:14336
    s_waitcnt vmcnt(9)
    v_mfma_f32_16x16x32_bf16 v[64:67], v[112:115], a[16:19], v[64:67]
    buffer_load_dwordx4 a[8:11], v3, s[12:15], s66 offen offset:64 sc1
    ds_read_b128 v[112:115], v6 offset:15360
    v_mfma_f32_16x16x32_bf16 v[68:71], v[116:119], a[16:19], v[68:71]
    s_add_u32 s66, s66, 18432
    ds_read_b128 v[116:119], v6 offset:16384
    v_mfma_f32_16x16x32_bf16 v[72:75], v[120:123], a[16:19], v[72:75]
    ds_read_b128 v[120:123], v6 offset:17408
    v_mfma_f32_16x16x32_bf16 v[76:79], v[124:127], a[16:19], v[76:79]
    ds_read_b128 v[124:127], v6 offset:18432
    v_mfma_f32_16x16x32_bf16 v[80:83], v[128:131], a[16:19], v[80:83]
    ds_read_b128 v[128:131], v6 offset:19456
    s_waitcnt vmcnt(9)
    v_mfma_f32_16x16x32_bf16 v[64:67], v[132:135], a[20:23], v[64:67]
    buffer_load_dwordx4 a[12:15], v3, s[12:15], s66 offen offset:64 sc1
    ds_read_b128 v[132:135], v6 offset:20480
    v_mfma_f32_16x16x32_bf16 v[68:71], v[136:139], a[20:23], v[68:71]
    s_add_u32 s66, s66, 18432
    ds_read_b128 v[136:139], v6 offset:21504
    v_mfma_f32_16x16x32_bf16 v[72:75], v[140:143], a[20:23], v[72:75]
    ds_read_b128 v[140:143], v6 offset:22528
    v_mfma_f32_16x16x32_bf16 v[76:79], v[144:147], a[20:23], v[76:79]
    ds_read_b128 v[144:147], v6 offset:23552
    v_mfma_f32_16x16x32_bf16 v[80:83], v[148:151], a[20:23], v[80:83]
    ds_read_b128 v[148:151], v6 offset:24576
    s_waitcnt vmcnt(9)
    v_mfma_f32_16x16x32_bf16 v[64:67], v[152:155], a[24:27], v[64:67]
    buffer_load_dwordx4 a[16:19], v3, s[12:15], s66 offen offset:64 sc1
    ds_read_b128 v[152:155], v6 offset:25600
    v_mfma_f32_16x16x32_bf16 v[68:71], v[156:159], a[24:27], v[68:71]
    s_add_u32 s66, s66, 18432
    ds_read_b128 v[156:159], v6 offset:26624
    v_mfma_f32_16x16x32_bf16 v[72:75], v[160:163], a[24:27], v[72:75]
    ds_read_b128 v[160:163], v6 offset:27648
    v_mfma_f32_16x16x32_bf16 v[76:79], v[164:167], a[24:27], v[76:79]
    ds_read_b128 v[164:167], v6 offset:28672
    v_mfma_f32_16x16x32_bf16 v[80:83], v[168:171], a[24:27], v[80:83]
    ds_read_b128 v[168:171], v6 offset:29696
    s_waitcnt vmcnt(9) lgkmcnt(15)
    v_mfma_f32_16x16x32_bf16 v[64:67], a[124:127], a[28:31], v[64:67]
    buffer_load_dwordx4 a[20:23], v3, s[12:15], s66 offen offset:64 sc1
    ds_read_b128 a[124:127], v6 offset:30720
    v_mfma_f32_16x16x32_bf16 v[68:71], a[128:131], a[28:31], v[68:71]
    s_add_u32 s66, s66, 18432
    ds_read_b128 a[128:131], v6 offset:31744
    v_mfma_f32_16x16x32_bf16 v[72:75], a[132:135], a[28:31], v[72:75]
    ds_read_b128 a[132:135], v6 offset:32768
    v_mfma_f32_16x16x32_bf16 v[76:79], a[136:139], a[28:31], v[76:79]
    ds_read_b128 a[136:139], v6 offset:33792
    v_mfma_f32_16x16x32_bf16 v[80:83], a[140:143], a[28:31], v[80:83]
    ds_read_b128 a[140:143], v6 offset:34816
    s_waitcnt vmcnt(9) lgkmcnt(15)
    v_mfma_f32_16x16x32_bf16 v[64:67], a[144:147], a[32:35], v[64:67]
    buffer_load_dwordx4 a[24:27], v3, s[12:15], s66 offen offset:64 sc1
    ds_read_b128 a[144:147], v6 offset:35840
    v_mfma_f32_16x16x32_bf16 v[68:71], a[148:151], a[32:35], v[68:71]
    s_add_u32 s66, s66, 18432
    ds_read_b128 a[148:151], v6 offset:36864
    v_mfma_f32_16x16x32_bf16 v[72:75], a[152:155], a[32:35], v[72:75]
    ds_read_b128 a[152:155], v6 offset:37888
    v_mfma_f32_16x16x32_bf16 v[76:79], a[156:159], a[32:35], v[76:79]
    ds_read_b128 a[156:159], v6 offset:38912
    v_mfma_f32_16x16x32_bf16 v[80:83], a[160:163], a[32:35], v[80:83]
    ds_read_b128 a[160:163], v6 offset:39936
    s_waitcnt vmcnt(9) lgkmcnt(15)
    v_mfma_f32_16x16x32_bf16 v[64:67], a[164:167], a[36:39], v[64:67]
    buffer_load_dwordx4 a[28:31], v3, s[12:15], s66 offen offset:64 sc1
    ds_read_b128 a[164:167], v6 offset:40960
    v_mfma_f32_16x16x32_bf16 v[68:71], a[168:171], a[36:39], v[68:71]
    s_add_u32 s66, s66, 18432
    ds_read_b128 a[168:171], v6 offset:41984
    v_mfma_f32_16x16x32_bf16 v[72:75], a[172:175], a[36:39], v[72:75]
    ds_read_b128 a[172:175], v6 offset:43008
    v_mfma_f32_16x16x32_bf16 v[76:79], a[176:179], a[36:39], v[76:79]
    ds_read_b128 a[176:179], v6 offset:44032
    v_mfma_f32_16x16x32_bf16 v[80:83], a[180:183], a[36:39], v[80:83]
    ds_read_b128 a[180:183], v6 offset:45056
    s_waitcnt vmcnt(9) lgkmcnt(15)
    v_mfma_f32_16x16x32_bf16 v[64:67], a[184:187], a[40:43], v[64:67]
    buffer_load_dwordx4 a[32:35], v3, s[12:15], s66 offen offset:64 sc1
    ds_read_b128 a[184:187], v6 offset:46080
    v_mfma_f32_16x16x32_bf16 v[68:71], a[188:191], a[40:43], v[68:71]
    s_add_u32 s66, s66, 18432
    ds_read_b128 a[188:191], v6 offset:47104
    v_mfma_f32_16x16x32_bf16 v[72:75], a[192:195], a[40:43], v[72:75]
    ds_read_b128 a[192:195], v6 offset:48128
    v_mfma_f32_16x16x32_bf16 v[76:79], a[196:199], a[40:43], v[76:79]
    ds_read_b128 a[196:199], v6 offset:49152
    v_mfma_f32_16x16x32_bf16 v[80:83], a[200:203], a[40:43], v[80:83]
    ds_read_b128 a[200:203], v6 offset:50176
    s_waitcnt vmcnt(9) lgkmcnt(15)
    v_mfma_f32_16x16x32_bf16 v[64:67], a[204:207], a[44:47], v[64:67]
    buffer_load_dwordx4 a[36:39], v3, s[12:15], s66 offen offset:64 sc1
    ds_read_b128 a[204:207], v6 offset:51200
    v_mfma_f32_16x16x32_bf16 v[68:71], a[208:211], a[44:47], v[68:71]
    s_add_u32 s66, s66, 18432
    ds_read_b128 a[208:211], v6 offset:52224
    v_mfma_f32_16x16x32_bf16 v[72:75], a[212:215], a[44:47], v[72:75]
    ds_read_b128 a[212:215], v6 offset:53248
    v_mfma_f32_16x16x32_bf16 v[76:79], a[216:219], a[44:47], v[76:79]
    ds_read_b128 a[216:219], v6 offset:54272
    v_mfma_f32_16x16x32_bf16 v[80:83], a[220:223], a[44:47], v[80:83]
    ds_read_b128 a[220:223], v6 offset:55296
    s_waitcnt vmcnt(9) lgkmcnt(15)
    v_mfma_f32_16x16x32_bf16 v[64:67], a[224:227], a[0:3], v[64:67]
    buffer_load_dwordx4 a[40:43], v3, s[12:15], s66 offen offset:64 sc1
    ds_read_b128 a[224:227], v6 offset:56320
    v_mfma_f32_16x16x32_bf16 v[68:71], a[228:231], a[0:3], v[68:71]
    s_add_u32 s66, s66, 18432
    ds_read_b128 a[228:231], v6 offset:57344
    v_mfma_f32_16x16x32_bf16 v[72:75], a[232:235], a[0:3], v[72:75]
    ds_read_b128 a[232:235], v6 offset:58368
    v_mfma_f32_16x16x32_bf16 v[76:79], a[236:239], a[0:3], v[76:79]
    ds_read_b128 a[236:239], v6 offset:59392
    v_mfma_f32_16x16x32_bf16 v[80:83], a[240:243], a[0:3], v[80:83]
    ds_read_b128 a[240:243], v6 offset:60416
    s_waitcnt vmcnt(9) lgkmcnt(15)
    v_mfma_f32_16x16x32_bf16 v[64:67], a[244:247], a[4:7], v[64:67]
    buffer_load_dwordx4 a[44:47], v3, s[12:15], s66 offen offset:64 sc1
    ds_read_b128 a[244:247], v10 offset:0
    v_mfma_f32_16x16x32_bf16 v[68:71], a[248:251], a[4:7], v[68:71]
    s_add_u32 s66, s66, 18432
    ds_read_b128 a[248:251], v10 offset:1024
    v_mfma_f32_16x16x32_bf16 v[72:75], a[252:255], a[4:7], v[72:75]
    ds_read_b128 a[252:255], v10 offset:2048
    v_mfma_f32_16x16x32_bf16 v[76:79], v[172:175], a[4:7], v[76:79]
    ds_read_b128 v[172:175], v10 offset:3072
    v_mfma_f32_16x16x32_bf16 v[80:83], v[176:179], a[4:7], v[80:83]
    ds_read_b128 v[176:179], v10 offset:4096
    s_waitcnt vmcnt(9) lgkmcnt(15)
    v_mfma_f32_16x16x32_bf16 v[64:67], v[180:183], a[8:11], v[64:67]
    buffer_load_dwordx4 a[0:3], v3, s[12:15], s66 offen offset:64 sc1
    ds_read_b128 v[180:183], v10 offset:5120
    v_mfma_f32_16x16x32_bf16 v[68:71], v[184:187], a[8:11], v[68:71]
    s_add_u32 s66, s66, 18432
    ds_read_b128 v[184:187], v10 offset:6144
    v_mfma_f32_16x16x32_bf16 v[72:75], v[188:191], a[8:11], v[72:75]
    ds_read_b128 v[188:191], v10 offset:7168
    v_mfma_f32_16x16x32_bf16 v[76:79], v[192:195], a[8:11], v[76:79]
    ds_read_b128 v[192:195], v10 offset:8192
    v_mfma_f32_16x16x32_bf16 v[80:83], v[196:199], a[8:11], v[80:83]
    ds_read_b128 v[196:199], v10 offset:9216
    s_waitcnt vmcnt(9) lgkmcnt(15)
    v_mfma_f32_16x16x32_bf16 v[64:67], v[200:203], a[12:15], v[64:67]
    buffer_load_dwordx4 a[4:7], v3, s[12:15], s66 offen offset:64 sc1
    ds_read_b128 v[200:203], v10 offset:10240
    v_mfma_f32_16x16x32_bf16 v[68:71], v[204:207], a[12:15], v[68:71]
    s_add_u32 s66, s66, 18432
    ds_read_b128 v[204:207], v10 offset:11264
    v_mfma_f32_16x16x32_bf16 v[72:75], v[208:211], a[12:15], v[72:75]
    ds_read_b128 v[208:211], v10 offset:12288
    v_mfma_f32_16x16x32_bf16 v[76:79], v[212:215], a[12:15], v[76:79]
    ds_read_b128 v[212:215], v10 offset:13312
    v_mfma_f32_16x16x32_bf16 v[80:83], v[216:219], a[12:15], v[80:83]
    ds_read_b128 v[216:219], v10 offset:14336
    s_waitcnt vmcnt(9) lgkmcnt(15)
    v_mfma_f32_16x16x32_bf16 v[64:67], v[220:223], a[16:19], v[64:67]
    buffer_load_dwordx4 a[8:11], v3, s[12:15], s66 offen offset:64 sc1
    ds_read_b128 v[220:223], v10 offset:15360
    v_mfma_f32_16x16x32_bf16 v[68:71], v[224:227], a[16:19], v[68:71]
    s_add_u32 s66, s66, 18432
    ds_read_b128 v[224:227], v10 offset:16384
    v_mfma_f32_16x16x32_bf16 v[72:75], v[228:231], a[16:19], v[72:75]
    ds_read_b128 v[228:231], v10 offset:17408
    v_mfma_f32_16x16x32_bf16 v[76:79], v[232:235], a[16:19], v[76:79]
    ds_read_b128 v[232:235], v10 offset:18432
    v_mfma_f32_16x16x32_bf16 v[80:83], v[236:239], a[16:19], v[80:83]
    ds_read_b128 v[236:239], v10 offset:19456
    s_waitcnt vmcnt(9) lgkmcnt(15)
    v_mfma_f32_16x16x32_bf16 v[64:67], v[240:243], a[20:23], v[64:67]
    buffer_load_dwordx4 a[12:15], v3, s[12:15], s66 offen offset:64 sc1
    v_mfma_f32_16x16x32_bf16 v[68:71], v[244:247], a[20:23], v[68:71]
    s_add_u32 s66, s66, 18432
    v_mfma_f32_16x16x32_bf16 v[72:75], v[248:251], a[20:23], v[72:75]
    v_mfma_f32_16x16x32_bf16 v[76:79], v[252:255], a[20:23], v[76:79]
    v_mfma_f32_16x16x32_bf16 v[80:83], a[48:51], a[20:23], v[80:83]
    s_waitcnt vmcnt(9) lgkmcnt(15)
    v_mfma_f32_16x16x32_bf16 v[64:67], a[52:55], a[24:27], v[64:67]
    buffer_load_dwordx4 a[16:19], v3, s[12:15], s66 offen offset:64 sc1
    v_mfma_f32_16x16x32_bf16 v[68:71], a[56:59], a[24:27], v[68:71]
    s_add_u32 s66, s66, 18432
    v_mfma_f32_16x16x32_bf16 v[72:75], a[60:63], a[24:27], v[72:75]
    v_mfma_f32_16x16x32_bf16 v[76:79], a[64:67], a[24:27], v[76:79]
    v_mfma_f32_16x16x32_bf16 v[80:83], a[68:71], a[24:27], v[80:83]
    s_waitcnt vmcnt(9) lgkmcnt(15)
    v_mfma_f32_16x16x32_bf16 v[64:67], a[72:75], a[28:31], v[64:67]
    buffer_load_dwordx4 a[20:23], v3, s[12:15], s66 offen offset:64 sc1
    v_mfma_f32_16x16x32_bf16 v[68:71], a[76:79], a[28:31], v[68:71]
    s_add_u32 s66, s66, 18432
    v_mfma_f32_16x16x32_bf16 v[72:75], a[80:83], a[28:31], v[72:75]
    v_mfma_f32_16x16x32_bf16 v[76:79], a[84:87], a[28:31], v[76:79]
    v_mfma_f32_16x16x32_bf16 v[80:83], a[88:91], a[28:31], v[80:83]
    s_waitcnt vmcnt(9) lgkmcnt(15)
    v_mfma_f32_16x16x32_bf16 v[64:67], a[92:95], a[32:35], v[64:67]
    buffer_load_dwordx4 a[24:27], v3, s[12:15], s66 offen offset:64 sc1
    v_add_u32_e64 v50, 0, v0
    v_mfma_f32_16x16x32_bf16 v[68:71], a[96:99], a[32:35], v[68:71]
    s_add_u32 s66, s66, 18432
    s_mov_b32 s71, 0xCCCD
    v_mul_u32_u24 v51, s71, v50
    v_mfma_f32_16x16x32_bf16 v[72:75], a[100:103], a[32:35], v[72:75]
    v_lshrrev_b32 v51, 19, v51
    v_mfma_f32_16x16x32_bf16 v[76:79], a[104:107], a[32:35], v[76:79]
    s_movk_i32 s71, 1120
    v_mul_u32_u24 v51, s71, v51
    v_mfma_f32_16x16x32_bf16 v[80:83], a[108:111], a[32:35], v[80:83]
    v_lshl_add_u32 v56, v50, 4, v51
    s_waitcnt vmcnt(9) lgkmcnt(15)
    v_mfma_f32_16x16x32_bf16 v[64:67], a[112:115], a[36:39], v[64:67]
    buffer_load_dwordx4 a[28:31], v3, s[12:15], s66 offen offset:64 sc1
    v_add_u32 v50, 64, v0
    v_mfma_f32_16x16x32_bf16 v[68:71], a[116:119], a[36:39], v[68:71]
    s_add_u32 s66, s66, 18432
    s_mov_b32 s71, 0xCCCD
    v_mul_u32_u24 v51, s71, v50
    v_mfma_f32_16x16x32_bf16 v[72:75], a[120:123], a[36:39], v[72:75]
    v_lshrrev_b32 v51, 19, v51
    v_mfma_f32_16x16x32_bf16 v[76:79], v[84:87], a[36:39], v[76:79]
    s_movk_i32 s71, 1120
    v_mul_u32_u24 v51, s71, v51
    v_mfma_f32_16x16x32_bf16 v[80:83], v[88:91], a[36:39], v[80:83]
    v_lshl_add_u32 v57, v50, 4, v51
    s_waitcnt vmcnt(9) lgkmcnt(15)
    v_mfma_f32_16x16x32_bf16 v[64:67], v[92:95], a[40:43], v[64:67]
    buffer_load_dwordx4 a[32:35], v3, s[12:15], s66 offen offset:64 sc1
    v_add_u32 v50, 128, v0
    v_mfma_f32_16x16x32_bf16 v[68:71], v[96:99], a[40:43], v[68:71]
    s_add_u32 s66, s66, 18432
    s_mov_b32 s71, 0xCCCD
    v_mul_u32_u24 v51, s71, v50
    v_mfma_f32_16x16x32_bf16 v[72:75], v[100:103], a[40:43], v[72:75]
    v_lshrrev_b32 v51, 19, v51
    v_mfma_f32_16x16x32_bf16 v[76:79], v[104:107], a[40:43], v[76:79]
    s_movk_i32 s71, 1120
    v_mul_u32_u24_e64 v51, s71, v51
    v_mfma_f32_16x16x32_bf16 v[80:83], v[108:111], a[40:43], v[80:83]
    v_lshl_add_u32 v58, v50, 4, v51
    s_waitcnt vmcnt(9) lgkmcnt(15)
    v_mfma_f32_16x16x32_bf16 v[64:67], v[112:115], a[44:47], v[64:67]
    buffer_load_dwordx4 a[36:39], v3, s[12:15], s66 offen offset:64 sc1
    v_mov_b32 v50, 1073741824
    v_mfma_f32_16x16x32_bf16 v[68:71], v[116:119], a[44:47], v[68:71]
    s_add_u32 s66, s66, 18432
    v_cmp_gt_u32 vcc, 32, v0
    s_nop 1
    v_cndmask_b32 v58, v50, v58, vcc
    v_mfma_f32_16x16x32_bf16 v[72:75], v[120:123], a[44:47], v[72:75]
    s_movk_i32 s68, 160
    v_mul_u32_u24_e64 v59, s68, v2
    v_mfma_f32_16x16x32_bf16 v[76:79], v[124:127], a[44:47], v[76:79]
    v_lshl_add_u32 v59, v1, 3, v59
    v_mfma_f32_16x16x32_bf16 v[80:83], v[128:131], a[44:47], v[80:83]
    s_mul_i32 s68, s44, 2560
    s_add_u32 s68, s68, 81920
    s_waitcnt vmcnt(9) lgkmcnt(15)
    v_mfma_f32_16x16x32_bf16 v[64:67], v[132:135], a[0:3], v[64:67]
    buffer_load_dwordx4 a[40:43], v3, s[12:15], s66 offen offset:64 sc1
    v_add_u32 v59, s68, v59
    v_mfma_f32_16x16x32_bf16 v[68:71], v[136:139], a[0:3], v[68:71]
    s_add_u32 s66, s66, 18432
    v_add_u32_e64 v60, s68, v6
    v_mfma_f32_16x16x32_bf16 v[72:75], v[140:143], a[0:3], v[72:75]
    s_mul_i32 s69, s57, 20480
    s_mul_i32 s70, s48, 160
    v_mfma_f32_16x16x32_bf16 v[76:79], v[144:147], a[0:3], v[76:79]
    s_add_u32 s69, s69, s70
    v_mfma_f32_16x16x32_bf16 v[80:83], v[148:151], a[0:3], v[80:83]
    s_waitcnt vmcnt(9) lgkmcnt(15)
    v_mfma_f32_16x16x32_bf16 v[64:67], v[152:155], a[4:7], v[64:67]
    buffer_load_dwordx4 a[44:47], v3, s[12:15], s66 offen offset:64 sc1
    v_mfma_f32_16x16x32_bf16 v[68:71], v[156:159], a[4:7], v[68:71]
    v_mfma_f32_16x16x32_bf16 v[72:75], v[160:163], a[4:7], v[72:75]
    v_mfma_f32_16x16x32_bf16 v[76:79], v[164:167], a[4:7], v[76:79]
    v_mfma_f32_16x16x32_bf16 v[80:83], v[168:171], a[4:7], v[80:83]
    s_waitcnt vmcnt(9) lgkmcnt(15)
    v_mfma_f32_16x16x32_bf16 v[64:67], a[124:127], a[8:11], v[64:67]
    v_mfma_f32_16x16x32_bf16 v[68:71], a[128:131], a[8:11], v[68:71]
    v_mfma_f32_16x16x32_bf16 v[72:75], a[132:135], a[8:11], v[72:75]
    v_mfma_f32_16x16x32_bf16 v[76:79], a[136:139], a[8:11], v[76:79]
    v_mfma_f32_16x16x32_bf16 v[80:83], a[140:143], a[8:11], v[80:83]
    s_waitcnt vmcnt(8) lgkmcnt(15)
    v_mfma_f32_16x16x32_bf16 v[64:67], a[144:147], a[12:15], v[64:67]
    v_mfma_f32_16x16x32_bf16 v[68:71], a[148:151], a[12:15], v[68:71]
    v_mfma_f32_16x16x32_bf16 v[72:75], a[152:155], a[12:15], v[72:75]
    v_mfma_f32_16x16x32_bf16 v[76:79], a[156:159], a[12:15], v[76:79]
    v_mfma_f32_16x16x32_bf16 v[80:83], a[160:163], a[12:15], v[80:83]
    s_waitcnt vmcnt(7) lgkmcnt(15)
    v_mfma_f32_16x16x32_bf16 v[64:67], a[164:167], a[16:19], v[64:67]
    v_mfma_f32_16x16x32_bf16 v[68:71], a[168:171], a[16:19], v[68:71]
    v_mfma_f32_16x16x32_bf16 v[72:75], a[172:175], a[16:19], v[72:75]
    v_mfma_f32_16x16x32_bf16 v[76:79], a[176:179], a[16:19], v[76:79]
    v_mfma_f32_16x16x32_bf16 v[80:83], a[180:183], a[16:19], v[80:83]
    s_waitcnt vmcnt(6) lgkmcnt(15)
    v_mfma_f32_16x16x32_bf16 v[64:67], a[184:187], a[20:23], v[64:67]
    v_mfma_f32_16x16x32_bf16 v[68:71], a[188:191], a[20:23], v[68:71]
    v_mfma_f32_16x16x32_bf16 v[72:75], a[192:195], a[20:23], v[72:75]
    v_mfma_f32_16x16x32_bf16 v[76:79], a[196:199], a[20:23], v[76:79]
    v_mfma_f32_16x16x32_bf16 v[80:83], a[200:203], a[20:23], v[80:83]
    s_waitcnt vmcnt(5) lgkmcnt(15)
    v_mfma_f32_16x16x32_bf16 v[64:67], a[204:207], a[24:27], v[64:67]
    v_mfma_f32_16x16x32_bf16 v[68:71], a[208:211], a[24:27], v[68:71]
    v_mfma_f32_16x16x32_bf16 v[72:75], a[212:215], a[24:27], v[72:75]
    v_mfma_f32_16x16x32_bf16 v[76:79], a[216:219], a[24:27], v[76:79]
    v_mfma_f32_16x16x32_bf16 v[80:83], a[220:223], a[24:27], v[80:83]
    s_waitcnt vmcnt(4) lgkmcnt(15)
    v_mfma_f32_16x16x32_bf16 v[64:67], a[224:227], a[28:31], v[64:67]
    v_mfma_f32_16x16x32_bf16 v[68:71], a[228:231], a[28:31], v[68:71]
    v_mfma_f32_16x16x32_bf16 v[72:75], a[232:235], a[28:31], v[72:75]
    v_mfma_f32_16x16x32_bf16 v[76:79], a[236:239], a[28:31], v[76:79]
    v_mfma_f32_16x16x32_bf16 v[80:83], a[240:243], a[28:31], v[80:83]
    s_waitcnt vmcnt(3) lgkmcnt(15)
    v_mfma_f32_16x16x32_bf16 v[64:67], a[244:247], a[32:35], v[64:67]
    v_mfma_f32_16x16x32_bf16 v[68:71], a[248:251], a[32:35], v[68:71]
    v_mfma_f32_16x16x32_bf16 v[72:75], a[252:255], a[32:35], v[72:75]
    v_mfma_f32_16x16x32_bf16 v[76:79], v[172:175], a[32:35], v[76:79]
    v_mfma_f32_16x16x32_bf16 v[80:83], v[176:179], a[32:35], v[80:83]
    s_waitcnt vmcnt(2) lgkmcnt(10)
    v_mfma_f32_16x16x32_bf16 v[64:67], v[180:183], a[36:39], v[64:67]
    v_mfma_f32_16x16x32_bf16 v[68:71], v[184:187], a[36:39], v[68:71]
    v_mfma_f32_16x16x32_bf16 v[72:75], v[188:191], a[36:39], v[72:75]
    v_mfma_f32_16x16x32_bf16 v[76:79], v[192:195], a[36:39], v[76:79]
    v_mfma_f32_16x16x32_bf16 v[80:83], v[196:199], a[36:39], v[80:83]
    s_waitcnt vmcnt(1) lgkmcnt(5)
    v_mfma_f32_16x16x32_bf16 v[64:67], v[200:203], a[40:43], v[64:67]
    v_mfma_f32_16x16x32_bf16 v[68:71], v[204:207], a[40:43], v[68:71]
    v_mfma_f32_16x16x32_bf16 v[72:75], v[208:211], a[40:43], v[72:75]
    v_mfma_f32_16x16x32_bf16 v[76:79], v[212:215], a[40:43], v[76:79]
    v_mfma_f32_16x16x32_bf16 v[80:83], v[216:219], a[40:43], v[80:83]
    s_waitcnt vmcnt(0) lgkmcnt(0)
    v_mfma_f32_16x16x32_bf16 v[64:67], v[220:223], a[44:47], v[64:67]
    v_mfma_f32_16x16x32_bf16 v[68:71], v[224:227], a[44:47], v[68:71]
    v_mfma_f32_16x16x32_bf16 v[72:75], v[228:231], a[44:47], v[72:75]
    v_mfma_f32_16x16x32_bf16 v[76:79], v[232:235], a[44:47], v[76:79]
    v_mfma_f32_16x16x32_bf16 v[80:83], v[236:239], a[44:47], v[80:83]
    s_branch L_sk9
L_stub9:
    s_setpc_b64 s[98:99]
L_sk9:
    s_nop 3
    v_pk_add_f32 v[64:65], v[64:65], v[20:21]
    v_pk_add_f32 v[66:67], v[66:67], v[22:23]
    v_cvt_pk_bf16_f32 v64, v64, v65
    v_cvt_pk_bf16_f32 v65, v66, v67
    ds_write_b64 v59, v[64:65] offset:0
    v_pk_add_f32 v[68:69], v[68:69], v[24:25]
    v_pk_add_f32 v[70:71], v[70:71], v[26:27]
    v_cvt_pk_bf16_f32 v68, v68, v69
    v_cvt_pk_bf16_f32 v69, v70, v71
    ds_write_b64 v59, v[68:69] offset:32
    v_pk_add_f32 v[72:73], v[72:73], v[28:29]
    v_pk_add_f32 v[74:75], v[74:75], v[30:31]
    v_cvt_pk_bf16_f32 v72, v72, v73
    v_cvt_pk_bf16_f32 v73, v74, v75
    ds_write_b64 v59, v[72:73] offset:64
    v_pk_add_f32 v[76:77], v[76:77], v[32:33]
    v_pk_add_f32 v[78:79], v[78:79], v[34:35]
    v_cvt_pk_bf16_f32 v76, v76, v77
    v_cvt_pk_bf16_f32 v77, v78, v79
    ds_write_b64 v59, v[76:77] offset:96
    v_pk_add_f32 v[80:81], v[80:81], v[36:37]
    v_pk_add_f32 v[82:83], v[82:83], v[38:39]
    v_cvt_pk_bf16_f32 v80, v80, v81
    v_cvt_pk_bf16_f32 v81, v82, v83
    ds_write_b64 v59, v[80:81] offset:128
    s_waitcnt lgkmcnt(0)
    ds_read_b128 v[84:87], v60 offset:0
    ds_read_b128 v[88:91], v60 offset:1024
    ds_read_b128 v[92:95], v60 offset:2048
    s_waitcnt lgkmcnt(2)
    buffer_store_dwordx4 v[84:87], v56, s[16:19], s69 offen
    s_waitcnt lgkmcnt(1)
    buffer_store_dwordx4 v[88:91], v57, s[16:19], s69 offen
    s_waitcnt lgkmcnt(0)
    buffer_store_dwordx4 v[92:95], v58, s[16:19], s69 offen
L_end:
    s_endpgm
L_idle_1:
    v_lshrrev_b32 v48, 3, v0
    v_and_b32 v49, 7, v0
    v_lshlrev_b32 v49, 4, v49
    s_movk_i32 s71, 1280
    v_mad_u32_u24 v233, v48, s71, v49
    v_add_u32 v217, 9216, v233
    v_add_u32 v218, 18432, v233
    v_add_u32 v219, 27648, v233
    v_mov_b32 v216, v233
    s_lshl_b32 s100, s44, 15
    s_lshl_b32 s101, s54, 2
    s_add_u32 s101, s101, s44
    s_cmp_lt_u32 s101, 8
    s_cselect_b32 s73, 0, 1073741824
    s_add_u32 s68, s101, 0
    s_mul_i32 s69, s68, 0xCCCD
    s_lshr_b32 s69, s69, 19
    s_mul_i32 s70, s69, 10
    s_sub_u32 s70, s68, s70
    s_mul_i32 s3, s69, 40960
    s_lshl_b32 s70, s70, 7
    s_add_u32 s3, s3, s70
    s_add_u32 s68, s101, 64
    s_mul_i32 s69, s68, 0xCCCD
    s_lshr_b32 s69, s69, 19
    s_mul_i32 s70, s69, 10
    s_sub_u32 s70, s68, s70
    s_mul_i32 s82, s69, 40960
    s_lshl_b32 s70, s70, 7
    s_add_u32 s82, s82, s70
    s_add_u32 s68, s101, 128
    s_mul_i32 s69, s68, 0xCCCD
    s_lshr_b32 s69, s69, 19
    s_mul_i32 s70, s69, 10
    s_sub_u32 s70, s68, s70
    s_mul_i32 s83, s69, 40960
    s_lshl_b32 s70, s70, 7
    s_add_u32 s83, s83, s70
    s_add_u32 s68, s101, 192
    s_mul_i32 s69, s68, 0xCCCD
    s_lshr_b32 s69, s69, 19
    s_mul_i32 s70, s69, 10
    s_sub_u32 s70, s68, s70
    s_mul_i32 s66, s69, 40960
    s_lshl_b32 s70, s70, 7
    s_add_u32 s66, s66, s70
    v_mov_b32 v42, 0x3f803f80
    v_mov_b32 v43, 0x3f803f80
    v_mov_b32 v44, 0x3f803f80
    v_mov_b32 v45, 0x3f803f80
    s_waitcnt lgkmcnt(0)
    s_mov_b32 s24, s88
    s_mov_b32 s25, s89
    s_mov_b32 s26, 819200
    s_mov_b32 s27, 0x20000
    s_mov_b32 s12, s74
    s_mov_b32 s13, s75
    s_mov_b32 s14, 18874368
    s_mov_b32 s15, 0x20000
    s_mov_b32 s20, s78
    s_mov_b32 s21, s79
    s_mov_b32 s22, 256
    s_mov_b32 s23, 0x20000
    s_mov_b32 s16, s76
    s_mov_b32 s17, s77
    s_mov_b32 s18, 2621440
    s_mov_b32 s19, 0x20000
    v_mov_b32 v52, 0
    v_mov_b32 v53, 0
    v_mov_b32 v54, 0
    v_mov_b32 v55, 0
    s_sub_u32 s68, s2, 252
    s_lshl_b32 s68, s68, 2
    s_add_u32 s68, s68, s44
    s_lshl_b32 s68, s68, 11
    s_cmp_ge_u32 s2, 252
    s_cselect_b32 s68, s68, 1073741824
    v_lshlrev_b32 v48, 4, v0
    buffer_store_dwordx4 v[52:55], v48, s[12:15], s68 offen offset:0 sc1
    buffer_store_dwordx4 v[52:55], v48, s[12:15], s68 offen offset:1024 sc1
    s_add_u32 m0, s100, 0
    s_nop 0
    buffer_load_dwordx4 v216, s[24:27], s3 offen offset:0 nt lds
    buffer_load_dwordx4 v217, s[24:27], s3 offen offset:1024 nt lds
    buffer_load_dwordx4 v218, s[24:27], s3 offen offset:2048 nt lds
    buffer_load_dwordx4 v219, s[24:27], s3 offen offset:3072 nt lds
    s_cmp_lt_u32 s2, 252
    s_cbranch_scc1 L_noclr_20
    s_waitcnt vmcnt(4)
    s_barrier
    s_cmp_lg_u32 s44, 0
    s_cbranch_scc1 L_noclr_20
    s_sub_u32 s68, s2, 252
    s_lshl_b32 s68, s68, 2
    v_mov_b32 v48, 1
    s_mov_b64 exec, 1
    buffer_store_dword v48, v52, s[20:23], s68 offen sc1
    s_mov_b64 exec, -1
L_noclr_20:
    s_add_u32 m0, s100, 4096
    s_nop 0
    buffer_load_dwordx4 v216, s[24:27], s82 offen offset:0 nt lds
    buffer_load_dwordx4 v217, s[24:27], s82 offen offset:1024 nt lds
    buffer_load_dwordx4 v218, s[24:27], s82 offen offset:2048 nt lds
    buffer_load_dwordx4 v219, s[24:27], s82 offen offset:3072 nt lds
    s_add_u32 m0, s100, 8192
    s_nop 0
    buffer_load_dwordx4 v216, s[24:27], s83 offen offset:0 nt lds
    buffer_load_dwordx4 v217, s[24:27], s83 offen offset:1024 nt lds
    buffer_load_dwordx4 v218, s[24:27], s83 offen offset:2048 nt lds
    buffer_load_dwordx4 v219, s[24:27], s83 offen offset:3072 nt lds
    s_add_u32 m0, s100, 12288
    s_nop 0
    buffer_load_dwordx4 v216, s[24:27], s66 offen offset:0 nt lds
    buffer_load_dwordx4 v217, s[24:27], s66 offen offset:1024 nt lds
    buffer_load_dwordx4 v218, s[24:27], s66 offen offset:2048 nt lds
    buffer_load_dwordx4 v219, s[24:27], s66 offen offset:3072 nt lds
    s_mov_b32 s4, s84
    s_mov_b32 s5, s85
    s_mov_b32 s6, 2621440
    s_mov_b32 s7, 0x20000
    s_mov_b32 s24, s88
    s_mov_b32 s25, s89
    s_mov_b32 s26, 819200
    s_mov_b32 s27, 0x20000
    s_mov_b32 s28, s92
    s_mov_b32 s29, s93
    s_mov_b32 s30, 819200
    s_mov_b32 s31, 0x20000
    s_mov_b32 s32, s94
    s_mov_b32 s33, s95
    s_mov_b32 s34, 819200
    s_mov_b32 s35, 0x20000
    s_mov_b32 s36, s96
    s_mov_b32 s37, s97
    s_mov_b32 s38, 1966080
    s_mov_b32 s39, 0x20000
    s_mov_b32 s40, s98
    s_mov_b32 s41, s99
    s_mov_b32 s42, 1966080
    s_mov_b32 s43, 0x20000
    s_mov_b32 s12, s74
    s_mov_b32 s13, s75
    s_mov_b32 s14, 18874368
    s_mov_b32 s15, 0x20000
    s_lshl_b32 s49, s47, 2
    s_add_u32 s49, s49, s44
    s_lshl_b32 s57, s45, 4
    s_add_u32 s57, s57, s49
    s_mul_i32 s50, s45, 1310720
    s_add_u32 s50, s50, 1048576
    s_lshl_b32 s53, s45, 9
    s_add_u32 s53, s53, 8192
    s_lshl_b32 s52, s46, 2
    s_add_u32 s52, s52, s44
    s_lshl_b32 s52, s52, 2
    s_add_u32 s52, s52, s53
    v_lshlrev_b32 v8, 3, v0
    v_lshlrev_b32 v48, 3, v0
    v_add_u32 v48, s45, v48
    s_add_u32 s71, s45, 7
    v_lshlrev_b32 v49, 4, v2
    v_add_u32 v49, s71, v49
    v_cmp_lt_u32 vcc, 1, v1
    s_nop 1
    v_cndmask_b32 v48, v48, v49, vcc
    v_lshlrev_b32 v4, 5, v48
    s_movk_i32 s71, 4608
    v_mul_u32_u24 v3, s71, v1
    v_lshlrev_b32 v48, 4, v2
    v_add_u32 v3, v3, v48
    v_lshlrev_b32 v6, 4, v0
    v_lshrrev_b32 v48, 2, v0
    s_movk_i32 s71, 160
    v_mul_u32_u24 v50, s71, v48
    v_and_b32 v49, 3, v0
    v_lshl_add_u32 v15, v49, 3, v50
    v_add_u32 v10, 61440, v6
    v_add_u32 v11, 122880, v6
    v_and_b32 v48, 1, v1
    v_lshlrev_b32 v48, 10, v48
    v_lshrrev_b32_e64 v49, 5, v0
    v_lshl_add_u32 v48, v49, 8, v48
    v_lshl_add_u32 v7, v2, 4, v48
    v_add_u32 v16, 61440, v7
    v_add_u32 v17, 122880, v7
    s_movk_i32 s71, 4608
    v_and_b32 v48, 31, v0
    v_lshlrev_b32 v48, 4, v48
    v_mad_u32_u24 v19, v49, s71, v48
    v_lshlrev_b32 v12, 6, v2
    v_lshl_add_u32 v12, v1, 4, v12
    s_mul_i32 s59, s44, 5120
    s_mul_i32 s58, s48, 5120
    s_mul_i32 s71, s44, 40960
    s_add_u32 s58, s58, s71
    s_mul_i32 s61, s44, 3072
    s_lshr_b32 s60, s46, 1
    s_mul_i32 s60, s60, 6144
    s_lshr_b32 s71, s44, 1
    s_mul_i32 s71, s71, 98304
    s_add_u32 s60, s60, s71
    s_and_b32 s71, s44, 1
    s_mul_i32 s71, s71, 3072
    s_add_u32 s60, s60, s71
    s_mul_i32 s71, s48, 5
    s_lshr_b32 s71, s71, 1
    s_mul_i32 s71, s71, 18432
    s_lshl_b32 s72, s49, 8
    s_add_u32 s72, s72, s50
    s_add_u32 s63, s71, s72
    s_add_u32 s64, s63, 18432
    s_add_u32 s65, s63, 36864
    v_lshrrev_b32 v48, 2, v0
    v_lshlrev_b32 v48, 7, v48
    v_and_b32 v49, 3, v0
    v_lshl_add_u32 v48, v49, 3, v48
    v_add_u32 v234, s100, v48
    v_lshlrev_b32 v238, 2, v49
    v_add_u32 v237, 240, v2
    v_lshlrev_b32 v237, 5, v237
    s_waitcnt vmcnt(12)
    ds_read_b64_tr_b16 a[0:1], v234 offset:0
    ds_read_b64_tr_b16 a[2:3], v234 offset:2048
    ds_read_b64_tr_b16 a[4:5], v234 offset:32
    ds_read_b64_tr_b16 a[6:7], v234 offset:2080
    ds_read_b64_tr_b16 a[8:9], v234 offset:64
    ds_read_b64_tr_b16 a[10:11], v234 offset:2112
    ds_read_b64_tr_b16 a[12:13], v234 offset:96
    ds_read_b64_tr_b16 a[14:15], v234 offset:2144
    s_lshl_b32 s86, s101, 12
    s_add_u32 s86, s86, 11534336
    s_waitcnt lgkmcnt(0)
    buffer_store_dwordx4 a[0:3], v6, s[12:15], s86 offen offset:0 sc1
    buffer_store_dwordx4 a[4:7], v6, s[12:15], s86 offen offset:1024 sc1
    buffer_store_dwordx4 a[8:11], v6, s[12:15], s86 offen offset:2048 sc1
    buffer_store_dwordx4 a[12:15], v6, s[12:15], s86 offen offset:3072 sc1
    s_waitcnt vmcnt(12)
    ds_read_b64_tr_b16 a[16:17], v234 offset:4096
    ds_read_b64_tr_b16 a[18:19], v234 offset:6144
    ds_read_b64_tr_b16 a[20:21], v234 offset:4128
    ds_read_b64_tr_b16 a[22:23], v234 offset:6176
    ds_read_b64_tr_b16 a[24:25], v234 offset:4160
    ds_read_b64_tr_b16 a[26:27], v234 offset:6208
    ds_read_b64_tr_b16 a[28:29], v234 offset:4192
    ds_read_b64_tr_b16 a[30:31], v234 offset:6240
    s_lshl_b32 s86, s101, 12
    s_add_u32 s86, s86, 11796480
    s_waitcnt lgkmcnt(0)
    buffer_store_dwordx4 a[16:19], v6, s[12:15], s86 offen offset:0 sc1
    buffer_store_dwordx4 a[20:23], v6, s[12:15], s86 offen offset:1024 sc1
    buffer_store_dwordx4 a[24:27], v6, s[12:15], s86 offen offset:2048 sc1
    buffer_store_dwordx4 a[28:31], v6, s[12:15], s86 offen offset:3072 sc1
    s_waitcnt vmcnt(12)
    ds_read_b64_tr_b16 a[32:33], v234 offset:8192
    ds_read_b64_tr_b16 a[34:35], v234 offset:10240
    ds_read_b64_tr_b16 a[36:37], v234 offset:8224
    ds_read_b64_tr_b16 a[38:39], v234 offset:10272
    ds_read_b64_tr_b16 a[40:41], v234 offset:8256
    ds_read_b64_tr_b16 a[42:43], v234 offset:10304
    ds_read_b64_tr_b16 a[44:45], v234 offset:8288
    ds_read_b64_tr_b16 a[46:47], v234 offset:10336
    s_lshl_b32 s86, s101, 12
    s_add_u32 s86, s86, 12058624
    s_waitcnt lgkmcnt(0)
    buffer_store_dwordx4 a[32:35], v6, s[12:15], s86 offen offset:0 sc1
    buffer_store_dwordx4 a[36:39], v6, s[12:15], s86 offen offset:1024 sc1
    buffer_store_dwordx4 a[40:43], v6, s[12:15], s86 offen offset:2048 sc1
    buffer_store_dwordx4 a[44:47], v6, s[12:15], s86 offen offset:3072 sc1
    s_waitcnt vmcnt(12)
    ds_read_b64_tr_b16 a[48:49], v234 offset:12288
    ds_read_b64_tr_b16 a[50:51], v234 offset:14336
    ds_read_b64_tr_b16 a[52:53], v234 offset:12320
    ds_read_b64_tr_b16 a[54:55], v234 offset:14368
    ds_read_b64_tr_b16 a[56:57], v234 offset:12352
    ds_read_b64_tr_b16 a[58:59], v234 offset:14400
    ds_read_b64_tr_b16 a[60:61], v234 offset:12384
    ds_read_b64_tr_b16 a[62:63], v234 offset:14432
    s_lshl_b32 s86, s101, 12
    s_add_u32 s86, s86, 12320768
    s_or_b32 s86, s86, s73
    s_waitcnt lgkmcnt(0)
    buffer_store_dwordx4 a[48:51], v6, s[12:15], s86 offen offset:0 sc1
    buffer_store_dwordx4 a[52:55], v6, s[12:15], s86 offen offset:1024 sc1
    buffer_store_dwordx4 a[56:59], v6, s[12:15], s86 offen offset:2048 sc1
    buffer_store_dwordx4 a[60:63], v6, s[12:15], s86 offen offset:3072 sc1
    s_mov_b32 s56, 0
L_sp_21:
    buffer_load_dword v236, v238, s[20:23], 0 offen sc1
    s_add_u32 s56, s56, 1
    s_waitcnt vmcnt(0)
    v_cmp_eq_u32 vcc, 0, v236
    s_cmp_gt_u32 s56, 200000
    s_cbranch_scc1 L_spo_22
    s_cbranch_vccnz L_sp_21
L_spo_22:
    s_barrier
    s_cmp_lg_u32 s44, 0
    s_cbranch_scc1 L_norf_23
    v_mov_b32 v48, 1
    v_mov_b32 v49, 0
    s_lshl_b32 s68, s2, 5
    s_mov_b64 exec, 1
    buffer_store_dword v48, v49, s[12:15], s68 offen offset:16 sc1
    s_mov_b64 exec, -1
L_norf_23:
    s_getreg_b32 s71, hwreg(HW_REG_XCC_ID)
    s_and_b32 s71, s71, 15
    s_or_b32 s71, s71, 0x80
    v_mov_b32 v48, s71
    s_lshl_b32 s71, s2, 5
    s_cmp_eq_u32 s44, 0
    s_cselect_b32 s71, s71, 1073741824
    v_mov_b32 v49, 0
    s_mov_b64 exec, 1
    buffer_store_dword v48, v49, s[12:15], s71 offen sc1
    s_mov_b64 exec, -1
    s_mov_b32 s56, 0
L_sp_24:
    buffer_load_dword v236, v237, s[12:15], 0 offen offset:16 sc1
    s_add_u32 s56, s56, 1
    s_waitcnt vmcnt(0)
    v_cmp_eq_u32 vcc, 0, v236
    s_cmp_gt_u32 s56, 200000
    s_cbranch_scc1 L_spo_25
    s_cbranch_vccnz L_sp_24
L_spo_25:
    s_add_u32 m0, s59, 61440
    s_add_u32 s67, s58, 11534336
    buffer_load_dwordx4 v6, s[12:15], s67 offen offset:0 sc1 lds
    buffer_load_dwordx4 v6, s[12:15], s67 offen offset:1024 sc1 lds
    buffer_load_dwordx4 v6, s[12:15], s67 offen offset:2048 sc1 lds
    buffer_load_dwordx4 v6, s[12:15], s67 offen offset:3072 sc1 lds
    s_add_u32 m0, s59, 65536
    s_add_u32 s67, s58, 11538432
    buffer_load_dwordx4 v6, s[12:15], s67 offen offset:0 sc1 lds
    s_add_u32 m0, s59, 81920
    s_add_u32 s67, s58, 11698176
    buffer_load_dwordx4 v6, s[12:15], s67 offen offset:0 sc1 lds
    buffer_load_dwordx4 v6, s[12:15], s67 offen offset:1024 sc1 lds
    buffer_load_dwordx4 v6, s[12:15], s67 offen offset:2048 sc1 lds
    buffer_load_dwordx4 v6, s[12:15], s67 offen offset:3072 sc1 lds
    s_add_u32 m0, s59, 86016
    s_add_u32 s67, s58, 11702272
    buffer_load_dwordx4 v6, s[12:15], s67 offen offset:0 sc1 lds
    s_add_u32 m0, s59, 102400
    s_add_u32 s67, s58, 11862016
    buffer_load_dwordx4 v6, s[12:15], s67 offen offset:0 sc1 lds
    buffer_load_dwordx4 v6, s[12:15], s67 offen offset:1024 sc1 lds
    buffer_load_dwordx4 v6, s[12:15], s67 offen offset:2048 sc1 lds
    buffer_load_dwordx4 v6, s[12:15], s67 offen offset:3072 sc1 lds
    s_add_u32 m0, s59, 106496
    s_add_u32 s67, s58, 11866112
    buffer_load_dwordx4 v6, s[12:15], s67 offen offset:0 sc1 lds
    s_add_u32 m0, s59, 122880
    s_add_u32 s67, s58, 12025856
    buffer_load_dwordx4 v6, s[12:15], s67 offen offset:0 sc1 lds
    buffer_load_dwordx4 v6, s[12:15], s67 offen offset:1024 sc1 lds
    buffer_load_dwordx4 v6, s[12:15], s67 offen offset:2048 sc1 lds
    buffer_load_dwordx4 v6, s[12:15], s67 offen offset:3072 sc1 lds
    s_add_u32 m0, s59, 126976
    s_add_u32 s67, s58, 12029952
    buffer_load_dwordx4 v6, s[12:15], s67 offen offset:0 sc1 lds
    s_add_u32 m0, s59, 143360
    s_add_u32 s67, s58, 12189696
    buffer_load_dwordx4 v6, s[12:15], s67 offen offset:0 sc1 lds
    buffer_load_dwordx4 v6, s[12:15], s67 offen offset:1024 sc1 lds
    buffer_load_dwordx4 v6, s[12:15], s67 offen offset:2048 sc1 lds
    buffer_load_dwordx4 v6, s[12:15], s67 offen offset:3072 sc1 lds
    s_add_u32 m0, s59, 147456
    s_add_u32 s67, s58, 12193792
    buffer_load_dwordx4 v6, s[12:15], s67 offen offset:0 sc1 lds
    s_mov_b32 exec_hi, 0
    buffer_load_dword v239, v4, s[12:15], 0 offen sc1
    s_mov_b32 exec_hi, -1
    s_waitcnt vmcnt(0)
    s_mov_b32 exec_hi, 0
    v_cmp_eq_u32 vcc, 0, v239
    s_cbranch_vccz L_gm_26
    s_mov_b32 s56, 0
L_sp_27:
    buffer_load_dword v239, v4, s[12:15], 0 offen sc1
    s_add_u32 s56, s56, 1
    s_waitcnt vmcnt(0)
    v_cmp_eq_u32 vcc, 0, v239
    s_cmp_gt_u32 s56, 200000
    s_cbranch_scc1 L_spo_28
    s_cbranch_vccnz L_sp_27
L_spo_28:
L_gm_26:
    s_getreg_b32 s71, hwreg(HW_REG_XCC_ID)
    s_and_b32 s71, s71, 15
    s_or_b32 s71, s71, 0x80
    v_cmp_ne_u32 vcc, s71, v239
    s_mov_b32 exec_hi, -1
    s_cmp_eq_u32 vcc_lo, 0
    s_cselect_b32 s51, 1, 0
    v_mov_b32 v48, 2
    v_mov_b32 v49, 0
    s_mov_b64 exec, 1
    s_cmp_eq_u32 s51, 1
    s_cbranch_scc0 L_alt_29
    buffer_store_dword v48, v49, s[12:15], s52 offen
    s_branch L_altd_30
L_alt_29:
    buffer_store_dword v48, v49, s[12:15], s52 offen sc1
L_altd_30:
    s_mov_b64 exec, -1
    s_cmp_lg_u32 s46, 30
    s_cbranch_scc1 L_nogd_31
    s_cmp_lg_u32 s44, 0
    s_cbranch_scc1 L_nogd_31
    s_mov_b64 s[74:75], -1
    s_mov_b64 exec, s[74:75]
    s_mov_b32 s56, 0
L_sp_32:
    buffer_load_dwordx2 v[48:49], v8, s[12:15], s53 offen sc1
    s_add_u32 s56, s56, 1
    s_waitcnt vmcnt(0)
    v_min_u32 v48, v48, v49
    v_cmp_gt_u32 vcc, 1, v48
    s_cmp_gt_u32 s56, 200000
    s_cbranch_scc1 L_spo_33
    s_cbranch_vccnz L_sp_32
L_spo_33:
    s_mov_b64 exec, -1
    v_mov_b32 v48, 1
    v_mov_b32 v49, 0
    s_lshl_b32 s68, s45, 2
    s_add_u32 s68, s68, 14336
    s_mov_b64 exec, 1
    buffer_store_dword v48, v49, s[12:15], s68 offen sc1
    s_mov_b64 exec, -1
L_nogd_31:
    s_and_b32 s68, s46, 1
    s_lshl_b32 s68, s68, 2
    s_add_u32 s68, s68, s44
    s_lshl_b32 s68, s68, 2
    s_add_u32 s68, s68, 240
    s_mul_i32 s68, s68, 4608
    s_add_u32 s68, s68, s50
    s_movk_i32 s69, 4608
    v_lshlrev_b32 v238, 7, v2
    v_mad_u32_u24 v238, v1, s69, v238
    buffer_load_dword v5, v238, s[12:15], s68 offen offset:256 sc1
    buffer_load_dword v5, v238, s[12:15], s68 offen offset:2304 sc1
    s_barrier
    v_add_u32 v50, 0, v0
    s_mov_b32 s71, 0xCCCD
    v_mul_u32_u24 v51, s71, v50
    v_lshrrev_b32 v51, 19, v51
    s_movk_i32 s71, 1120
    v_mul_u32_u24 v51, s71, v51
    v_lshl_add_u32 v251, v50, 4, v51
    v_add_u32 v50, 64, v0
    s_mov_b32 s71, 0xCCCD
    v_mul_u32_u24 v51, s71, v50
    v_lshrrev_b32 v51, 19, v51
    s_movk_i32 s71, 1120
    v_mul_u32_u24_e64 v51, s71, v51
    v_lshl_add_u32 v252, v50, 4, v51
    v_add_u32 v50, 128, v0
    s_mov_b32 s71, 0xCCCD
    v_mul_u32_u24 v51, s71, v50
    v_lshrrev_b32 v51, 19, v51
    s_movk_i32 s71, 1120
    v_mul_u32_u24 v51, s71, v51
    v_lshl_add_u32 v253, v50, 4, v51
    v_mov_b32 v50, 1073741824
    v_cmp_gt_u32 vcc, 32, v0
    s_nop 1
    v_cndmask_b32 v253, v50, v253, vcc
    s_add_u32 s100, s59, 40960
    s_movk_i32 s68, 160
    v_mul_u32_u24 v254, s68, v2
    v_lshl_add_u32 v254, v1, 3, v254
    v_add_u32_e64 v254, s100, v254
    s_mul_i32 s72, s57, 20480
    s_mul_i32 s70, s48, 160
    s_add_u32 s72, s72, s70
    s_add_u32 m0, s100, 0
    s_nop 0
    buffer_load_dwordx4 v251, s[4:7], s72 offen lds
    s_add_u32 m0, s100, 1024
    s_nop 0
    buffer_load_dwordx4 v252, s[4:7], s72 offen lds
    s_add_u32 m0, s100, 2048
    s_nop 0
    buffer_load_dwordx4 v253, s[4:7], s72 offen lds
    s_lshl_b32 s68, s57, 10
    s_add_u32 s68, s68, 262144
    s_mov_b64 exec, 0x5555
    buffer_load_dword v5, v12, s[12:15], s68 offen sc1
    s_mov_b64 exec, -1
    s_waitcnt vmcnt(1)
    ds_read_b64 v[20:21], v254 offset:0
    ds_read_b64 v[22:23], v254 offset:32
    ds_read_b64 v[24:25], v254 offset:64
    ds_read_b64 v[26:27], v254 offset:96
    ds_read_b64 v[28:29], v254 offset:128
    ds_read_b128 a[48:51], v10 offset:0
    ds_read_b128 a[52:55], v10 offset:1024
    ds_read_b128 a[56:59], v10 offset:2048
    ds_read_b128 a[60:63], v10 offset:3072
    ds_read_b128 a[64:67], v10 offset:4096
    ds_read_b128 a[68:71], v10 offset:5120
    ds_read_b128 a[72:75], v10 offset:6144
    ds_read_b128 a[76:79], v10 offset:7168
    ds_read_b128 a[80:83], v10 offset:8192
    ds_read_b128 a[84:87], v10 offset:9216
    ds_read_b128 a[88:91], v10 offset:10240
    ds_read_b128 a[92:95], v10 offset:11264
    ds_read_b128 a[96:99], v10 offset:12288
    ds_read_b128 a[100:103], v10 offset:13312
    ds_read_b128 a[104:107], v10 offset:14336
    ds_read_b128 a[108:111], v10 offset:15360
    ds_read_b128 a[112:115], v10 offset:16384
    ds_read_b128 a[116:119], v10 offset:17408
    ds_read_b128 a[120:123], v10 offset:18432
    ds_read_b128 a[124:127], v10 offset:19456
    ds_read_b128 a[128:131], v10 offset:20480
    ds_read_b128 a[132:135], v10 offset:21504
    ds_read_b128 a[136:139], v10 offset:22528
    ds_read_b128 a[140:143], v10 offset:23552
    ds_read_b128 a[144:147], v10 offset:24576
    ds_read_b128 a[148:151], v10 offset:25600
    ds_read_b128 a[152:155], v10 offset:26624
    ds_read_b128 a[156:159], v10 offset:27648
    ds_read_b128 a[160:163], v10 offset:28672
    ds_read_b128 a[164:167], v10 offset:29696
    ds_read_b128 a[168:171], v10 offset:30720
    ds_read_b128 a[172:175], v10 offset:31744
    ds_read_b128 a[176:179], v10 offset:32768
    ds_read_b128 a[180:183], v10 offset:33792
    ds_read_b128 a[184:187], v10 offset:34816
    ds_read_b128 a[188:191], v10 offset:35840
    ds_read_b128 a[192:195], v10 offset:36864
    ds_read_b128 a[196:199], v10 offset:37888
    ds_read_b128 a[200:203], v10 offset:38912
    ds_read_b128 a[204:207], v10 offset:39936
    ds_read_b128 a[208:211], v10 offset:40960
    ds_read_b128 a[212:215], v10 offset:41984
    ds_read_b128 a[216:219], v10 offset:43008
    ds_read_b128 a[220:223], v10 offset:44032
    ds_read_b128 a[224:227], v10 offset:45056
    ds_read_b128 a[228:231], v10 offset:46080
    ds_read_b128 a[232:235], v10 offset:47104
    ds_read_b128 a[236:239], v10 offset:48128
    ds_read_b128 a[240:243], v10 offset:49152
    ds_read_b128 a[244:247], v10 offset:50176
    ds_read_b128 a[248:251], v10 offset:51200
    ds_read_b128 a[252:255], v10 offset:52224
    s_and_b32 s62, s46, 1
    s_lshl_b32 s62, s62, 2
    s_add_u32 s62, s62, s44
    v_lshlrev_b32 v53, 2, v1
    v_sub_u32 v53, v2, v53
    v_mov_b32 v55, 0xf149f2ca
    s_cmp_eq_u32 s57, 0
    s_cselect_b32 s70, 7, 0x80000000
    v_subrev_u32 v54, 0, v53
    v_and_b32 v54, 0x80000001, v54
    v_cmp_eq_u32 vcc, 0, v54
    s_nop 1
    v_cndmask_b32 v176, v55, 0, vcc
    v_cmp_eq_u32 vcc, s70, v54
    s_nop 1
    v_cndmask_b32 v172, v55, 0, vcc
    v_subrev_u32 v54, 1, v53
    v_and_b32 v54, 0x80000001, v54
    v_cmp_eq_u32 vcc, 0, v54
    s_nop 1
    v_cndmask_b32 v177, v55, 0, vcc
    v_cmp_eq_u32 vcc, s70, v54
    s_nop 1
    v_cndmask_b32 v173, v55, 0, vcc
    v_subrev_u32 v54, 2, v53
    v_and_b32 v54, 0x80000001, v54
    v_cmp_eq_u32 vcc, 0, v54
    s_nop 1
    v_cndmask_b32 v178, v55, 0, vcc
    v_cmp_eq_u32 vcc, s70, v54
    s_nop 1
    v_cndmask_b32 v174, v55, 0, vcc
    v_subrev_u32 v54, 3, v53
    v_and_b32 v54, 0x80000001, v54
    v_cmp_eq_u32 vcc, 0, v54
    s_nop 1
    v_cndmask_b32 v179, v55, 0, vcc
    v_cmp_eq_u32 vcc, s70, v54
    s_nop 1
    v_cndmask_b32 v175, v55, 0, vcc
    v_add_u32 v56, 368640, v3
    v_add_u32 v57, 737280, v3
    v_add_u32 v58, 0, v3
    s_cmp_eq_u32 s57, 0
    s_cselect_b32 s70, 1073741824, 0
    v_or_b32 v59, s70, v57
    v_or_b32 v60, s70, v58
    s_add_u32 s68, s59, 40960
    s_movk_i32 s69, 160
    v_mul_u32_u24 v53, s69, v2
    v_lshlrev_b32 v54, 3, v1
    v_add3_u32 v53, v53, v54, s68
    v_add_u32_e64 v54, s68, v15
    s_mul_i32 s68, s48, 80
    s_add_u32 s69, s68, 79
    s_lshr_b32 s68, s68, 7
    s_lshr_b32 s69, s69, 7
    s_lshl_b32 s72, 0x420, s68
    s_lshl_b32 s73, 0x420, s69
    s_or_b32 s72, s72, s73
    s_lshl_b32 s68, s68, 2
    s_lshl_b32 s69, s69, 2
    s_mov_b32 s76, 0x00100001
    s_mov_b32 s77, 0x100
    s_lshl_b64 s[74:75], s[76:77], s68
    s_lshl_b64 s[76:77], s[76:77], s69
    s_or_b64 s[76:77], s[74:75], s[76:77]
    s_lshr_b32 s68, s49, 2
    s_sub_u32 s69, s49, 1
    s_max_i32 s69, s69, 0
    s_lshr_b32 s69, s69, 2
    s_lshl_b64 s[74:75], s[76:77], s68
    s_lshl_b64 s[76:77], s[76:77], s69
    s_or_b64 s[74:75], s[74:75], s[76:77]
    s_branch L_join_2
.section .rodata,"a"
.p2align 6
.amdhsa_kernel sequential_preLN__sliding_local_dilated__mixer_s_mlp__prompt_kernel
  .amdhsa_next_free_vgpr 512
  .amdhsa_next_free_sgpr 102
  .amdhsa_accum_offset 256
  .amdhsa_group_segment_fixed_size 0
  .amdhsa_kernarg_size 88
  .amdhsa_user_sgpr_count 2
  .amdhsa_user_sgpr_kernarg_segment_ptr 1
  .amdhsa_system_sgpr_workgroup_id_x 1
  .amdhsa_float_denorm_mode_32 3
.end_amdhsa_kernel
```
